```python
import torch

def _softmax(x, axis=-1):
    return torch.softmax(x, dim=axis)
def _gelu(x):
    return torch.nn.functional.gelu(x, approximate="tanh")
def _silu(x):
    return torch.nn.functional.silu(x)
def _sigmoid(x):
    return torch.sigmoid(x)
def _layernorm(x, axis=-1, eps=1e-5):
    m = x.mean(dim=axis, keepdim=True)
    v = x.var(dim=axis, keepdim=True, unbiased=False)
    return (x - m) / torch.sqrt(v + eps)
def _scatter_add(tgt, idx, src, axis=0):
    return tgt.clone().index_add_(axis, idx, src)
def _segment_sum(src, seg, n):
    out = torch.zeros((n,) + src.shape[1:], dtype=src.dtype)
    return out.index_add_(0, seg, src)
def _pad(x, pw):
    flat = tuple(v for pair in reversed(pw) for v in pair)
    return torch.nn.functional.pad(x, flat)

kernel_name = 'concat_heads__gqa_block_cached__mha_block_cached__near_ridge'

def setup_inputs():

    _w = (lambda a: (lambda t: t.to(torch.bfloat16) if t.is_floating_point() else t)(torch.as_tensor(a)))
    def _A_setup():
        B, Sq, D = 8, 80, 576
        Hq, Hkv, Sk, Dh = 32, 16, 1024, 128
        assert Hq % Hkv == 0, (Hq, Hkv)
        return {
            "x": _w((lambda *s: torch.randn(*s, dtype=torch.bfloat16) * 0.8)(B, Sq, D)),
            "k_cache": _w((lambda *s: torch.randn(*s, dtype=torch.bfloat16) * 0.8)(B, Hkv, Sk, Dh)),
            "v_cache": _w((lambda *s: torch.randn(*s, dtype=torch.bfloat16) * 0.05)(B, Hkv, Sk, Dh)),
            "wq": _w((lambda *s: torch.randn(*s, dtype=torch.bfloat16) * 0.8)(D, Hq * Dh) * (D ** -0.5)),
            "wo": _w((lambda *s: torch.randn(*s, dtype=torch.bfloat16) * 0.05)(Hq * Dh, D) * ((Hq * Dh) ** -0.5)),
        }
    _A_in = _A_setup()

    def _B_setup():
        B, Sq, D = 8, 80, 576
        H, Sk, Dh = 32, 1024, 128
        return {
            "x": _w((lambda *s: torch.randn(*s, dtype=torch.bfloat16) * 0.8)(B, Sq, D)),
            "k_cache": _w((lambda *s: torch.randn(*s, dtype=torch.bfloat16) * 0.8)(B, H, Sk, Dh)),
            "v_cache": _w((lambda *s: torch.randn(*s, dtype=torch.bfloat16) * 0.05)(B, H, Sk, Dh)),
            "wq": _w((lambda *s: torch.randn(*s, dtype=torch.bfloat16) * 0.8)(D, H * Dh) * (D ** -0.5)),
            "wo": _w((lambda *s: torch.randn(*s, dtype=torch.bfloat16) * 0.05)(H * Dh, D) * ((H * Dh) ** -0.5)),
        }
    _B_in = _B_setup()

    return {
        "A_x": _A_in["x"],
        "A_k_cache": _A_in["k_cache"],
        "A_v_cache": _A_in["v_cache"],
        "A_wq": _A_in["wq"],
        "A_wo": _A_in["wo"],
        "B_x": _B_in["x"],
        "B_k_cache": _B_in["k_cache"],
        "B_v_cache": _B_in["v_cache"],
        "B_wq": _B_in["wq"],
        "B_wo": _B_in["wo"],
    }

def reference(A_x, A_k_cache, A_v_cache, A_wq, A_wo, B_x, B_k_cache, B_v_cache, B_wq, B_wo):
    def _A_ref(x, k_cache, v_cache, wq, wo):
        B, Sq, D = x.shape
        Hq, Dh = 32, 128
        Hkv = k_cache.shape[1]
        rep = Hq // Hkv
        q = (lambda x, *d: x.permute(*d))((x @ wq).reshape(B, Sq, Hq, Dh), 0, 2, 1, 3)
        k = (lambda x, n, axis: torch.repeat_interleave(x, n, dim=axis))(k_cache, rep, axis=1)
        v = (lambda x, n, axis: torch.repeat_interleave(x, n, dim=axis))(v_cache, rep, axis=1)
        scores = torch.einsum("bhqd,bhkd->bhqk", q, k) * (Dh ** -0.5)
        p = _softmax(scores, axis=-1)
        o = torch.einsum("bhqk,bhkd->bhqd", p, v)
        return (lambda x, *d: x.permute(*d))(o, 0, 2, 1, 3).reshape(B, Sq, Hq * Dh) @ wo

    def _B_ref(x, k_cache, v_cache, wq, wo):
        B, Sq, D = x.shape
        H, Dh = 32, 128
        q = (lambda x, *d: x.permute(*d))((x @ wq).reshape(B, Sq, H, Dh), 0, 2, 1, 3)
        scores = torch.einsum("bhqd,bhkd->bhqk", q, k_cache) * (Dh ** -0.5)
        p = _softmax(scores, axis=-1)
        o = torch.einsum("bhqk,bhkd->bhqd", p, v_cache)
        return (lambda x, *d: x.permute(*d))(o, 0, 2, 1, 3).reshape(B, Sq, H * Dh) @ wo

    a = _A_ref(A_x, A_k_cache, A_v_cache, A_wq, A_wo)
    b = _B_ref(B_x, B_k_cache, B_v_cache, B_wq, B_wo)
    return torch.concatenate([a, b], axis=-1)
```

```asm
; @launch grid=(256,1,1) block=(256,1,1) lds=163840
.amdgcn_target "amdgcn-amd-amdhsa--gfx950"
.text
  .globl concat_heads__gqa_block_cached__mha_block_cached__near_ridge_kernel
  .p2align 8
  .type concat_heads__gqa_block_cached__mha_block_cached__near_ridge_kernel,@function
concat_heads__gqa_block_cached__mha_block_cached__near_ridge_kernel:
  s_cmp_ge_u32 s2, 256
  s_cbranch_scc1 L_concat_heads__gqa_block_cached__mha_block_cached__near_ridge_kernel_end
  s_load_dwordx16 s[40:55], s[0:1], 0
  s_load_dwordx2 s[56:57], s[0:1], 64
  s_load_dwordx2 s[58:59], s[0:1], 96
  s_load_dwordx2 s[100:101], s[0:1], 72
  s_load_dwordx2 s[90:91], s[0:1], 88
  v_lshrrev_b32 v44, 6, v0
  v_and_b32 v1, 63, v0
  v_readfirstlane_b32 s24, v44
  v_and_b32 v2, 15, v1
  v_lshrrev_b32 v3, 4, v1
  s_lshr_b32 s37, s2, 3
  s_cmp_ge_u32 s37, 2
  s_cbranch_scc1 L_concat_heads__gqa_block_cached__mha_block_cached__near_ridge_kernel_nopf
  s_lshl_b32 s37, s37, 2
  s_add_u32 s37, s37, s24
  s_lshl_b32 s37, s37, 13
  s_getpc_b64 s[66:67]
L_concat_heads__gqa_block_cached__mha_block_cached__near_ridge_kernel_pc:
  v_lshlrev_b32 v44, 7, v1
  v_add_u32 v44, s37, v44
  v_min_u32 v44, L_concat_heads__gqa_block_cached__mha_block_cached__near_ridge_kernel_rareend-L_concat_heads__gqa_block_cached__mha_block_cached__near_ridge_kernel_pc-4, v44
  v_mov_b32 v45, s67
  v_add_co_u32 v46, vcc, s66, v44
  s_nop 1
  v_addc_co_u32 v47, vcc, 0, v45, vcc
  global_load_dword v52, v[46:47], off
L_concat_heads__gqa_block_cached__mha_block_cached__near_ridge_kernel_nopf:
  s_lshr_b32 s25, s24, 1
  s_and_b32 s26, s24, 1
  s_and_b32 s37, s2, 7
  s_lshr_b32 s38, s2, 3
  s_lshr_b32 s27, s38, 4
  s_and_b32 s38, s38, 15
  s_mov_b32 s28, 0x3e0293ee
  s_mov_b32 s29, 0x41000000
  v_or_b32 v44, 0, v3
  v_lshlrev_b32 v44, 1, v44
  v_xor_b32 v44, v44, v2
  v_lshlrev_b32 v44, 4, v44
  v_lshl_add_u32 v60, v3, 13, v44
  v_or_b32 v44, 0, v3
  v_lshlrev_b32 v44, 1, v44
  v_xor_b32 v44, v44, v2
  v_lshlrev_b32 v44, 4, v44
  v_lshl_add_u32 v61, v3, 13, v44
  v_add_u32 v61, 31744, v61
  v_or_b32 v44, 4, v3
  v_lshlrev_b32 v44, 1, v44
  v_xor_b32 v44, v44, v2
  v_lshlrev_b32 v44, 4, v44
  v_lshl_add_u32 v62, v3, 13, v44
  v_add_u32 v62, 63488, v62
  v_or_b32 v44, 4, v3
  v_lshlrev_b32 v44, 1, v44
  v_xor_b32 v44, v44, v2
  v_lshlrev_b32 v44, 4, v44
  v_lshl_add_u32 v63, v3, 13, v44
  v_add_u32 v63, 95232, v63
  v_lshrrev_b32 v45, 3, v1
  s_movk_i32 s39, 1152
  v_mul_lo_u32 v45, v45, s39
  v_and_b32 v46, 7, v1
  s_add_u32 s39, s26, 0
  s_and_b32 s39, s39, 1
  s_lshl_b32 s39, s39, 2
  v_add_u32 v44, s39, v3
  v_and_b32 v44, 7, v44
  v_xor_b32 v44, v44, v46
  v_lshl_add_u32 v56, v44, 4, v45
  s_add_u32 s39, s26, 1
  s_and_b32 s39, s39, 1
  s_lshl_b32 s39, s39, 2
  v_add_u32 v44, s39, v3
  v_and_b32 v44, 7, v44
  v_xor_b32 v44, v44, v46
  v_lshl_add_u32 v57, v44, 4, v45
  v_add_u32 v57, 8192, v57
  s_add_u32 s39, s26, 2
  s_and_b32 s39, s39, 1
  s_lshl_b32 s39, s39, 2
  v_add_u32 v44, s39, v3
  v_and_b32 v44, 7, v44
  v_xor_b32 v44, v44, v46
  v_lshl_add_u32 v58, v44, 4, v45
  v_add_u32 v58, 16384, v58
  s_add_u32 s39, s26, 3
  s_and_b32 s39, s39, 1
  s_lshl_b32 s39, s39, 2
  v_add_u32 v44, s39, v3
  v_and_b32 v44, 7, v44
  v_xor_b32 v44, v44, v46
  v_lshl_add_u32 v59, v44, 4, v45
  v_add_u32 v59, 24576, v59
  s_cmp_eq_u32 s27, 0
  s_cbranch_scc0 L_concat_heads__gqa_block_cached__mha_block_cached__near_ridge_kernel_qB
  s_lshr_b32 s67, s38, 1
  s_and_b32 s39, s38, 1
  s_lshl_b32 s39, s39, 2
  s_add_u32 s67, s67, s39
  s_sub_u32 s39, s67, 9
  s_cmp_ge_u32 s67, 9
  s_cselect_b32 s67, s39, s67
  s_lshr_b32 s63, s38, 1
  s_and_b32 s38, s38, 1
  s_lshl_b32 s37, s37, 1
  s_add_u32 s37, s37, s38
  s_lshl_b32 s64, s37, 1
  s_add_u32 s64, s64, s25
  s_lshl_b32 s38, s63, 4
  s_add_u32 s38, s38, s37
  s_lshl_b32 s30, s38, 18
  s_lshl_b32 s39, s26, 13
  s_add_u32 s30, s30, s39
  s_mov_b32 s31, s30
  s_mul_i32 s36, s63, 655360
  s_lshl_b32 s39, s64, 12
  s_add_u32 s36, s36, s39
  s_lshl_b32 s39, s26, 11
  s_add_u32 s36, s36, s39
  s_mul_i32 s34, s63, 92160
  s_mul_i32 s39, s24, 9216
  s_add_u32 s34, s34, s39
  s_lshl_b32 s61, s24, 10
  s_mul_i32 s65, s63, 92160
  s_add_u32 s39, s26, 8
  s_lshl_b32 s66, s39, 10
  s_mul_i32 s39, s39, 9216
  s_add_u32 s65, s65, s39
  s_lshl_b32 s35, s64, 8
  s_lshl_b32 s39, s26, 18
  s_add_u32 s35, s35, s39
  s_lshl_b32 s62, s25, 14
  s_lshl_b32 s39, s26, 13
  s_add_u32 s62, s62, s39
  s_add_u32 s62, s62, 10240
  s_waitcnt lgkmcnt(0)
  s_mov_b32 s4, s40
  s_mov_b32 s5, s41
  s_mov_b32 s6, 737280
  s_mov_b32 s7, 0x00020000
  s_mov_b32 s8, s46
  s_mov_b32 s9, s47
  s_mov_b32 s10, 4718592
  s_mov_b32 s11, 0x00020000
  s_lshl_b32 s39, s67, 7
  s_add_u32 s68, s34, s39
  s_add_u32 s3, s65, s39
  s_lshl_b32 s39, s67, 19
  s_add_u32 s69, s35, s39
  s_add_u32 s67, s67, 1
  s_cmp_eq_u32 s67, 9
  s_cselect_b32 s67, 0, s67
  s_add_u32 m0, s61, 34816
  s_nop 0
  buffer_load_dwordx4 v56, s[4:7], s68 offen offset:0 lds
  s_add_u32 m0, s61, 38912
  s_add_u32 s39, s68, 36864
  buffer_load_dwordx4 v56, s[4:7], s39 offen offset:0 lds
  s_add_u32 m0, s66, 34816
  s_nop 0
  buffer_load_dwordx4 v56, s[4:7], s3 offen offset:0 lds
  s_add_u32 m0, s62, 34816
  s_nop 0
  buffer_load_dwordx4 v60, s[8:11], s69 offen offset:0 lds
  buffer_load_dwordx4 v61, s[8:11], s69 offen offset:1024 lds
  buffer_load_dwordx4 v62, s[8:11], s69 offen offset:2048 lds
  buffer_load_dwordx4 v63, s[8:11], s69 offen offset:3072 lds
  s_add_u32 m0, s62, 38912
  s_add_u32 s69, s69, 131072
  buffer_load_dwordx4 v60, s[8:11], s69 offen offset:0 lds
  buffer_load_dwordx4 v61, s[8:11], s69 offen offset:1024 lds
  buffer_load_dwordx4 v62, s[8:11], s69 offen offset:2048 lds
  buffer_load_dwordx4 v63, s[8:11], s69 offen offset:3072 lds
  s_lshl_b32 s39, s67, 7
  s_add_u32 s68, s34, s39
  s_add_u32 s3, s65, s39
  s_lshl_b32 s39, s67, 19
  s_add_u32 s69, s35, s39
  s_add_u32 s67, s67, 1
  s_cmp_eq_u32 s67, 9
  s_cselect_b32 s67, 0, s67
  s_add_u32 m0, s61, 77824
  s_nop 0
  buffer_load_dwordx4 v56, s[4:7], s68 offen offset:0 lds
  s_add_u32 m0, s61, 81920
  s_add_u32 s39, s68, 36864
  buffer_load_dwordx4 v56, s[4:7], s39 offen offset:0 lds
  s_add_u32 m0, s66, 77824
  s_nop 0
  buffer_load_dwordx4 v56, s[4:7], s3 offen offset:0 lds
  s_add_u32 m0, s62, 77824
  s_nop 0
  buffer_load_dwordx4 v60, s[8:11], s69 offen offset:0 lds
  buffer_load_dwordx4 v61, s[8:11], s69 offen offset:1024 lds
  buffer_load_dwordx4 v62, s[8:11], s69 offen offset:2048 lds
  buffer_load_dwordx4 v63, s[8:11], s69 offen offset:3072 lds
  s_add_u32 m0, s62, 81920
  s_add_u32 s69, s69, 131072
  buffer_load_dwordx4 v60, s[8:11], s69 offen offset:0 lds
  buffer_load_dwordx4 v61, s[8:11], s69 offen offset:1024 lds
  buffer_load_dwordx4 v62, s[8:11], s69 offen offset:2048 lds
  buffer_load_dwordx4 v63, s[8:11], s69 offen offset:3072 lds
  s_mov_b32 s12, s42
  s_mov_b32 s13, s43
  s_mov_b32 s14, 33554432
  s_mov_b32 s15, 0x00020000
  s_mov_b32 s16, s44
  s_mov_b32 s17, s45
  s_mov_b32 s18, 33554432
  s_mov_b32 s19, 0x00020000
  s_mov_b32 s20, s58
  s_mov_b32 s21, s59
  s_mov_b32 s22, 10485760
  s_mov_b32 s23, 0x00020000
  v_add_u32 v44, 0, v3
  v_xor_b32 v44, v44, v2
  v_lshlrev_b32 v44, 4, v44
  v_lshl_add_u32 v4, v3, 8, v44
  v_add_u32 v44, 4, v3
  v_xor_b32 v44, v44, v2
  v_lshlrev_b32 v44, 4, v44
  v_lshl_add_u32 v5, v3, 8, v44
  v_add_u32 v44, 8, v3
  v_xor_b32 v44, v44, v2
  v_lshlrev_b32 v44, 4, v44
  v_lshl_add_u32 v6, v3, 8, v44
  v_add_u32 v44, 12, v3
  v_xor_b32 v44, v44, v2
  v_lshlrev_b32 v44, 4, v44
  v_lshl_add_u32 v7, v3, 8, v44
  v_add_u32 v44, 0, v3
  v_lshlrev_b32 v44, 1, v44
  v_xor_b32 v44, v44, v2
  v_lshlrev_b32 v44, 4, v44
  v_lshl_add_u32 v8, v3, 8, v44
  v_add_u32 v44, 4, v3
  v_lshlrev_b32 v44, 1, v44
  v_xor_b32 v44, v44, v2
  v_lshlrev_b32 v44, 4, v44
  v_lshl_add_u32 v9, v3, 8, v44
  s_lshl_b32 s32, s24, 13
  s_add_u32 s33, s32, 65536
  s_lshl_b32 s39, s26, 1
  s_xor_b32 s39, s39, 0
  s_lshl_b32 s39, s39, 2
  v_add_u32 v44, s39, v3
  v_xor_b32 v44, v44, v2
  v_lshlrev_b32 v44, 4, v44
  v_lshl_add_u32 v44, v2, 8, v44
  v_add_u32 v10, s32, v44
  s_lshl_b32 s39, s26, 1
  s_xor_b32 s39, s39, 1
  s_lshl_b32 s39, s39, 2
  v_add_u32 v44, s39, v3
  v_xor_b32 v44, v44, v2
  v_lshlrev_b32 v44, 4, v44
  v_lshl_add_u32 v44, v2, 8, v44
  v_add_u32 v11, s32, v44
  s_lshl_b32 s39, s26, 1
  s_xor_b32 s39, s39, 2
  s_lshl_b32 s39, s39, 2
  v_add_u32 v44, s39, v3
  v_xor_b32 v44, v44, v2
  v_lshlrev_b32 v44, 4, v44
  v_lshl_add_u32 v44, v2, 8, v44
  v_add_u32 v12, s32, v44
  s_lshl_b32 s39, s26, 1
  s_xor_b32 s39, s39, 3
  s_lshl_b32 s39, s39, 2
  v_add_u32 v44, s39, v3
  v_xor_b32 v44, v44, v2
  v_lshlrev_b32 v44, 4, v44
  v_lshl_add_u32 v44, v2, 8, v44
  v_add_u32 v13, s32, v44
  v_bfe_u32 v45, v1, 2, 2
  v_lshl_add_u32 v45, v3, 2, v45
  v_and_b32 v46, 7, v45
  v_lshlrev_b32 v46, 1, v46
  v_bfe_u32 v47, v1, 1, 1
  v_xor_b32 v46, v46, v47
  v_and_b32 v47, 1, v1
  v_lshlrev_b32 v47, 3, v47
  v_lshl_add_u32 v47, v45, 8, v47
  v_add_u32 v47, s33, v47
  s_lshl_b32 s39, s26, 2
  s_xor_b32 s39, s39, 0
  s_lshl_b32 s39, s39, 1
  v_xor_b32 v44, s39, v46
  v_lshl_add_u32 v14, v44, 4, v47
  s_lshl_b32 s39, s26, 2
  s_xor_b32 s39, s39, 1
  s_lshl_b32 s39, s39, 1
  v_xor_b32 v44, s39, v46
  v_lshl_add_u32 v15, v44, 4, v47
  s_lshl_b32 s39, s26, 2
  s_xor_b32 s39, s39, 2
  s_lshl_b32 s39, s39, 1
  v_xor_b32 v44, s39, v46
  v_lshl_add_u32 v16, v44, 4, v47
  s_lshl_b32 s39, s26, 2
  s_xor_b32 s39, s39, 3
  s_lshl_b32 s39, s39, 1
  v_xor_b32 v44, s39, v46
  v_lshl_add_u32 v17, v44, 4, v47
  s_lshl_b32 s39, s26, 2
  s_xor_b32 s39, s39, 4
  s_lshl_b32 s39, s39, 1
  v_xor_b32 v44, s39, v46
  v_lshl_add_u32 v18, v44, 4, v47
  s_lshl_b32 s39, s26, 2
  s_xor_b32 s39, s39, 5
  s_lshl_b32 s39, s39, 1
  v_xor_b32 v44, s39, v46
  v_lshl_add_u32 v19, v44, 4, v47
  s_lshl_b32 s39, s26, 2
  s_xor_b32 s39, s39, 6
  s_lshl_b32 s39, s39, 1
  v_xor_b32 v44, s39, v46
  v_lshl_add_u32 v20, v44, 4, v47
  s_lshl_b32 s39, s26, 2
  s_xor_b32 s39, s39, 7
  s_lshl_b32 s39, s39, 1
  v_xor_b32 v44, s39, v46
  v_lshl_add_u32 v21, v44, 4, v47
  s_mul_i32 s39, s25, 0
  s_add_u32 s39, s39, 34816
  v_lshrrev_b32 v45, 1, v2
  v_add_u32 v44, 0, v3
  v_xor_b32 v44, v44, v45
  v_lshlrev_b32 v44, 4, v44
  v_lshl_add_u32 v44, v2, 7, v44
  v_add_u32 v36, s39, v44
  v_add_u32 v44, 4, v3
  v_xor_b32 v44, v44, v45
  v_lshlrev_b32 v44, 4, v44
  v_lshl_add_u32 v44, v2, 7, v44
  v_add_u32 v37, s39, v44
  s_mul_i32 s39, s25, 16384
  s_add_u32 s39, s39, 45056
  v_bfe_u32 v45, v1, 2, 2
  v_and_b32 v46, 1, v3
  v_lshl_or_b32 v46, v46, 2, v45
  v_lshlrev_b32 v46, 1, v46
  v_and_b32 v47, 3, v1
  v_xor_b32 v46, v46, v47
  v_lshl_add_u32 v45, v3, 3, v45
  v_lshlrev_b32 v47, 8, v45
  v_add_u32 v47, s39, v47
  s_lshl_b32 s39, s26, 3
  s_add_u32 s39, s39, 0
  v_xor_b32 v44, s39, v46
  v_lshl_add_u32 v38, v44, 4, v47
  s_lshl_b32 s39, s26, 3
  s_add_u32 s39, s39, 0
  v_xor_b32 v44, s39, v46
  v_lshl_add_u32 v39, v44, 4, v47
  v_add_u32 v39, 8, v39
  s_lshl_b32 s39, s26, 3
  s_add_u32 s39, s39, 4
  v_xor_b32 v44, s39, v46
  v_lshl_add_u32 v40, v44, 4, v47
  s_lshl_b32 s39, s26, 3
  s_add_u32 s39, s39, 4
  v_xor_b32 v44, s39, v46
  v_lshl_add_u32 v41, v44, 4, v47
  v_add_u32 v41, 8, v41
  v_mov_b32 v64, v36
  v_mov_b32 v65, v37
  v_mov_b32 v66, v38
  v_mov_b32 v67, v39
  v_mov_b32 v68, v40
  v_mov_b32 v69, v41
  v_add_u32 v70, 43008, v36
  v_add_u32 v71, 43008, v37
  v_add_u32 v72, 43008, v38
  v_add_u32 v73, 43008, v39
  v_add_u32 v74, 43008, v40
  v_add_u32 v75, 43008, v41
  v_add_u32 v76, 86016, v36
  v_add_u32 v77, 86016, v37
  v_add_u32 v78, 86016, v38
  v_add_u32 v79, 86016, v39
  v_add_u32 v80, 86016, v40
  v_add_u32 v81, 86016, v41
  s_branch L_concat_heads__gqa_block_cached__mha_block_cached__near_ridge_kernel_loopA
L_concat_heads__gqa_block_cached__mha_block_cached__near_ridge_kernel_qB:
  s_lshr_b32 s67, s38, 2
  s_add_u32 s67, s67, s38
  s_and_b32 s67, s67, 3
  s_mul_i32 s67, s67, 5
  s_lshr_b32 s67, s67, 1
  s_lshr_b32 s63, s38, 2
  s_lshl_b32 s39, s25, 2
  s_add_u32 s63, s63, s39
  s_and_b32 s38, s38, 3
  s_lshl_b32 s64, s37, 2
  s_add_u32 s64, s64, s38
  s_lshl_b32 s38, s63, 5
  s_add_u32 s38, s38, s64
  s_lshl_b32 s30, s38, 18
  s_lshl_b32 s39, s26, 13
  s_add_u32 s30, s30, s39
  s_mov_b32 s31, s30
  s_mul_i32 s36, s63, 655360
  s_lshl_b32 s39, s64, 12
  s_add_u32 s36, s36, s39
  s_lshl_b32 s39, s26, 11
  s_add_u32 s36, s36, s39
  s_add_u32 s36, s36, 5242880
  s_mul_i32 s34, s63, 92160
  s_mul_i32 s39, s26, 46080
  s_add_u32 s34, s34, s39
  s_mul_i32 s61, s24, 5120
  s_lshl_b32 s35, s64, 8
  s_lshl_b32 s39, s24, 17
  s_add_u32 s35, s35, s39
  s_lshl_b32 s62, s24, 12
  s_add_u32 s62, s62, 20480
  s_waitcnt lgkmcnt(0)
  s_mov_b32 s4, s50
  s_mov_b32 s5, s51
  s_mov_b32 s6, 737280
  s_mov_b32 s7, 0x00020000
  s_mov_b32 s8, s56
  s_mov_b32 s9, s57
  s_mov_b32 s10, 4718592
  s_mov_b32 s11, 0x00020000
  s_lshl_b32 s39, s67, 7
  s_add_u32 s68, s34, s39
  s_lshl_b32 s39, s67, 19
  s_add_u32 s69, s35, s39
  s_add_u32 s67, s67, 1
  s_cmp_eq_u32 s67, 9
  s_cselect_b32 s67, 0, s67
  s_add_u32 m0, s61, 34816
  s_nop 0
  buffer_load_dwordx4 v56, s[4:7], s68 offen offset:0 lds
  buffer_load_dwordx4 v57, s[4:7], s68 offen offset:1024 lds
  buffer_load_dwordx4 v58, s[4:7], s68 offen offset:2048 lds
  buffer_load_dwordx4 v59, s[4:7], s68 offen offset:3072 lds
  s_add_u32 m0, s61, 38912
  s_add_u32 s68, s68, 36864
  buffer_load_dwordx4 v56, s[4:7], s68 offen offset:0 lds
  s_add_u32 m0, s62, 34816
  s_nop 0
  buffer_load_dwordx4 v60, s[8:11], s69 offen offset:0 lds
  buffer_load_dwordx4 v61, s[8:11], s69 offen offset:1024 lds
  buffer_load_dwordx4 v62, s[8:11], s69 offen offset:2048 lds
  buffer_load_dwordx4 v63, s[8:11], s69 offen offset:3072 lds
  s_lshl_b32 s39, s67, 7
  s_add_u32 s68, s34, s39
  s_lshl_b32 s39, s67, 19
  s_add_u32 s69, s35, s39
  s_add_u32 s67, s67, 1
  s_cmp_eq_u32 s67, 9
  s_cselect_b32 s67, 0, s67
  s_add_u32 m0, s61, 77824
  s_nop 0
  buffer_load_dwordx4 v56, s[4:7], s68 offen offset:0 lds
  buffer_load_dwordx4 v57, s[4:7], s68 offen offset:1024 lds
  buffer_load_dwordx4 v58, s[4:7], s68 offen offset:2048 lds
  buffer_load_dwordx4 v59, s[4:7], s68 offen offset:3072 lds
  s_add_u32 m0, s61, 81920
  s_add_u32 s68, s68, 36864
  buffer_load_dwordx4 v56, s[4:7], s68 offen offset:0 lds
  s_add_u32 m0, s62, 77824
  s_nop 0
  buffer_load_dwordx4 v60, s[8:11], s69 offen offset:0 lds
  buffer_load_dwordx4 v61, s[8:11], s69 offen offset:1024 lds
  buffer_load_dwordx4 v62, s[8:11], s69 offen offset:2048 lds
  buffer_load_dwordx4 v63, s[8:11], s69 offen offset:3072 lds
  s_mov_b32 s12, s52
  s_mov_b32 s13, s53
  s_mov_b32 s14, 67108864
  s_mov_b32 s15, 0x00020000
  s_mov_b32 s16, s54
  s_mov_b32 s17, s55
  s_mov_b32 s18, 67108864
  s_mov_b32 s19, 0x00020000
  s_mov_b32 s20, s58
  s_mov_b32 s21, s59
  s_mov_b32 s22, 10485760
  s_mov_b32 s23, 0x00020000
  v_add_u32 v44, 0, v3
  v_xor_b32 v44, v44, v2
  v_lshlrev_b32 v44, 4, v44
  v_lshl_add_u32 v4, v3, 8, v44
  v_add_u32 v44, 4, v3
  v_xor_b32 v44, v44, v2
  v_lshlrev_b32 v44, 4, v44
  v_lshl_add_u32 v5, v3, 8, v44
  v_add_u32 v44, 8, v3
  v_xor_b32 v44, v44, v2
  v_lshlrev_b32 v44, 4, v44
  v_lshl_add_u32 v6, v3, 8, v44
  v_add_u32 v44, 12, v3
  v_xor_b32 v44, v44, v2
  v_lshlrev_b32 v44, 4, v44
  v_lshl_add_u32 v7, v3, 8, v44
  v_add_u32 v44, 0, v3
  v_lshlrev_b32 v44, 1, v44
  v_xor_b32 v44, v44, v2
  v_lshlrev_b32 v44, 4, v44
  v_lshl_add_u32 v8, v3, 8, v44
  v_add_u32 v44, 4, v3
  v_lshlrev_b32 v44, 1, v44
  v_xor_b32 v44, v44, v2
  v_lshlrev_b32 v44, 4, v44
  v_lshl_add_u32 v9, v3, 8, v44
  s_lshl_b32 s32, s24, 13
  s_add_u32 s33, s32, 65536
  s_lshl_b32 s39, s26, 1
  s_xor_b32 s39, s39, 0
  s_lshl_b32 s39, s39, 2
  v_add_u32 v44, s39, v3
  v_xor_b32 v44, v44, v2
  v_lshlrev_b32 v44, 4, v44
  v_lshl_add_u32 v44, v2, 8, v44
  v_add_u32 v10, s32, v44
  s_lshl_b32 s39, s26, 1
  s_xor_b32 s39, s39, 1
  s_lshl_b32 s39, s39, 2
  v_add_u32 v44, s39, v3
  v_xor_b32 v44, v44, v2
  v_lshlrev_b32 v44, 4, v44
  v_lshl_add_u32 v44, v2, 8, v44
  v_add_u32 v11, s32, v44
  s_lshl_b32 s39, s26, 1
  s_xor_b32 s39, s39, 2
  s_lshl_b32 s39, s39, 2
  v_add_u32 v44, s39, v3
  v_xor_b32 v44, v44, v2
  v_lshlrev_b32 v44, 4, v44
  v_lshl_add_u32 v44, v2, 8, v44
  v_add_u32 v12, s32, v44
  s_lshl_b32 s39, s26, 1
  s_xor_b32 s39, s39, 3
  s_lshl_b32 s39, s39, 2
  v_add_u32 v44, s39, v3
  v_xor_b32 v44, v44, v2
  v_lshlrev_b32 v44, 4, v44
  v_lshl_add_u32 v44, v2, 8, v44
  v_add_u32 v13, s32, v44
  v_bfe_u32 v45, v1, 2, 2
  v_lshl_add_u32 v45, v3, 2, v45
  v_and_b32 v46, 7, v45
  v_lshlrev_b32 v46, 1, v46
  v_bfe_u32 v47, v1, 1, 1
  v_xor_b32 v46, v46, v47
  v_and_b32 v47, 1, v1
  v_lshlrev_b32 v47, 3, v47
  v_lshl_add_u32 v47, v45, 8, v47
  v_add_u32 v47, s33, v47
  s_lshl_b32 s39, s26, 2
  s_xor_b32 s39, s39, 0
  s_lshl_b32 s39, s39, 1
  v_xor_b32 v44, s39, v46
  v_lshl_add_u32 v14, v44, 4, v47
  s_lshl_b32 s39, s26, 2
  s_xor_b32 s39, s39, 1
  s_lshl_b32 s39, s39, 1
  v_xor_b32 v44, s39, v46
  v_lshl_add_u32 v15, v44, 4, v47
  s_lshl_b32 s39, s26, 2
  s_xor_b32 s39, s39, 2
  s_lshl_b32 s39, s39, 1
  v_xor_b32 v44, s39, v46
  v_lshl_add_u32 v16, v44, 4, v47
  s_lshl_b32 s39, s26, 2
  s_xor_b32 s39, s39, 3
  s_lshl_b32 s39, s39, 1
  v_xor_b32 v44, s39, v46
  v_lshl_add_u32 v17, v44, 4, v47
  s_lshl_b32 s39, s26, 2
  s_xor_b32 s39, s39, 4
  s_lshl_b32 s39, s39, 1
  v_xor_b32 v44, s39, v46
  v_lshl_add_u32 v18, v44, 4, v47
  s_lshl_b32 s39, s26, 2
  s_xor_b32 s39, s39, 5
  s_lshl_b32 s39, s39, 1
  v_xor_b32 v44, s39, v46
  v_lshl_add_u32 v19, v44, 4, v47
  s_lshl_b32 s39, s26, 2
  s_xor_b32 s39, s39, 6
  s_lshl_b32 s39, s39, 1
  v_xor_b32 v44, s39, v46
  v_lshl_add_u32 v20, v44, 4, v47
  s_lshl_b32 s39, s26, 2
  s_xor_b32 s39, s39, 7
  s_lshl_b32 s39, s39, 1
  v_xor_b32 v44, s39, v46
  v_lshl_add_u32 v21, v44, 4, v47
  s_mul_i32 s39, s25, 10240
  s_add_u32 s39, s39, 34816
  v_lshrrev_b32 v45, 1, v2
  v_add_u32 v44, 0, v3
  v_xor_b32 v44, v44, v45
  v_lshlrev_b32 v44, 4, v44
  v_lshl_add_u32 v44, v2, 7, v44
  v_add_u32 v36, s39, v44
  v_add_u32 v44, 4, v3
  v_xor_b32 v44, v44, v45
  v_lshlrev_b32 v44, 4, v44
  v_lshl_add_u32 v44, v2, 7, v44
  v_add_u32 v37, s39, v44
  s_mul_i32 s39, s25, 0
  s_add_u32 s39, s39, 55296
  v_bfe_u32 v45, v1, 2, 2
  v_and_b32 v46, 1, v3
  v_lshl_or_b32 v46, v46, 2, v45
  v_lshlrev_b32 v46, 1, v46
  v_and_b32 v47, 3, v1
  v_xor_b32 v46, v46, v47
  v_lshl_add_u32 v45, v3, 3, v45
  v_lshlrev_b32 v47, 8, v45
  v_add_u32 v47, s39, v47
  s_lshl_b32 s39, s26, 3
  s_add_u32 s39, s39, 0
  v_xor_b32 v44, s39, v46
  v_lshl_add_u32 v38, v44, 4, v47
  s_lshl_b32 s39, s26, 3
  s_add_u32 s39, s39, 0
  v_xor_b32 v44, s39, v46
  v_lshl_add_u32 v39, v44, 4, v47
  v_add_u32 v39, 8, v39
  s_lshl_b32 s39, s26, 3
  s_add_u32 s39, s39, 4
  v_xor_b32 v44, s39, v46
  v_lshl_add_u32 v40, v44, 4, v47
  s_lshl_b32 s39, s26, 3
  s_add_u32 s39, s39, 4
  v_xor_b32 v44, s39, v46
  v_lshl_add_u32 v41, v44, 4, v47
  v_add_u32 v41, 8, v41
  v_mov_b32 v64, v36
  v_mov_b32 v65, v37
  v_mov_b32 v66, v38
  v_mov_b32 v67, v39
  v_mov_b32 v68, v40
  v_mov_b32 v69, v41
  v_add_u32 v70, 43008, v36
  v_add_u32 v71, 43008, v37
  v_add_u32 v72, 43008, v38
  v_add_u32 v73, 43008, v39
  v_add_u32 v74, 43008, v40
  v_add_u32 v75, 43008, v41
  v_add_u32 v76, 86016, v36
  v_add_u32 v77, 86016, v37
  v_add_u32 v78, 86016, v38
  v_add_u32 v79, 86016, v39
  v_add_u32 v80, 86016, v40
  v_add_u32 v81, 86016, v41
  s_waitcnt vmcnt(9)
  s_barrier
  ds_read_b64_tr_b16 a[188:189], v66 offset:0
  ds_read_b64_tr_b16 a[190:191], v66 offset:1024
  ds_read_b128 a[168:171], v64 offset:0
  ds_read_b128 a[172:175], v64 offset:2048
  ds_read_b128 a[176:179], v64 offset:4096
  ds_read_b128 a[180:183], v64 offset:6144
  ds_read_b128 a[184:187], v64 offset:8192
  ds_read_b64_tr_b16 a[192:193], v67 offset:0
  ds_read_b64_tr_b16 a[194:195], v67 offset:1024
  ds_read_b64_tr_b16 a[196:197], v68 offset:0
  ds_read_b64_tr_b16 a[198:199], v68 offset:1024
  ds_read_b64_tr_b16 a[200:201], v69 offset:0
  ds_read_b64_tr_b16 a[202:203], v69 offset:1024
  s_lshl_b32 s39, s67, 7
  s_add_u32 s68, s34, s39
  s_lshl_b32 s39, s67, 19
  s_add_u32 s69, s35, s39
  s_add_u32 s67, s67, 1
  s_cmp_eq_u32 s67, 9
  s_cselect_b32 s67, 0, s67
  s_add_u32 m0, s61, 120832
  s_nop 0
  buffer_load_dwordx4 v56, s[4:7], s68 offen offset:0 lds
  buffer_load_dwordx4 v57, s[4:7], s68 offen offset:1024 lds
  buffer_load_dwordx4 v58, s[4:7], s68 offen offset:2048 lds
  buffer_load_dwordx4 v59, s[4:7], s68 offen offset:3072 lds
  s_waitcnt lgkmcnt(0)
  v_mfma_f32_16x16x32_bf16 v[96:99], a[188:191], a[168:171], 0
  ds_read_b64_tr_b16 a[224:225], v66 offset:8192
  v_mfma_f32_16x16x32_bf16 v[100:103], a[188:191], a[172:175], 0
  ds_read_b64_tr_b16 a[226:227], v66 offset:9216
  s_add_u32 m0, s61, 124928
  s_add_u32 s68, s68, 36864
  buffer_load_dwordx4 v56, s[4:7], s68 offen offset:0 lds
  v_mfma_f32_16x16x32_bf16 v[104:107], a[188:191], a[176:179], 0
  ds_read_b128 a[204:207], v65 offset:0
  v_mfma_f32_16x16x32_bf16 v[108:111], a[188:191], a[180:183], 0
  ds_read_b128 a[208:211], v65 offset:2048
  v_mfma_f32_16x16x32_bf16 v[112:115], a[188:191], a[184:187], 0
  ds_read_b128 a[212:215], v65 offset:4096
  s_add_u32 m0, s62, 120832
  s_nop 0
  buffer_load_dwordx4 v60, s[8:11], s69 offen offset:0 lds
  v_mfma_f32_16x16x32_bf16 v[116:119], a[192:195], a[168:171], 0
  ds_read_b128 a[216:219], v65 offset:6144
  v_mfma_f32_16x16x32_bf16 v[120:123], a[192:195], a[172:175], 0
  ds_read_b128 a[220:223], v65 offset:8192
  v_mfma_f32_16x16x32_bf16 v[124:127], a[192:195], a[176:179], 0
  ds_read_b64_tr_b16 a[228:229], v67 offset:8192
  v_mfma_f32_16x16x32_bf16 v[128:131], a[192:195], a[180:183], 0
  ds_read_b64_tr_b16 a[230:231], v67 offset:9216
  buffer_load_dwordx4 v61, s[8:11], s69 offen offset:1024 lds
  v_mfma_f32_16x16x32_bf16 v[132:135], a[192:195], a[184:187], 0
  ds_read_b64_tr_b16 a[232:233], v68 offset:8192
  v_mfma_f32_16x16x32_bf16 v[136:139], a[196:199], a[168:171], 0
  ds_read_b64_tr_b16 a[234:235], v68 offset:9216
  v_mfma_f32_16x16x32_bf16 v[140:143], a[196:199], a[172:175], 0
  ds_read_b64_tr_b16 a[236:237], v69 offset:8192
  buffer_load_dwordx4 v62, s[8:11], s69 offen offset:2048 lds
  v_mfma_f32_16x16x32_bf16 v[144:147], a[196:199], a[176:179], 0
  ds_read_b64_tr_b16 a[238:239], v69 offset:9216
  v_mfma_f32_16x16x32_bf16 v[148:151], a[196:199], a[180:183], 0
  v_mfma_f32_16x16x32_bf16 v[152:155], a[196:199], a[184:187], 0
  v_mfma_f32_16x16x32_bf16 v[156:159], a[200:203], a[168:171], 0
  buffer_load_dwordx4 v63, s[8:11], s69 offen offset:3072 lds
  v_mfma_f32_16x16x32_bf16 v[160:163], a[200:203], a[172:175], 0
  v_mfma_f32_16x16x32_bf16 v[164:167], a[200:203], a[176:179], 0
  v_mfma_f32_16x16x32_bf16 v[168:171], a[200:203], a[180:183], 0
  v_mfma_f32_16x16x32_bf16 v[172:175], a[200:203], a[184:187], 0
  s_waitcnt vmcnt(9)
  s_waitcnt lgkmcnt(0)
  s_barrier
  v_mfma_f32_16x16x32_bf16 v[96:99], a[224:227], a[204:207], v[96:99]
  ds_read_b64_tr_b16 a[188:189], v72 offset:0
  v_mfma_f32_16x16x32_bf16 v[100:103], a[224:227], a[208:211], v[100:103]
  ds_read_b64_tr_b16 a[190:191], v72 offset:1024
  s_lshl_b32 s39, s67, 7
  s_add_u32 s68, s34, s39
  s_lshl_b32 s39, s67, 19
  s_add_u32 s69, s35, s39
  s_add_u32 s67, s67, 1
  s_cmp_eq_u32 s67, 9
  s_cselect_b32 s67, 0, s67
  v_mfma_f32_16x16x32_bf16 v[104:107], a[224:227], a[212:215], v[104:107]
  ds_read_b128 a[168:171], v70 offset:0
  v_mfma_f32_16x16x32_bf16 v[108:111], a[224:227], a[216:219], v[108:111]
  ds_read_b128 a[172:175], v70 offset:2048
  v_mfma_f32_16x16x32_bf16 v[112:115], a[224:227], a[220:223], v[112:115]
  ds_read_b128 a[176:179], v70 offset:4096
  s_add_u32 m0, s61, 34816
  s_nop 0
  buffer_load_dwordx4 v56, s[4:7], s68 offen offset:0 lds
  v_mfma_f32_16x16x32_bf16 v[116:119], a[228:231], a[204:207], v[116:119]
  ds_read_b128 a[180:183], v70 offset:6144
  v_mfma_f32_16x16x32_bf16 v[120:123], a[228:231], a[208:211], v[120:123]
  ds_read_b128 a[184:187], v70 offset:8192
  v_mfma_f32_16x16x32_bf16 v[124:127], a[228:231], a[212:215], v[124:127]
  ds_read_b64_tr_b16 a[192:193], v73 offset:0
  v_mfma_f32_16x16x32_bf16 v[128:131], a[228:231], a[216:219], v[128:131]
  ds_read_b64_tr_b16 a[194:195], v73 offset:1024
  buffer_load_dwordx4 v57, s[4:7], s68 offen offset:1024 lds
  v_mfma_f32_16x16x32_bf16 v[132:135], a[228:231], a[220:223], v[132:135]
  ds_read_b64_tr_b16 a[196:197], v74 offset:0
  v_mfma_f32_16x16x32_bf16 v[136:139], a[232:235], a[204:207], v[136:139]
  ds_read_b64_tr_b16 a[198:199], v74 offset:1024
  v_mfma_f32_16x16x32_bf16 v[140:143], a[232:235], a[208:211], v[140:143]
  ds_read_b64_tr_b16 a[200:201], v75 offset:0
  buffer_load_dwordx4 v58, s[4:7], s68 offen offset:2048 lds
  v_mfma_f32_16x16x32_bf16 v[144:147], a[232:235], a[212:215], v[144:147]
  ds_read_b64_tr_b16 a[202:203], v75 offset:1024
  v_mfma_f32_16x16x32_bf16 v[148:151], a[232:235], a[216:219], v[148:151]
  v_mfma_f32_16x16x32_bf16 v[152:155], a[232:235], a[220:223], v[152:155]
  v_mfma_f32_16x16x32_bf16 v[156:159], a[236:239], a[204:207], v[156:159]
  buffer_load_dwordx4 v59, s[4:7], s68 offen offset:3072 lds
  v_mfma_f32_16x16x32_bf16 v[160:163], a[236:239], a[208:211], v[160:163]
  v_mfma_f32_16x16x32_bf16 v[164:167], a[236:239], a[212:215], v[164:167]
  v_mfma_f32_16x16x32_bf16 v[168:171], a[236:239], a[216:219], v[168:171]
  v_mfma_f32_16x16x32_bf16 v[172:175], a[236:239], a[220:223], v[172:175]
  s_waitcnt lgkmcnt(0)
  v_mfma_f32_16x16x32_bf16 v[96:99], a[188:191], a[168:171], v[96:99]
  ds_read_b64_tr_b16 a[224:225], v72 offset:8192
  v_mfma_f32_16x16x32_bf16 v[100:103], a[188:191], a[172:175], v[100:103]
  ds_read_b64_tr_b16 a[226:227], v72 offset:9216
  s_add_u32 m0, s61, 38912
  s_add_u32 s68, s68, 36864
  buffer_load_dwordx4 v56, s[4:7], s68 offen offset:0 lds
  v_mfma_f32_16x16x32_bf16 v[104:107], a[188:191], a[176:179], v[104:107]
  ds_read_b128 a[204:207], v71 offset:0
  v_mfma_f32_16x16x32_bf16 v[108:111], a[188:191], a[180:183], v[108:111]
  ds_read_b128 a[208:211], v71 offset:2048
  v_mfma_f32_16x16x32_bf16 v[112:115], a[188:191], a[184:187], v[112:115]
  ds_read_b128 a[212:215], v71 offset:4096
  s_add_u32 m0, s62, 34816
  s_nop 0
  buffer_load_dwordx4 v60, s[8:11], s69 offen offset:0 lds
  v_mfma_f32_16x16x32_bf16 v[116:119], a[192:195], a[168:171], v[116:119]
  ds_read_b128 a[216:219], v71 offset:6144
  v_mfma_f32_16x16x32_bf16 v[120:123], a[192:195], a[172:175], v[120:123]
  ds_read_b128 a[220:223], v71 offset:8192
  v_mfma_f32_16x16x32_bf16 v[124:127], a[192:195], a[176:179], v[124:127]
  ds_read_b64_tr_b16 a[228:229], v73 offset:8192
  v_mfma_f32_16x16x32_bf16 v[128:131], a[192:195], a[180:183], v[128:131]
  ds_read_b64_tr_b16 a[230:231], v73 offset:9216
  buffer_load_dwordx4 v61, s[8:11], s69 offen offset:1024 lds
  v_mfma_f32_16x16x32_bf16 v[132:135], a[192:195], a[184:187], v[132:135]
  ds_read_b64_tr_b16 a[232:233], v74 offset:8192
  v_mfma_f32_16x16x32_bf16 v[136:139], a[196:199], a[168:171], v[136:139]
  ds_read_b64_tr_b16 a[234:235], v74 offset:9216
  v_mfma_f32_16x16x32_bf16 v[140:143], a[196:199], a[172:175], v[140:143]
  ds_read_b64_tr_b16 a[236:237], v75 offset:8192
  buffer_load_dwordx4 v62, s[8:11], s69 offen offset:2048 lds
  v_mfma_f32_16x16x32_bf16 v[144:147], a[196:199], a[176:179], v[144:147]
  ds_read_b64_tr_b16 a[238:239], v75 offset:9216
  v_mfma_f32_16x16x32_bf16 v[148:151], a[196:199], a[180:183], v[148:151]
  v_mfma_f32_16x16x32_bf16 v[152:155], a[196:199], a[184:187], v[152:155]
  v_mfma_f32_16x16x32_bf16 v[156:159], a[200:203], a[168:171], v[156:159]
  buffer_load_dwordx4 v63, s[8:11], s69 offen offset:3072 lds
  v_mfma_f32_16x16x32_bf16 v[160:163], a[200:203], a[172:175], v[160:163]
  v_mfma_f32_16x16x32_bf16 v[164:167], a[200:203], a[176:179], v[164:167]
  v_mfma_f32_16x16x32_bf16 v[168:171], a[200:203], a[180:183], v[168:171]
  v_mfma_f32_16x16x32_bf16 v[172:175], a[200:203], a[184:187], v[172:175]
  s_waitcnt vmcnt(9)
  s_waitcnt lgkmcnt(0)
  s_barrier
  v_mfma_f32_16x16x32_bf16 v[96:99], a[224:227], a[204:207], v[96:99]
  ds_read_b64_tr_b16 a[188:189], v78 offset:0
  v_mfma_f32_16x16x32_bf16 v[100:103], a[224:227], a[208:211], v[100:103]
  ds_read_b64_tr_b16 a[190:191], v78 offset:1024
  s_lshl_b32 s39, s67, 7
  s_add_u32 s68, s34, s39
  s_lshl_b32 s39, s67, 19
  s_add_u32 s69, s35, s39
  s_add_u32 s67, s67, 1
  s_cmp_eq_u32 s67, 9
  s_cselect_b32 s67, 0, s67
  v_mfma_f32_16x16x32_bf16 v[104:107], a[224:227], a[212:215], v[104:107]
  ds_read_b128 a[168:171], v76 offset:0
  v_mfma_f32_16x16x32_bf16 v[108:111], a[224:227], a[216:219], v[108:111]
  ds_read_b128 a[172:175], v76 offset:2048
  s_add_u32 m0, s61, 77824
  s_nop 0
  buffer_load_dwordx4 v56, s[4:7], s68 offen offset:0 lds
  v_mfma_f32_16x16x32_bf16 v[112:115], a[224:227], a[220:223], v[112:115]
  ds_read_b128 a[176:179], v76 offset:4096
  v_mfma_f32_16x16x32_bf16 v[116:119], a[228:231], a[204:207], v[116:119]
  ds_read_b128 a[180:183], v76 offset:6144
  buffer_load_dwordx4 v57, s[4:7], s68 offen offset:1024 lds
  v_mfma_f32_16x16x32_bf16 v[120:123], a[228:231], a[208:211], v[120:123]
  ds_read_b128 a[184:187], v76 offset:8192
  v_mfma_f32_16x16x32_bf16 v[124:127], a[228:231], a[212:215], v[124:127]
  ds_read_b64_tr_b16 a[192:193], v79 offset:0
  buffer_load_dwordx4 v58, s[4:7], s68 offen offset:2048 lds
  v_mfma_f32_16x16x32_bf16 v[128:131], a[228:231], a[216:219], v[128:131]
  ds_read_b64_tr_b16 a[194:195], v79 offset:1024
  v_mfma_f32_16x16x32_bf16 v[132:135], a[228:231], a[220:223], v[132:135]
  ds_read_b64_tr_b16 a[196:197], v80 offset:0
  buffer_load_dwordx4 v59, s[4:7], s68 offen offset:3072 lds
  v_mfma_f32_16x16x32_bf16 v[136:139], a[232:235], a[204:207], v[136:139]
  ds_read_b64_tr_b16 a[198:199], v80 offset:1024
  v_mfma_f32_16x16x32_bf16 v[140:143], a[232:235], a[208:211], v[140:143]
  ds_read_b64_tr_b16 a[200:201], v81 offset:0
  s_add_u32 m0, s61, 81920
  s_add_u32 s68, s68, 36864
  buffer_load_dwordx4 v56, s[4:7], s68 offen offset:0 lds
  v_mfma_f32_16x16x32_bf16 v[144:147], a[232:235], a[212:215], v[144:147]
  ds_read_b64_tr_b16 a[202:203], v81 offset:1024
  v_mfma_f32_16x16x32_bf16 v[148:151], a[232:235], a[216:219], v[148:151]
  s_add_u32 m0, s62, 77824
  s_nop 0
  buffer_load_dwordx4 v60, s[8:11], s69 offen offset:0 lds
  v_mfma_f32_16x16x32_bf16 v[152:155], a[232:235], a[220:223], v[152:155]
  v_mfma_f32_16x16x32_bf16 v[156:159], a[236:239], a[204:207], v[156:159]
  buffer_load_dwordx4 v61, s[8:11], s69 offen offset:1024 lds
  v_mfma_f32_16x16x32_bf16 v[160:163], a[236:239], a[208:211], v[160:163]
  v_mfma_f32_16x16x32_bf16 v[164:167], a[236:239], a[212:215], v[164:167]
  buffer_load_dwordx4 v62, s[8:11], s69 offen offset:2048 lds
  v_mfma_f32_16x16x32_bf16 v[168:171], a[236:239], a[216:219], v[168:171]
  v_mfma_f32_16x16x32_bf16 v[172:175], a[236:239], a[220:223], v[172:175]
  s_waitcnt lgkmcnt(0)
  v_mfma_f32_16x16x32_bf16 v[96:99], a[188:191], a[168:171], v[96:99]
  ds_read_b64_tr_b16 a[224:225], v78 offset:8192
  v_mfma_f32_16x16x32_bf16 v[100:103], a[188:191], a[172:175], v[100:103]
  ds_read_b64_tr_b16 a[226:227], v78 offset:9216
  buffer_load_dwordx4 v63, s[8:11], s69 offen offset:3072 lds
  v_mfma_f32_16x16x32_bf16 v[104:107], a[188:191], a[176:179], v[104:107]
  ds_read_b128 a[204:207], v77 offset:0
  v_mfma_f32_16x16x32_bf16 v[108:111], a[188:191], a[180:183], v[108:111]
  ds_read_b128 a[208:211], v77 offset:2048
  s_add_u32 m0, s32, 0
  s_add_u32 s96, s30, 4096
  buffer_load_dwordx4 v4, s[12:15], s30 offen offset:0 nt lds
  v_mfma_f32_16x16x32_bf16 v[112:115], a[188:191], a[184:187], v[112:115]
  ds_read_b128 a[212:215], v77 offset:4096
  v_mfma_f32_16x16x32_bf16 v[116:119], a[192:195], a[168:171], v[116:119]
  ds_read_b128 a[216:219], v77 offset:6144
  buffer_load_dwordx4 v5, s[12:15], s30 offen offset:1024 nt lds
  v_mfma_f32_16x16x32_bf16 v[120:123], a[192:195], a[172:175], v[120:123]
  ds_read_b128 a[220:223], v77 offset:8192
  v_mfma_f32_16x16x32_bf16 v[124:127], a[192:195], a[176:179], v[124:127]
  ds_read_b64_tr_b16 a[228:229], v79 offset:8192
  buffer_load_dwordx4 v6, s[12:15], s30 offen offset:2048 nt lds
  v_mfma_f32_16x16x32_bf16 v[128:131], a[192:195], a[180:183], v[128:131]
  ds_read_b64_tr_b16 a[230:231], v79 offset:9216
  v_mfma_f32_16x16x32_bf16 v[132:135], a[192:195], a[184:187], v[132:135]
  ds_read_b64_tr_b16 a[232:233], v80 offset:8192
  buffer_load_dwordx4 v7, s[12:15], s30 offen offset:3072 nt lds
  v_mfma_f32_16x16x32_bf16 v[136:139], a[196:199], a[168:171], v[136:139]
  ds_read_b64_tr_b16 a[234:235], v80 offset:9216
  v_mfma_f32_16x16x32_bf16 v[140:143], a[196:199], a[172:175], v[140:143]
  ds_read_b64_tr_b16 a[236:237], v81 offset:8192
  s_add_u32 m0, s32, 4096
  s_add_u32 s30, s30, 16384
  buffer_load_dwordx4 v4, s[12:15], s96 offen offset:0 nt lds
  v_mfma_f32_16x16x32_bf16 v[144:147], a[196:199], a[176:179], v[144:147]
  ds_read_b64_tr_b16 a[238:239], v81 offset:9216
  v_mfma_f32_16x16x32_bf16 v[148:151], a[196:199], a[180:183], v[148:151]
  buffer_load_dwordx4 v5, s[12:15], s96 offen offset:1024 nt lds
  v_mfma_f32_16x16x32_bf16 v[152:155], a[196:199], a[184:187], v[152:155]
  v_mfma_f32_16x16x32_bf16 v[156:159], a[200:203], a[168:171], v[156:159]
  buffer_load_dwordx4 v6, s[12:15], s96 offen offset:2048 nt lds
  v_mfma_f32_16x16x32_bf16 v[160:163], a[200:203], a[172:175], v[160:163]
  v_mfma_f32_16x16x32_bf16 v[164:167], a[200:203], a[176:179], v[164:167]
  buffer_load_dwordx4 v7, s[12:15], s96 offen offset:3072 nt lds
  v_mfma_f32_16x16x32_bf16 v[168:171], a[200:203], a[180:183], v[168:171]
  v_mfma_f32_16x16x32_bf16 v[172:175], a[200:203], a[184:187], v[172:175]
  s_waitcnt vmcnt(17)
  s_waitcnt lgkmcnt(0)
  s_barrier
  v_mfma_f32_16x16x32_bf16 v[96:99], a[224:227], a[204:207], v[96:99]
  ds_read_b64_tr_b16 a[188:189], v66 offset:0
  v_mfma_f32_16x16x32_bf16 v[100:103], a[224:227], a[208:211], v[100:103]
  ds_read_b64_tr_b16 a[190:191], v66 offset:1024
  s_lshl_b32 s39, s67, 7
  s_add_u32 s68, s34, s39
  s_lshl_b32 s39, s67, 19
  s_add_u32 s69, s35, s39
  s_add_u32 s67, s67, 1
  s_cmp_eq_u32 s67, 9
  s_cselect_b32 s67, 0, s67
  v_mfma_f32_16x16x32_bf16 v[104:107], a[224:227], a[212:215], v[104:107]
  ds_read_b128 a[168:171], v64 offset:0
  v_mfma_f32_16x16x32_bf16 v[108:111], a[224:227], a[216:219], v[108:111]
  ds_read_b128 a[172:175], v64 offset:2048
  v_mfma_f32_16x16x32_bf16 v[112:115], a[224:227], a[220:223], v[112:115]
  ds_read_b128 a[176:179], v64 offset:4096
  s_add_u32 m0, s61, 120832
  s_nop 0
  buffer_load_dwordx4 v56, s[4:7], s68 offen offset:0 lds
  v_mfma_f32_16x16x32_bf16 v[116:119], a[228:231], a[204:207], v[116:119]
  ds_read_b128 a[180:183], v64 offset:6144
  v_mfma_f32_16x16x32_bf16 v[120:123], a[228:231], a[208:211], v[120:123]
  ds_read_b128 a[184:187], v64 offset:8192
  v_mfma_f32_16x16x32_bf16 v[124:127], a[228:231], a[212:215], v[124:127]
  ds_read_b64_tr_b16 a[192:193], v67 offset:0
  v_mfma_f32_16x16x32_bf16 v[128:131], a[228:231], a[216:219], v[128:131]
  ds_read_b64_tr_b16 a[194:195], v67 offset:1024
  buffer_load_dwordx4 v57, s[4:7], s68 offen offset:1024 lds
  v_mfma_f32_16x16x32_bf16 v[132:135], a[228:231], a[220:223], v[132:135]
  ds_read_b64_tr_b16 a[196:197], v68 offset:0
  v_mfma_f32_16x16x32_bf16 v[136:139], a[232:235], a[204:207], v[136:139]
  ds_read_b64_tr_b16 a[198:199], v68 offset:1024
  v_mfma_f32_16x16x32_bf16 v[140:143], a[232:235], a[208:211], v[140:143]
  ds_read_b64_tr_b16 a[200:201], v69 offset:0
  buffer_load_dwordx4 v58, s[4:7], s68 offen offset:2048 lds
  v_mfma_f32_16x16x32_bf16 v[144:147], a[232:235], a[212:215], v[144:147]
  ds_read_b64_tr_b16 a[202:203], v69 offset:1024
  v_mfma_f32_16x16x32_bf16 v[148:151], a[232:235], a[216:219], v[148:151]
  v_mfma_f32_16x16x32_bf16 v[152:155], a[232:235], a[220:223], v[152:155]
  v_mfma_f32_16x16x32_bf16 v[156:159], a[236:239], a[204:207], v[156:159]
  buffer_load_dwordx4 v59, s[4:7], s68 offen offset:3072 lds
  v_mfma_f32_16x16x32_bf16 v[160:163], a[236:239], a[208:211], v[160:163]
  v_mfma_f32_16x16x32_bf16 v[164:167], a[236:239], a[212:215], v[164:167]
  v_mfma_f32_16x16x32_bf16 v[168:171], a[236:239], a[216:219], v[168:171]
  v_mfma_f32_16x16x32_bf16 v[172:175], a[236:239], a[220:223], v[172:175]
  s_waitcnt lgkmcnt(0)
  v_mfma_f32_16x16x32_bf16 v[96:99], a[188:191], a[168:171], v[96:99]
  ds_read_b64_tr_b16 a[224:225], v66 offset:8192
  v_mfma_f32_16x16x32_bf16 v[100:103], a[188:191], a[172:175], v[100:103]
  ds_read_b64_tr_b16 a[226:227], v66 offset:9216
  s_add_u32 m0, s61, 124928
  s_add_u32 s68, s68, 36864
  buffer_load_dwordx4 v56, s[4:7], s68 offen offset:0 lds
  v_mfma_f32_16x16x32_bf16 v[104:107], a[188:191], a[176:179], v[104:107]
  ds_read_b128 a[204:207], v65 offset:0
  v_mfma_f32_16x16x32_bf16 v[108:111], a[188:191], a[180:183], v[108:111]
  ds_read_b128 a[208:211], v65 offset:2048
  v_mfma_f32_16x16x32_bf16 v[112:115], a[188:191], a[184:187], v[112:115]
  ds_read_b128 a[212:215], v65 offset:4096
  s_add_u32 m0, s62, 120832
  s_nop 0
  buffer_load_dwordx4 v60, s[8:11], s69 offen offset:0 lds
  v_mfma_f32_16x16x32_bf16 v[116:119], a[192:195], a[168:171], v[116:119]
  ds_read_b128 a[216:219], v65 offset:6144
  v_mfma_f32_16x16x32_bf16 v[120:123], a[192:195], a[172:175], v[120:123]
  ds_read_b128 a[220:223], v65 offset:8192
  v_mfma_f32_16x16x32_bf16 v[124:127], a[192:195], a[176:179], v[124:127]
  ds_read_b64_tr_b16 a[228:229], v67 offset:8192
  v_mfma_f32_16x16x32_bf16 v[128:131], a[192:195], a[180:183], v[128:131]
  ds_read_b64_tr_b16 a[230:231], v67 offset:9216
  buffer_load_dwordx4 v61, s[8:11], s69 offen offset:1024 lds
  v_mfma_f32_16x16x32_bf16 v[132:135], a[192:195], a[184:187], v[132:135]
  ds_read_b64_tr_b16 a[232:233], v68 offset:8192
  v_mfma_f32_16x16x32_bf16 v[136:139], a[196:199], a[168:171], v[136:139]
  ds_read_b64_tr_b16 a[234:235], v68 offset:9216
  v_mfma_f32_16x16x32_bf16 v[140:143], a[196:199], a[172:175], v[140:143]
  ds_read_b64_tr_b16 a[236:237], v69 offset:8192
  buffer_load_dwordx4 v62, s[8:11], s69 offen offset:2048 lds
  v_mfma_f32_16x16x32_bf16 v[144:147], a[196:199], a[176:179], v[144:147]
  ds_read_b64_tr_b16 a[238:239], v69 offset:9216
  v_mfma_f32_16x16x32_bf16 v[148:151], a[196:199], a[180:183], v[148:151]
  v_mfma_f32_16x16x32_bf16 v[152:155], a[196:199], a[184:187], v[152:155]
  v_mfma_f32_16x16x32_bf16 v[156:159], a[200:203], a[168:171], v[156:159]
  buffer_load_dwordx4 v63, s[8:11], s69 offen offset:3072 lds
  v_mfma_f32_16x16x32_bf16 v[160:163], a[200:203], a[172:175], v[160:163]
  v_mfma_f32_16x16x32_bf16 v[164:167], a[200:203], a[176:179], v[164:167]
  v_mfma_f32_16x16x32_bf16 v[168:171], a[200:203], a[180:183], v[168:171]
  v_mfma_f32_16x16x32_bf16 v[172:175], a[200:203], a[184:187], v[172:175]
  s_waitcnt vmcnt(17)
  s_waitcnt lgkmcnt(0)
  s_barrier
  v_mfma_f32_16x16x32_bf16 v[96:99], a[224:227], a[204:207], v[96:99]
  ds_read_b64_tr_b16 a[188:189], v72 offset:0
  v_mfma_f32_16x16x32_bf16 v[100:103], a[224:227], a[208:211], v[100:103]
  ds_read_b64_tr_b16 a[190:191], v72 offset:1024
  s_lshl_b32 s39, s67, 7
  s_add_u32 s68, s34, s39
  s_lshl_b32 s39, s67, 19
  s_add_u32 s69, s35, s39
  s_add_u32 s67, s67, 1
  s_cmp_eq_u32 s67, 9
  s_cselect_b32 s67, 0, s67
  v_mfma_f32_16x16x32_bf16 v[104:107], a[224:227], a[212:215], v[104:107]
  ds_read_b128 a[168:171], v70 offset:0
  v_mfma_f32_16x16x32_bf16 v[108:111], a[224:227], a[216:219], v[108:111]
  ds_read_b128 a[172:175], v70 offset:2048
  v_mfma_f32_16x16x32_bf16 v[112:115], a[224:227], a[220:223], v[112:115]
  ds_read_b128 a[176:179], v70 offset:4096
  s_add_u32 m0, s61, 34816
  s_nop 0
  buffer_load_dwordx4 v56, s[4:7], s68 offen offset:0 lds
  v_mfma_f32_16x16x32_bf16 v[116:119], a[228:231], a[204:207], v[116:119]
  ds_read_b128 a[180:183], v70 offset:6144
  v_mfma_f32_16x16x32_bf16 v[120:123], a[228:231], a[208:211], v[120:123]
  ds_read_b128 a[184:187], v70 offset:8192
  v_mfma_f32_16x16x32_bf16 v[124:127], a[228:231], a[212:215], v[124:127]
  ds_read_b64_tr_b16 a[192:193], v73 offset:0
  v_mfma_f32_16x16x32_bf16 v[128:131], a[228:231], a[216:219], v[128:131]
  ds_read_b64_tr_b16 a[194:195], v73 offset:1024
  buffer_load_dwordx4 v57, s[4:7], s68 offen offset:1024 lds
  v_mfma_f32_16x16x32_bf16 v[132:135], a[228:231], a[220:223], v[132:135]
  ds_read_b64_tr_b16 a[196:197], v74 offset:0
  v_mfma_f32_16x16x32_bf16 v[136:139], a[232:235], a[204:207], v[136:139]
  ds_read_b64_tr_b16 a[198:199], v74 offset:1024
  v_mfma_f32_16x16x32_bf16 v[140:143], a[232:235], a[208:211], v[140:143]
  ds_read_b64_tr_b16 a[200:201], v75 offset:0
  buffer_load_dwordx4 v58, s[4:7], s68 offen offset:2048 lds
  v_mfma_f32_16x16x32_bf16 v[144:147], a[232:235], a[212:215], v[144:147]
  ds_read_b64_tr_b16 a[202:203], v75 offset:1024
  v_mfma_f32_16x16x32_bf16 v[148:151], a[232:235], a[216:219], v[148:151]
  v_mfma_f32_16x16x32_bf16 v[152:155], a[232:235], a[220:223], v[152:155]
  v_mfma_f32_16x16x32_bf16 v[156:159], a[236:239], a[204:207], v[156:159]
  buffer_load_dwordx4 v59, s[4:7], s68 offen offset:3072 lds
  v_mfma_f32_16x16x32_bf16 v[160:163], a[236:239], a[208:211], v[160:163]
  v_mfma_f32_16x16x32_bf16 v[164:167], a[236:239], a[212:215], v[164:167]
  v_mfma_f32_16x16x32_bf16 v[168:171], a[236:239], a[216:219], v[168:171]
  v_mfma_f32_16x16x32_bf16 v[172:175], a[236:239], a[220:223], v[172:175]
  s_waitcnt lgkmcnt(0)
  v_mfma_f32_16x16x32_bf16 v[96:99], a[188:191], a[168:171], v[96:99]
  ds_read_b64_tr_b16 a[224:225], v72 offset:8192
  v_mfma_f32_16x16x32_bf16 v[100:103], a[188:191], a[172:175], v[100:103]
  ds_read_b64_tr_b16 a[226:227], v72 offset:9216
  s_add_u32 m0, s61, 38912
  s_add_u32 s68, s68, 36864
  buffer_load_dwordx4 v56, s[4:7], s68 offen offset:0 lds
  v_mfma_f32_16x16x32_bf16 v[104:107], a[188:191], a[176:179], v[104:107]
  ds_read_b128 a[204:207], v71 offset:0
  v_mfma_f32_16x16x32_bf16 v[108:111], a[188:191], a[180:183], v[108:111]
  ds_read_b128 a[208:211], v71 offset:2048
  v_mfma_f32_16x16x32_bf16 v[112:115], a[188:191], a[184:187], v[112:115]
  ds_read_b128 a[212:215], v71 offset:4096
  s_add_u32 m0, s62, 34816
  s_nop 0
  buffer_load_dwordx4 v60, s[8:11], s69 offen offset:0 lds
  v_mfma_f32_16x16x32_bf16 v[116:119], a[192:195], a[168:171], v[116:119]
  ds_read_b128 a[216:219], v71 offset:6144
  v_mfma_f32_16x16x32_bf16 v[120:123], a[192:195], a[172:175], v[120:123]
  ds_read_b128 a[220:223], v71 offset:8192
  v_mfma_f32_16x16x32_bf16 v[124:127], a[192:195], a[176:179], v[124:127]
  ds_read_b64_tr_b16 a[228:229], v73 offset:8192
  v_mfma_f32_16x16x32_bf16 v[128:131], a[192:195], a[180:183], v[128:131]
  ds_read_b64_tr_b16 a[230:231], v73 offset:9216
  buffer_load_dwordx4 v61, s[8:11], s69 offen offset:1024 lds
  v_mfma_f32_16x16x32_bf16 v[132:135], a[192:195], a[184:187], v[132:135]
  ds_read_b64_tr_b16 a[232:233], v74 offset:8192
  v_mfma_f32_16x16x32_bf16 v[136:139], a[196:199], a[168:171], v[136:139]
  ds_read_b64_tr_b16 a[234:235], v74 offset:9216
  v_mfma_f32_16x16x32_bf16 v[140:143], a[196:199], a[172:175], v[140:143]
  ds_read_b64_tr_b16 a[236:237], v75 offset:8192
  buffer_load_dwordx4 v62, s[8:11], s69 offen offset:2048 lds
  v_mfma_f32_16x16x32_bf16 v[144:147], a[196:199], a[176:179], v[144:147]
  ds_read_b64_tr_b16 a[238:239], v75 offset:9216
  v_mfma_f32_16x16x32_bf16 v[148:151], a[196:199], a[180:183], v[148:151]
  v_mfma_f32_16x16x32_bf16 v[152:155], a[196:199], a[184:187], v[152:155]
  v_mfma_f32_16x16x32_bf16 v[156:159], a[200:203], a[168:171], v[156:159]
  buffer_load_dwordx4 v63, s[8:11], s69 offen offset:3072 lds
  v_mfma_f32_16x16x32_bf16 v[160:163], a[200:203], a[172:175], v[160:163]
  v_mfma_f32_16x16x32_bf16 v[164:167], a[200:203], a[176:179], v[164:167]
  v_mfma_f32_16x16x32_bf16 v[168:171], a[200:203], a[180:183], v[168:171]
  v_mfma_f32_16x16x32_bf16 v[172:175], a[200:203], a[184:187], v[172:175]
  s_waitcnt vmcnt(9)
  s_waitcnt lgkmcnt(0)
  s_barrier
  v_mfma_f32_16x16x32_bf16 v[96:99], a[224:227], a[204:207], v[96:99]
  ds_read_b64_tr_b16 a[188:189], v78 offset:0
  v_mfma_f32_16x16x32_bf16 v[100:103], a[224:227], a[208:211], v[100:103]
  ds_read_b64_tr_b16 a[190:191], v78 offset:1024
  s_lshl_b32 s39, s67, 7
  s_add_u32 s68, s34, s39
  s_lshl_b32 s39, s67, 19
  s_add_u32 s69, s35, s39
  s_add_u32 s67, s67, 1
  s_cmp_eq_u32 s67, 9
  s_cselect_b32 s67, 0, s67
  v_mfma_f32_16x16x32_bf16 v[104:107], a[224:227], a[212:215], v[104:107]
  ds_read_b128 a[168:171], v76 offset:0
  v_mfma_f32_16x16x32_bf16 v[108:111], a[224:227], a[216:219], v[108:111]
  ds_read_b128 a[172:175], v76 offset:2048
  v_mfma_f32_16x16x32_bf16 v[112:115], a[224:227], a[220:223], v[112:115]
  ds_read_b128 a[176:179], v76 offset:4096
  s_add_u32 m0, s61, 77824
  s_nop 0
  buffer_load_dwordx4 v56, s[4:7], s68 offen offset:0 lds
  v_mfma_f32_16x16x32_bf16 v[116:119], a[228:231], a[204:207], v[116:119]
  ds_read_b128 a[180:183], v76 offset:6144
  v_mfma_f32_16x16x32_bf16 v[120:123], a[228:231], a[208:211], v[120:123]
  ds_read_b128 a[184:187], v76 offset:8192
  v_mfma_f32_16x16x32_bf16 v[124:127], a[228:231], a[212:215], v[124:127]
  ds_read_b64_tr_b16 a[192:193], v79 offset:0
  v_mfma_f32_16x16x32_bf16 v[128:131], a[228:231], a[216:219], v[128:131]
  ds_read_b64_tr_b16 a[194:195], v79 offset:1024
  buffer_load_dwordx4 v57, s[4:7], s68 offen offset:1024 lds
  v_mfma_f32_16x16x32_bf16 v[132:135], a[228:231], a[220:223], v[132:135]
  ds_read_b64_tr_b16 a[196:197], v80 offset:0
  v_mfma_f32_16x16x32_bf16 v[136:139], a[232:235], a[204:207], v[136:139]
  ds_read_b64_tr_b16 a[198:199], v80 offset:1024
  v_mfma_f32_16x16x32_bf16 v[140:143], a[232:235], a[208:211], v[140:143]
  ds_read_b64_tr_b16 a[200:201], v81 offset:0
  buffer_load_dwordx4 v58, s[4:7], s68 offen offset:2048 lds
  v_mfma_f32_16x16x32_bf16 v[144:147], a[232:235], a[212:215], v[144:147]
  ds_read_b64_tr_b16 a[202:203], v81 offset:1024
  v_mfma_f32_16x16x32_bf16 v[148:151], a[232:235], a[216:219], v[148:151]
  v_mfma_f32_16x16x32_bf16 v[152:155], a[232:235], a[220:223], v[152:155]
  v_mfma_f32_16x16x32_bf16 v[156:159], a[236:239], a[204:207], v[156:159]
  buffer_load_dwordx4 v59, s[4:7], s68 offen offset:3072 lds
  v_mfma_f32_16x16x32_bf16 v[160:163], a[236:239], a[208:211], v[160:163]
  v_mfma_f32_16x16x32_bf16 v[164:167], a[236:239], a[212:215], v[164:167]
  v_mfma_f32_16x16x32_bf16 v[168:171], a[236:239], a[216:219], v[168:171]
  v_mfma_f32_16x16x32_bf16 v[172:175], a[236:239], a[220:223], v[172:175]
  s_waitcnt lgkmcnt(0)
  v_mfma_f32_16x16x32_bf16 v[96:99], a[188:191], a[168:171], v[96:99]
  ds_read_b64_tr_b16 a[224:225], v78 offset:8192
  v_mfma_f32_16x16x32_bf16 v[100:103], a[188:191], a[172:175], v[100:103]
  ds_read_b64_tr_b16 a[226:227], v78 offset:9216
  s_add_u32 m0, s61, 81920
  s_add_u32 s68, s68, 36864
  buffer_load_dwordx4 v56, s[4:7], s68 offen offset:0 lds
  v_mfma_f32_16x16x32_bf16 v[104:107], a[188:191], a[176:179], v[104:107]
  ds_read_b128 a[204:207], v77 offset:0
  v_mfma_f32_16x16x32_bf16 v[108:111], a[188:191], a[180:183], v[108:111]
  ds_read_b128 a[208:211], v77 offset:2048
  v_mfma_f32_16x16x32_bf16 v[112:115], a[188:191], a[184:187], v[112:115]
  ds_read_b128 a[212:215], v77 offset:4096
  s_add_u32 m0, s62, 77824
  s_nop 0
  buffer_load_dwordx4 v60, s[8:11], s69 offen offset:0 lds
  v_mfma_f32_16x16x32_bf16 v[116:119], a[192:195], a[168:171], v[116:119]
  ds_read_b128 a[216:219], v77 offset:6144
  v_mfma_f32_16x16x32_bf16 v[120:123], a[192:195], a[172:175], v[120:123]
  ds_read_b128 a[220:223], v77 offset:8192
  v_mfma_f32_16x16x32_bf16 v[124:127], a[192:195], a[176:179], v[124:127]
  ds_read_b64_tr_b16 a[228:229], v79 offset:8192
  v_mfma_f32_16x16x32_bf16 v[128:131], a[192:195], a[180:183], v[128:131]
  ds_read_b64_tr_b16 a[230:231], v79 offset:9216
  buffer_load_dwordx4 v61, s[8:11], s69 offen offset:1024 lds
  v_mfma_f32_16x16x32_bf16 v[132:135], a[192:195], a[184:187], v[132:135]
  ds_read_b64_tr_b16 a[232:233], v80 offset:8192
  v_mfma_f32_16x16x32_bf16 v[136:139], a[196:199], a[168:171], v[136:139]
  ds_read_b64_tr_b16 a[234:235], v80 offset:9216
  v_mfma_f32_16x16x32_bf16 v[140:143], a[196:199], a[172:175], v[140:143]
  ds_read_b64_tr_b16 a[236:237], v81 offset:8192
  buffer_load_dwordx4 v62, s[8:11], s69 offen offset:2048 lds
  v_mfma_f32_16x16x32_bf16 v[144:147], a[196:199], a[176:179], v[144:147]
  ds_read_b64_tr_b16 a[238:239], v81 offset:9216
  v_mfma_f32_16x16x32_bf16 v[148:151], a[196:199], a[180:183], v[148:151]
  v_mfma_f32_16x16x32_bf16 v[152:155], a[196:199], a[184:187], v[152:155]
  v_mfma_f32_16x16x32_bf16 v[156:159], a[200:203], a[168:171], v[156:159]
  buffer_load_dwordx4 v63, s[8:11], s69 offen offset:3072 lds
  v_mfma_f32_16x16x32_bf16 v[160:163], a[200:203], a[172:175], v[160:163]
  v_mfma_f32_16x16x32_bf16 v[164:167], a[200:203], a[176:179], v[164:167]
  v_mfma_f32_16x16x32_bf16 v[168:171], a[200:203], a[180:183], v[168:171]
  v_mfma_f32_16x16x32_bf16 v[172:175], a[200:203], a[184:187], v[172:175]
  s_waitcnt vmcnt(9)
  s_waitcnt lgkmcnt(0)
  s_barrier
  v_mfma_f32_16x16x32_bf16 v[96:99], a[224:227], a[204:207], v[96:99]
  ds_read_b64_tr_b16 a[188:189], v66 offset:0
  v_mfma_f32_16x16x32_bf16 v[100:103], a[224:227], a[208:211], v[100:103]
  ds_read_b64_tr_b16 a[190:191], v66 offset:1024
  s_lshl_b32 s39, s67, 7
  s_add_u32 s68, s34, s39
  s_lshl_b32 s39, s67, 19
  s_add_u32 s69, s35, s39
  s_add_u32 s67, s67, 1
  s_cmp_eq_u32 s67, 9
  s_cselect_b32 s67, 0, s67
  v_mfma_f32_16x16x32_bf16 v[104:107], a[224:227], a[212:215], v[104:107]
  ds_read_b128 a[168:171], v64 offset:0
  v_mfma_f32_16x16x32_bf16 v[108:111], a[224:227], a[216:219], v[108:111]
  ds_read_b128 a[172:175], v64 offset:2048
  v_mfma_f32_16x16x32_bf16 v[112:115], a[224:227], a[220:223], v[112:115]
  ds_read_b128 a[176:179], v64 offset:4096
  s_add_u32 m0, s61, 120832
  s_nop 0
  buffer_load_dwordx4 v56, s[4:7], s68 offen offset:0 lds
  v_mfma_f32_16x16x32_bf16 v[116:119], a[228:231], a[204:207], v[116:119]
  ds_read_b128 a[180:183], v64 offset:6144
  v_mfma_f32_16x16x32_bf16 v[120:123], a[228:231], a[208:211], v[120:123]
  ds_read_b128 a[184:187], v64 offset:8192
  v_mfma_f32_16x16x32_bf16 v[124:127], a[228:231], a[212:215], v[124:127]
  ds_read_b64_tr_b16 a[192:193], v67 offset:0
  v_mfma_f32_16x16x32_bf16 v[128:131], a[228:231], a[216:219], v[128:131]
  ds_read_b64_tr_b16 a[194:195], v67 offset:1024
  buffer_load_dwordx4 v57, s[4:7], s68 offen offset:1024 lds
  v_mfma_f32_16x16x32_bf16 v[132:135], a[228:231], a[220:223], v[132:135]
  ds_read_b64_tr_b16 a[196:197], v68 offset:0
  v_mfma_f32_16x16x32_bf16 v[136:139], a[232:235], a[204:207], v[136:139]
  ds_read_b64_tr_b16 a[198:199], v68 offset:1024
  v_mfma_f32_16x16x32_bf16 v[140:143], a[232:235], a[208:211], v[140:143]
  ds_read_b64_tr_b16 a[200:201], v69 offset:0
  buffer_load_dwordx4 v58, s[4:7], s68 offen offset:2048 lds
  v_mfma_f32_16x16x32_bf16 v[144:147], a[232:235], a[212:215], v[144:147]
  ds_read_b64_tr_b16 a[202:203], v69 offset:1024
  v_mfma_f32_16x16x32_bf16 v[148:151], a[232:235], a[216:219], v[148:151]
  v_mfma_f32_16x16x32_bf16 v[152:155], a[232:235], a[220:223], v[152:155]
  v_mfma_f32_16x16x32_bf16 v[156:159], a[236:239], a[204:207], v[156:159]
  buffer_load_dwordx4 v59, s[4:7], s68 offen offset:3072 lds
  v_mfma_f32_16x16x32_bf16 v[160:163], a[236:239], a[208:211], v[160:163]
  v_mfma_f32_16x16x32_bf16 v[164:167], a[236:239], a[212:215], v[164:167]
  v_mfma_f32_16x16x32_bf16 v[168:171], a[236:239], a[216:219], v[168:171]
  v_mfma_f32_16x16x32_bf16 v[172:175], a[236:239], a[220:223], v[172:175]
  s_waitcnt lgkmcnt(0)
  v_mfma_f32_16x16x32_bf16 v[96:99], a[188:191], a[168:171], v[96:99]
  ds_read_b64_tr_b16 a[224:225], v66 offset:8192
  v_mfma_f32_16x16x32_bf16 v[100:103], a[188:191], a[172:175], v[100:103]
  ds_read_b64_tr_b16 a[226:227], v66 offset:9216
  s_add_u32 m0, s61, 124928
  s_add_u32 s68, s68, 36864
  buffer_load_dwordx4 v56, s[4:7], s68 offen offset:0 lds
  v_mfma_f32_16x16x32_bf16 v[104:107], a[188:191], a[176:179], v[104:107]
  ds_read_b128 a[204:207], v65 offset:0
  v_mfma_f32_16x16x32_bf16 v[108:111], a[188:191], a[180:183], v[108:111]
  ds_read_b128 a[208:211], v65 offset:2048
  v_mfma_f32_16x16x32_bf16 v[112:115], a[188:191], a[184:187], v[112:115]
  ds_read_b128 a[212:215], v65 offset:4096
  s_add_u32 m0, s62, 120832
  s_nop 0
  buffer_load_dwordx4 v60, s[8:11], s69 offen offset:0 lds
  v_mfma_f32_16x16x32_bf16 v[116:119], a[192:195], a[168:171], v[116:119]
  ds_read_b128 a[216:219], v65 offset:6144
  v_mfma_f32_16x16x32_bf16 v[120:123], a[192:195], a[172:175], v[120:123]
  ds_read_b128 a[220:223], v65 offset:8192
  v_mfma_f32_16x16x32_bf16 v[124:127], a[192:195], a[176:179], v[124:127]
  ds_read_b64_tr_b16 a[228:229], v67 offset:8192
  v_mfma_f32_16x16x32_bf16 v[128:131], a[192:195], a[180:183], v[128:131]
  ds_read_b64_tr_b16 a[230:231], v67 offset:9216
  buffer_load_dwordx4 v61, s[8:11], s69 offen offset:1024 lds
  v_mfma_f32_16x16x32_bf16 v[132:135], a[192:195], a[184:187], v[132:135]
  ds_read_b64_tr_b16 a[232:233], v68 offset:8192
  v_mfma_f32_16x16x32_bf16 v[136:139], a[196:199], a[168:171], v[136:139]
  ds_read_b64_tr_b16 a[234:235], v68 offset:9216
  v_mfma_f32_16x16x32_bf16 v[140:143], a[196:199], a[172:175], v[140:143]
  ds_read_b64_tr_b16 a[236:237], v69 offset:8192
  buffer_load_dwordx4 v62, s[8:11], s69 offen offset:2048 lds
  v_mfma_f32_16x16x32_bf16 v[144:147], a[196:199], a[176:179], v[144:147]
  ds_read_b64_tr_b16 a[238:239], v69 offset:9216
  v_mfma_f32_16x16x32_bf16 v[148:151], a[196:199], a[180:183], v[148:151]
  v_mfma_f32_16x16x32_bf16 v[152:155], a[196:199], a[184:187], v[152:155]
  v_mfma_f32_16x16x32_bf16 v[156:159], a[200:203], a[168:171], v[156:159]
  buffer_load_dwordx4 v63, s[8:11], s69 offen offset:3072 lds
  v_mfma_f32_16x16x32_bf16 v[160:163], a[200:203], a[172:175], v[160:163]
  v_mfma_f32_16x16x32_bf16 v[164:167], a[200:203], a[176:179], v[164:167]
  v_mfma_f32_16x16x32_bf16 v[168:171], a[200:203], a[180:183], v[168:171]
  v_mfma_f32_16x16x32_bf16 v[172:175], a[200:203], a[184:187], v[172:175]
  s_waitcnt vmcnt(9)
  s_waitcnt lgkmcnt(0)
  s_barrier
  v_mfma_f32_16x16x32_bf16 v[96:99], a[224:227], a[204:207], v[96:99]
  ds_read_b64_tr_b16 a[188:189], v72 offset:0
  v_mfma_f32_16x16x32_bf16 v[100:103], a[224:227], a[208:211], v[100:103]
  ds_read_b64_tr_b16 a[190:191], v72 offset:1024
  s_add_u32 m0, s32, 32768
  s_add_u32 s96, s30, 4096
  buffer_load_dwordx4 v4, s[12:15], s30 offen offset:0 nt lds
  v_mfma_f32_16x16x32_bf16 v[104:107], a[224:227], a[212:215], v[104:107]
  ds_read_b128 a[168:171], v70 offset:0
  v_mfma_f32_16x16x32_bf16 v[108:111], a[224:227], a[216:219], v[108:111]
  ds_read_b128 a[172:175], v70 offset:2048
  v_mfma_f32_16x16x32_bf16 v[112:115], a[224:227], a[220:223], v[112:115]
  ds_read_b128 a[176:179], v70 offset:4096
  v_mfma_f32_16x16x32_bf16 v[116:119], a[228:231], a[204:207], v[116:119]
  ds_read_b128 a[180:183], v70 offset:6144
  buffer_load_dwordx4 v5, s[12:15], s30 offen offset:1024 nt lds
  v_mfma_f32_16x16x32_bf16 v[120:123], a[228:231], a[208:211], v[120:123]
  ds_read_b128 a[184:187], v70 offset:8192
  v_mfma_f32_16x16x32_bf16 v[124:127], a[228:231], a[212:215], v[124:127]
  ds_read_b64_tr_b16 a[192:193], v73 offset:0
  v_mfma_f32_16x16x32_bf16 v[128:131], a[228:231], a[216:219], v[128:131]
  ds_read_b64_tr_b16 a[194:195], v73 offset:1024
  v_mfma_f32_16x16x32_bf16 v[132:135], a[228:231], a[220:223], v[132:135]
  ds_read_b64_tr_b16 a[196:197], v74 offset:0
  v_mfma_f32_16x16x32_bf16 v[136:139], a[232:235], a[204:207], v[136:139]
  ds_read_b64_tr_b16 a[198:199], v74 offset:1024
  buffer_load_dwordx4 v6, s[12:15], s30 offen offset:2048 nt lds
  v_mfma_f32_16x16x32_bf16 v[140:143], a[232:235], a[208:211], v[140:143]
  ds_read_b64_tr_b16 a[200:201], v75 offset:0
  v_mfma_f32_16x16x32_bf16 v[144:147], a[232:235], a[212:215], v[144:147]
  ds_read_b64_tr_b16 a[202:203], v75 offset:1024
  v_mfma_f32_16x16x32_bf16 v[148:151], a[232:235], a[216:219], v[148:151]
  v_mfma_f32_16x16x32_bf16 v[152:155], a[232:235], a[220:223], v[152:155]
  buffer_load_dwordx4 v7, s[12:15], s30 offen offset:3072 nt lds
  v_mfma_f32_16x16x32_bf16 v[156:159], a[236:239], a[204:207], v[156:159]
  v_mfma_f32_16x16x32_bf16 v[160:163], a[236:239], a[208:211], v[160:163]
  v_mfma_f32_16x16x32_bf16 v[164:167], a[236:239], a[212:215], v[164:167]
  v_mfma_f32_16x16x32_bf16 v[168:171], a[236:239], a[216:219], v[168:171]
  v_mfma_f32_16x16x32_bf16 v[172:175], a[236:239], a[220:223], v[172:175]
  s_waitcnt lgkmcnt(0)
  v_mfma_f32_16x16x32_bf16 v[96:99], a[188:191], a[168:171], v[96:99]
  ds_read_b64_tr_b16 a[224:225], v72 offset:8192
  v_mfma_f32_16x16x32_bf16 v[100:103], a[188:191], a[172:175], v[100:103]
  ds_read_b64_tr_b16 a[226:227], v72 offset:9216
  s_add_u32 m0, s32, 36864
  s_add_u32 s30, s30, 16384
  buffer_load_dwordx4 v4, s[12:15], s96 offen offset:0 nt lds
  v_mfma_f32_16x16x32_bf16 v[104:107], a[188:191], a[176:179], v[104:107]
  ds_read_b128 a[204:207], v71 offset:0
  v_mfma_f32_16x16x32_bf16 v[108:111], a[188:191], a[180:183], v[108:111]
  ds_read_b128 a[208:211], v71 offset:2048
  v_mfma_f32_16x16x32_bf16 v[112:115], a[188:191], a[184:187], v[112:115]
  ds_read_b128 a[212:215], v71 offset:4096
  v_mfma_f32_16x16x32_bf16 v[116:119], a[192:195], a[168:171], v[116:119]
  ds_read_b128 a[216:219], v71 offset:6144
  buffer_load_dwordx4 v5, s[12:15], s96 offen offset:1024 nt lds
  v_mfma_f32_16x16x32_bf16 v[120:123], a[192:195], a[172:175], v[120:123]
  ds_read_b128 a[220:223], v71 offset:8192
  v_mfma_f32_16x16x32_bf16 v[124:127], a[192:195], a[176:179], v[124:127]
  ds_read_b64_tr_b16 a[228:229], v73 offset:8192
  v_mfma_f32_16x16x32_bf16 v[128:131], a[192:195], a[180:183], v[128:131]
  ds_read_b64_tr_b16 a[230:231], v73 offset:9216
  v_mfma_f32_16x16x32_bf16 v[132:135], a[192:195], a[184:187], v[132:135]
  ds_read_b64_tr_b16 a[232:233], v74 offset:8192
  v_mfma_f32_16x16x32_bf16 v[136:139], a[196:199], a[168:171], v[136:139]
  ds_read_b64_tr_b16 a[234:235], v74 offset:9216
  buffer_load_dwordx4 v6, s[12:15], s96 offen offset:2048 nt lds
  v_mfma_f32_16x16x32_bf16 v[140:143], a[196:199], a[172:175], v[140:143]
  ds_read_b64_tr_b16 a[236:237], v75 offset:8192
  v_mfma_f32_16x16x32_bf16 v[144:147], a[196:199], a[176:179], v[144:147]
  ds_read_b64_tr_b16 a[238:239], v75 offset:9216
  v_mfma_f32_16x16x32_bf16 v[148:151], a[196:199], a[180:183], v[148:151]
  v_mfma_f32_16x16x32_bf16 v[152:155], a[196:199], a[184:187], v[152:155]
  buffer_load_dwordx4 v7, s[12:15], s96 offen offset:3072 nt lds
  v_mfma_f32_16x16x32_bf16 v[156:159], a[200:203], a[168:171], v[156:159]
  v_mfma_f32_16x16x32_bf16 v[160:163], a[200:203], a[172:175], v[160:163]
  v_mfma_f32_16x16x32_bf16 v[164:167], a[200:203], a[176:179], v[164:167]
  v_mfma_f32_16x16x32_bf16 v[168:171], a[200:203], a[180:183], v[168:171]
  v_mfma_f32_16x16x32_bf16 v[172:175], a[200:203], a[184:187], v[172:175]
  s_waitcnt vmcnt(8)
  s_waitcnt lgkmcnt(0)
  s_barrier
  v_mfma_f32_16x16x32_bf16 v[96:99], a[224:227], a[204:207], v[96:99]
  ds_read_b64_tr_b16 a[188:189], v78 offset:0
  v_mfma_f32_16x16x32_bf16 v[100:103], a[224:227], a[208:211], v[100:103]
  ds_read_b64_tr_b16 a[190:191], v78 offset:1024
  s_add_u32 m0, s33, 0
  s_add_u32 s97, s31, 4096
  buffer_load_dwordx4 v8, s[16:19], s31 offen offset:0 nt lds
  v_mfma_f32_16x16x32_bf16 v[104:107], a[224:227], a[212:215], v[104:107]
  ds_read_b128 a[168:171], v76 offset:0
  v_mfma_f32_16x16x32_bf16 v[108:111], a[224:227], a[216:219], v[108:111]
  ds_read_b128 a[172:175], v76 offset:2048
  v_mfma_f32_16x16x32_bf16 v[112:115], a[224:227], a[220:223], v[112:115]
  ds_read_b128 a[176:179], v76 offset:4096
  v_mfma_f32_16x16x32_bf16 v[116:119], a[228:231], a[204:207], v[116:119]
  ds_read_b128 a[180:183], v76 offset:6144
  buffer_load_dwordx4 v9, s[16:19], s31 offen offset:1024 nt lds
  v_mfma_f32_16x16x32_bf16 v[120:123], a[228:231], a[208:211], v[120:123]
  ds_read_b128 a[184:187], v76 offset:8192
  v_mfma_f32_16x16x32_bf16 v[124:127], a[228:231], a[212:215], v[124:127]
  ds_read_b64_tr_b16 a[192:193], v79 offset:0
  v_mfma_f32_16x16x32_bf16 v[128:131], a[228:231], a[216:219], v[128:131]
  ds_read_b64_tr_b16 a[194:195], v79 offset:1024
  v_mfma_f32_16x16x32_bf16 v[132:135], a[228:231], a[220:223], v[132:135]
  ds_read_b64_tr_b16 a[196:197], v80 offset:0
  v_mfma_f32_16x16x32_bf16 v[136:139], a[232:235], a[204:207], v[136:139]
  ds_read_b64_tr_b16 a[198:199], v80 offset:1024
  buffer_load_dwordx4 v8, s[16:19], s31 offen offset:2048 nt lds
  v_mfma_f32_16x16x32_bf16 v[140:143], a[232:235], a[208:211], v[140:143]
  ds_read_b64_tr_b16 a[200:201], v81 offset:0
  v_mfma_f32_16x16x32_bf16 v[144:147], a[232:235], a[212:215], v[144:147]
  ds_read_b64_tr_b16 a[202:203], v81 offset:1024
  v_mfma_f32_16x16x32_bf16 v[148:151], a[232:235], a[216:219], v[148:151]
  v_mfma_f32_16x16x32_bf16 v[152:155], a[232:235], a[220:223], v[152:155]
  buffer_load_dwordx4 v9, s[16:19], s31 offen offset:3072 nt lds
  v_mfma_f32_16x16x32_bf16 v[156:159], a[236:239], a[204:207], v[156:159]
  v_mfma_f32_16x16x32_bf16 v[160:163], a[236:239], a[208:211], v[160:163]
  v_mfma_f32_16x16x32_bf16 v[164:167], a[236:239], a[212:215], v[164:167]
  v_mfma_f32_16x16x32_bf16 v[168:171], a[236:239], a[216:219], v[168:171]
  v_mfma_f32_16x16x32_bf16 v[172:175], a[236:239], a[220:223], v[172:175]
  s_waitcnt lgkmcnt(0)
  v_mfma_f32_16x16x32_bf16 v[96:99], a[188:191], a[168:171], v[96:99]
  ds_read_b64_tr_b16 a[224:225], v78 offset:8192
  v_mfma_f32_16x16x32_bf16 v[100:103], a[188:191], a[172:175], v[100:103]
  ds_read_b64_tr_b16 a[226:227], v78 offset:9216
  s_add_u32 m0, s33, 4096
  s_add_u32 s31, s31, 16384
  buffer_load_dwordx4 v8, s[16:19], s97 offen offset:0 nt lds
  v_mfma_f32_16x16x32_bf16 v[104:107], a[188:191], a[176:179], v[104:107]
  ds_read_b128 a[204:207], v77 offset:0
  v_mfma_f32_16x16x32_bf16 v[108:111], a[188:191], a[180:183], v[108:111]
  ds_read_b128 a[208:211], v77 offset:2048
  v_mfma_f32_16x16x32_bf16 v[112:115], a[188:191], a[184:187], v[112:115]
  ds_read_b128 a[212:215], v77 offset:4096
  v_mfma_f32_16x16x32_bf16 v[116:119], a[192:195], a[168:171], v[116:119]
  ds_read_b128 a[216:219], v77 offset:6144
  buffer_load_dwordx4 v9, s[16:19], s97 offen offset:1024 nt lds
  v_mfma_f32_16x16x32_bf16 v[120:123], a[192:195], a[172:175], v[120:123]
  ds_read_b128 a[220:223], v77 offset:8192
  v_mfma_f32_16x16x32_bf16 v[124:127], a[192:195], a[176:179], v[124:127]
  ds_read_b64_tr_b16 a[228:229], v79 offset:8192
  v_mfma_f32_16x16x32_bf16 v[128:131], a[192:195], a[180:183], v[128:131]
  ds_read_b64_tr_b16 a[230:231], v79 offset:9216
  v_mfma_f32_16x16x32_bf16 v[132:135], a[192:195], a[184:187], v[132:135]
  ds_read_b64_tr_b16 a[232:233], v80 offset:8192
  v_mfma_f32_16x16x32_bf16 v[136:139], a[196:199], a[168:171], v[136:139]
  ds_read_b64_tr_b16 a[234:235], v80 offset:9216
  buffer_load_dwordx4 v8, s[16:19], s97 offen offset:2048 nt lds
  v_mfma_f32_16x16x32_bf16 v[140:143], a[196:199], a[172:175], v[140:143]
  ds_read_b64_tr_b16 a[236:237], v81 offset:8192
  v_mfma_f32_16x16x32_bf16 v[144:147], a[196:199], a[176:179], v[144:147]
  ds_read_b64_tr_b16 a[238:239], v81 offset:9216
  v_mfma_f32_16x16x32_bf16 v[148:151], a[196:199], a[180:183], v[148:151]
  v_mfma_f32_16x16x32_bf16 v[152:155], a[196:199], a[184:187], v[152:155]
  buffer_load_dwordx4 v9, s[16:19], s97 offen offset:3072 nt lds
  v_mfma_f32_16x16x32_bf16 v[156:159], a[200:203], a[168:171], v[156:159]
  v_mfma_f32_16x16x32_bf16 v[160:163], a[200:203], a[172:175], v[160:163]
  v_mfma_f32_16x16x32_bf16 v[164:167], a[200:203], a[176:179], v[164:167]
  v_mfma_f32_16x16x32_bf16 v[168:171], a[200:203], a[180:183], v[168:171]
  v_mfma_f32_16x16x32_bf16 v[172:175], a[200:203], a[184:187], v[172:175]
  s_waitcnt lgkmcnt(0)
  s_branch L_concat_heads__gqa_block_cached__mha_block_cached__near_ridge_kernel_qx
L_concat_heads__gqa_block_cached__mha_block_cached__near_ridge_kernel_loopA:
  s_waitcnt vmcnt(11)
  s_barrier
  ds_read_b64_tr_b16 a[188:189], v66 offset:0
  ds_read_b64_tr_b16 a[190:191], v66 offset:1024
  ds_read_b128 a[168:171], v64 offset:0
  ds_read_b128 a[172:175], v64 offset:2048
  ds_read_b128 a[176:179], v64 offset:4096
  ds_read_b128 a[180:183], v64 offset:6144
  ds_read_b128 a[184:187], v64 offset:8192
  ds_read_b64_tr_b16 a[192:193], v67 offset:0
  ds_read_b64_tr_b16 a[194:195], v67 offset:1024
  ds_read_b64_tr_b16 a[196:197], v68 offset:0
  ds_read_b64_tr_b16 a[198:199], v68 offset:1024
  ds_read_b64_tr_b16 a[200:201], v69 offset:0
  ds_read_b64_tr_b16 a[202:203], v69 offset:1024
  s_lshl_b32 s39, s67, 7
  s_add_u32 s68, s34, s39
  s_add_u32 s3, s65, s39
  s_lshl_b32 s39, s67, 19
  s_add_u32 s69, s35, s39
  s_add_u32 s67, s67, 1
  s_cmp_eq_u32 s67, 9
  s_cselect_b32 s67, 0, s67
  s_add_u32 m0, s61, 120832
  s_nop 0
  buffer_load_dwordx4 v56, s[4:7], s68 offen offset:0 lds
  s_add_u32 m0, s61, 124928
  s_add_u32 s39, s68, 36864
  buffer_load_dwordx4 v56, s[4:7], s39 offen offset:0 lds
  s_add_u32 m0, s66, 120832
  s_nop 0
  buffer_load_dwordx4 v56, s[4:7], s3 offen offset:0 lds
  s_add_u32 m0, s62, 120832
  s_nop 0
  buffer_load_dwordx4 v60, s[8:11], s69 offen offset:0 lds
  buffer_load_dwordx4 v61, s[8:11], s69 offen offset:1024 lds
  s_waitcnt lgkmcnt(0)
  v_mfma_f32_16x16x32_bf16 v[96:99], a[188:191], a[168:171], 0
  ds_read_b64_tr_b16 a[224:225], v66 offset:8192
  v_mfma_f32_16x16x32_bf16 v[100:103], a[188:191], a[172:175], 0
  ds_read_b64_tr_b16 a[226:227], v66 offset:9216
  buffer_load_dwordx4 v62, s[8:11], s69 offen offset:2048 lds
  v_mfma_f32_16x16x32_bf16 v[104:107], a[188:191], a[176:179], 0
  ds_read_b128 a[204:207], v65 offset:0
  v_mfma_f32_16x16x32_bf16 v[108:111], a[188:191], a[180:183], 0
  ds_read_b128 a[208:211], v65 offset:2048
  v_mfma_f32_16x16x32_bf16 v[112:115], a[188:191], a[184:187], 0
  ds_read_b128 a[212:215], v65 offset:4096
  buffer_load_dwordx4 v63, s[8:11], s69 offen offset:3072 lds
  v_mfma_f32_16x16x32_bf16 v[116:119], a[192:195], a[168:171], 0
  ds_read_b128 a[216:219], v65 offset:6144
  v_mfma_f32_16x16x32_bf16 v[120:123], a[192:195], a[172:175], 0
  ds_read_b128 a[220:223], v65 offset:8192
  v_mfma_f32_16x16x32_bf16 v[124:127], a[192:195], a[176:179], 0
  ds_read_b64_tr_b16 a[228:229], v67 offset:8192
  s_add_u32 m0, s62, 124928
  s_add_u32 s69, s69, 131072
  buffer_load_dwordx4 v60, s[8:11], s69 offen offset:0 lds
  v_mfma_f32_16x16x32_bf16 v[128:131], a[192:195], a[180:183], 0
  ds_read_b64_tr_b16 a[230:231], v67 offset:9216
  v_mfma_f32_16x16x32_bf16 v[132:135], a[192:195], a[184:187], 0
  ds_read_b64_tr_b16 a[232:233], v68 offset:8192
  v_mfma_f32_16x16x32_bf16 v[136:139], a[196:199], a[168:171], 0
  ds_read_b64_tr_b16 a[234:235], v68 offset:9216
  buffer_load_dwordx4 v61, s[8:11], s69 offen offset:1024 lds
  v_mfma_f32_16x16x32_bf16 v[140:143], a[196:199], a[172:175], 0
  ds_read_b64_tr_b16 a[236:237], v69 offset:8192
  v_mfma_f32_16x16x32_bf16 v[144:147], a[196:199], a[176:179], 0
  ds_read_b64_tr_b16 a[238:239], v69 offset:9216
  v_mfma_f32_16x16x32_bf16 v[148:151], a[196:199], a[180:183], 0
  buffer_load_dwordx4 v62, s[8:11], s69 offen offset:2048 lds
  v_mfma_f32_16x16x32_bf16 v[152:155], a[196:199], a[184:187], 0
  v_mfma_f32_16x16x32_bf16 v[156:159], a[200:203], a[168:171], 0
  v_mfma_f32_16x16x32_bf16 v[160:163], a[200:203], a[172:175], 0
  buffer_load_dwordx4 v63, s[8:11], s69 offen offset:3072 lds
  v_mfma_f32_16x16x32_bf16 v[164:167], a[200:203], a[176:179], 0
  v_mfma_f32_16x16x32_bf16 v[168:171], a[200:203], a[180:183], 0
  v_mfma_f32_16x16x32_bf16 v[172:175], a[200:203], a[184:187], 0
  s_waitcnt vmcnt(11)
  s_waitcnt lgkmcnt(0)
  s_barrier
  v_mfma_f32_16x16x32_bf16 v[96:99], a[224:227], a[204:207], v[96:99]
  ds_read_b64_tr_b16 a[188:189], v72 offset:0
  v_mfma_f32_16x16x32_bf16 v[100:103], a[224:227], a[208:211], v[100:103]
  ds_read_b64_tr_b16 a[190:191], v72 offset:1024
  s_lshl_b32 s39, s67, 7
  s_add_u32 s68, s34, s39
  s_add_u32 s3, s65, s39
  s_lshl_b32 s39, s67, 19
  s_add_u32 s69, s35, s39
  s_add_u32 s67, s67, 1
  s_cmp_eq_u32 s67, 9
  s_cselect_b32 s67, 0, s67
  v_mfma_f32_16x16x32_bf16 v[104:107], a[224:227], a[212:215], v[104:107]
  ds_read_b128 a[168:171], v70 offset:0
  v_mfma_f32_16x16x32_bf16 v[108:111], a[224:227], a[216:219], v[108:111]
  ds_read_b128 a[172:175], v70 offset:2048
  v_mfma_f32_16x16x32_bf16 v[112:115], a[224:227], a[220:223], v[112:115]
  ds_read_b128 a[176:179], v70 offset:4096
  s_add_u32 m0, s61, 34816
  s_nop 0
  buffer_load_dwordx4 v56, s[4:7], s68 offen offset:0 lds
  v_mfma_f32_16x16x32_bf16 v[116:119], a[228:231], a[204:207], v[116:119]
  ds_read_b128 a[180:183], v70 offset:6144
  v_mfma_f32_16x16x32_bf16 v[120:123], a[228:231], a[208:211], v[120:123]
  ds_read_b128 a[184:187], v70 offset:8192
  v_mfma_f32_16x16x32_bf16 v[124:127], a[228:231], a[212:215], v[124:127]
  ds_read_b64_tr_b16 a[192:193], v73 offset:0
  s_add_u32 m0, s61, 38912
  s_add_u32 s39, s68, 36864
  buffer_load_dwordx4 v56, s[4:7], s39 offen offset:0 lds
  v_mfma_f32_16x16x32_bf16 v[128:131], a[228:231], a[216:219], v[128:131]
  ds_read_b64_tr_b16 a[194:195], v73 offset:1024
  v_mfma_f32_16x16x32_bf16 v[132:135], a[228:231], a[220:223], v[132:135]
  ds_read_b64_tr_b16 a[196:197], v74 offset:0
  v_mfma_f32_16x16x32_bf16 v[136:139], a[232:235], a[204:207], v[136:139]
  ds_read_b64_tr_b16 a[198:199], v74 offset:1024
  s_add_u32 m0, s66, 34816
  s_nop 0
  buffer_load_dwordx4 v56, s[4:7], s3 offen offset:0 lds
  v_mfma_f32_16x16x32_bf16 v[140:143], a[232:235], a[208:211], v[140:143]
  ds_read_b64_tr_b16 a[200:201], v75 offset:0
  v_mfma_f32_16x16x32_bf16 v[144:147], a[232:235], a[212:215], v[144:147]
  ds_read_b64_tr_b16 a[202:203], v75 offset:1024
  v_mfma_f32_16x16x32_bf16 v[148:151], a[232:235], a[216:219], v[148:151]
  s_add_u32 m0, s62, 34816
  s_nop 0
  buffer_load_dwordx4 v60, s[8:11], s69 offen offset:0 lds
  v_mfma_f32_16x16x32_bf16 v[152:155], a[232:235], a[220:223], v[152:155]
  v_mfma_f32_16x16x32_bf16 v[156:159], a[236:239], a[204:207], v[156:159]
  v_mfma_f32_16x16x32_bf16 v[160:163], a[236:239], a[208:211], v[160:163]
  buffer_load_dwordx4 v61, s[8:11], s69 offen offset:1024 lds
  v_mfma_f32_16x16x32_bf16 v[164:167], a[236:239], a[212:215], v[164:167]
  v_mfma_f32_16x16x32_bf16 v[168:171], a[236:239], a[216:219], v[168:171]
  v_mfma_f32_16x16x32_bf16 v[172:175], a[236:239], a[220:223], v[172:175]
  s_waitcnt lgkmcnt(0)
  v_mfma_f32_16x16x32_bf16 v[96:99], a[188:191], a[168:171], v[96:99]
  ds_read_b64_tr_b16 a[224:225], v72 offset:8192
  v_mfma_f32_16x16x32_bf16 v[100:103], a[188:191], a[172:175], v[100:103]
  ds_read_b64_tr_b16 a[226:227], v72 offset:9216
  buffer_load_dwordx4 v62, s[8:11], s69 offen offset:2048 lds
  v_mfma_f32_16x16x32_bf16 v[104:107], a[188:191], a[176:179], v[104:107]
  ds_read_b128 a[204:207], v71 offset:0
  v_mfma_f32_16x16x32_bf16 v[108:111], a[188:191], a[180:183], v[108:111]
  ds_read_b128 a[208:211], v71 offset:2048
  v_mfma_f32_16x16x32_bf16 v[112:115], a[188:191], a[184:187], v[112:115]
  ds_read_b128 a[212:215], v71 offset:4096
  buffer_load_dwordx4 v63, s[8:11], s69 offen offset:3072 lds
  v_mfma_f32_16x16x32_bf16 v[116:119], a[192:195], a[168:171], v[116:119]
  ds_read_b128 a[216:219], v71 offset:6144
  v_mfma_f32_16x16x32_bf16 v[120:123], a[192:195], a[172:175], v[120:123]
  ds_read_b128 a[220:223], v71 offset:8192
  v_mfma_f32_16x16x32_bf16 v[124:127], a[192:195], a[176:179], v[124:127]
  ds_read_b64_tr_b16 a[228:229], v73 offset:8192
  s_add_u32 m0, s62, 38912
  s_add_u32 s69, s69, 131072
  buffer_load_dwordx4 v60, s[8:11], s69 offen offset:0 lds
  v_mfma_f32_16x16x32_bf16 v[128:131], a[192:195], a[180:183], v[128:131]
  ds_read_b64_tr_b16 a[230:231], v73 offset:9216
  v_mfma_f32_16x16x32_bf16 v[132:135], a[192:195], a[184:187], v[132:135]
  ds_read_b64_tr_b16 a[232:233], v74 offset:8192
  v_mfma_f32_16x16x32_bf16 v[136:139], a[196:199], a[168:171], v[136:139]
  ds_read_b64_tr_b16 a[234:235], v74 offset:9216
  buffer_load_dwordx4 v61, s[8:11], s69 offen offset:1024 lds
  v_mfma_f32_16x16x32_bf16 v[140:143], a[196:199], a[172:175], v[140:143]
  ds_read_b64_tr_b16 a[236:237], v75 offset:8192
  v_mfma_f32_16x16x32_bf16 v[144:147], a[196:199], a[176:179], v[144:147]
  ds_read_b64_tr_b16 a[238:239], v75 offset:9216
  v_mfma_f32_16x16x32_bf16 v[148:151], a[196:199], a[180:183], v[148:151]
  buffer_load_dwordx4 v62, s[8:11], s69 offen offset:2048 lds
  v_mfma_f32_16x16x32_bf16 v[152:155], a[196:199], a[184:187], v[152:155]
  v_mfma_f32_16x16x32_bf16 v[156:159], a[200:203], a[168:171], v[156:159]
  v_mfma_f32_16x16x32_bf16 v[160:163], a[200:203], a[172:175], v[160:163]
  buffer_load_dwordx4 v63, s[8:11], s69 offen offset:3072 lds
  v_mfma_f32_16x16x32_bf16 v[164:167], a[200:203], a[176:179], v[164:167]
  v_mfma_f32_16x16x32_bf16 v[168:171], a[200:203], a[180:183], v[168:171]
  v_mfma_f32_16x16x32_bf16 v[172:175], a[200:203], a[184:187], v[172:175]
  s_waitcnt vmcnt(11)
  s_waitcnt lgkmcnt(0)
  s_barrier
  v_mfma_f32_16x16x32_bf16 v[96:99], a[224:227], a[204:207], v[96:99]
  ds_read_b64_tr_b16 a[188:189], v78 offset:0
  v_mfma_f32_16x16x32_bf16 v[100:103], a[224:227], a[208:211], v[100:103]
  ds_read_b64_tr_b16 a[190:191], v78 offset:1024
  s_lshl_b32 s39, s67, 7
  s_add_u32 s68, s34, s39
  s_add_u32 s3, s65, s39
  s_lshl_b32 s39, s67, 19
  s_add_u32 s69, s35, s39
  s_add_u32 s67, s67, 1
  s_cmp_eq_u32 s67, 9
  s_cselect_b32 s67, 0, s67
  v_mfma_f32_16x16x32_bf16 v[104:107], a[224:227], a[212:215], v[104:107]
  ds_read_b128 a[168:171], v76 offset:0
  s_add_u32 m0, s61, 77824
  s_nop 0
  buffer_load_dwordx4 v56, s[4:7], s68 offen offset:0 lds
  v_mfma_f32_16x16x32_bf16 v[108:111], a[224:227], a[216:219], v[108:111]
  ds_read_b128 a[172:175], v76 offset:2048
  v_mfma_f32_16x16x32_bf16 v[112:115], a[224:227], a[220:223], v[112:115]
  ds_read_b128 a[176:179], v76 offset:4096
  s_add_u32 m0, s61, 81920
  s_add_u32 s39, s68, 36864
  buffer_load_dwordx4 v56, s[4:7], s39 offen offset:0 lds
  v_mfma_f32_16x16x32_bf16 v[116:119], a[228:231], a[204:207], v[116:119]
  ds_read_b128 a[180:183], v76 offset:6144
  v_mfma_f32_16x16x32_bf16 v[120:123], a[228:231], a[208:211], v[120:123]
  ds_read_b128 a[184:187], v76 offset:8192
  s_add_u32 m0, s66, 77824
  s_nop 0
  buffer_load_dwordx4 v56, s[4:7], s3 offen offset:0 lds
  v_mfma_f32_16x16x32_bf16 v[124:127], a[228:231], a[212:215], v[124:127]
  ds_read_b64_tr_b16 a[192:193], v79 offset:0
  v_mfma_f32_16x16x32_bf16 v[128:131], a[228:231], a[216:219], v[128:131]
  ds_read_b64_tr_b16 a[194:195], v79 offset:1024
  s_add_u32 m0, s62, 77824
  s_nop 0
  buffer_load_dwordx4 v60, s[8:11], s69 offen offset:0 lds
  v_mfma_f32_16x16x32_bf16 v[132:135], a[228:231], a[220:223], v[132:135]
  ds_read_b64_tr_b16 a[196:197], v80 offset:0
  v_mfma_f32_16x16x32_bf16 v[136:139], a[232:235], a[204:207], v[136:139]
  ds_read_b64_tr_b16 a[198:199], v80 offset:1024
  buffer_load_dwordx4 v61, s[8:11], s69 offen offset:1024 lds
  v_mfma_f32_16x16x32_bf16 v[140:143], a[232:235], a[208:211], v[140:143]
  ds_read_b64_tr_b16 a[200:201], v81 offset:0
  buffer_load_dwordx4 v62, s[8:11], s69 offen offset:2048 lds
  v_mfma_f32_16x16x32_bf16 v[144:147], a[232:235], a[212:215], v[144:147]
  ds_read_b64_tr_b16 a[202:203], v81 offset:1024
  v_mfma_f32_16x16x32_bf16 v[148:151], a[232:235], a[216:219], v[148:151]
  buffer_load_dwordx4 v63, s[8:11], s69 offen offset:3072 lds
  v_mfma_f32_16x16x32_bf16 v[152:155], a[232:235], a[220:223], v[152:155]
  v_mfma_f32_16x16x32_bf16 v[156:159], a[236:239], a[204:207], v[156:159]
  s_add_u32 m0, s62, 81920
  s_add_u32 s69, s69, 131072
  buffer_load_dwordx4 v60, s[8:11], s69 offen offset:0 lds
  v_mfma_f32_16x16x32_bf16 v[160:163], a[236:239], a[208:211], v[160:163]
  v_mfma_f32_16x16x32_bf16 v[164:167], a[236:239], a[212:215], v[164:167]
  buffer_load_dwordx4 v61, s[8:11], s69 offen offset:1024 lds
  v_mfma_f32_16x16x32_bf16 v[168:171], a[236:239], a[216:219], v[168:171]
  v_mfma_f32_16x16x32_bf16 v[172:175], a[236:239], a[220:223], v[172:175]
  s_waitcnt lgkmcnt(0)
  v_mfma_f32_16x16x32_bf16 v[96:99], a[188:191], a[168:171], v[96:99]
  ds_read_b64_tr_b16 a[224:225], v78 offset:8192
  v_mfma_f32_16x16x32_bf16 v[100:103], a[188:191], a[172:175], v[100:103]
  ds_read_b64_tr_b16 a[226:227], v78 offset:9216
  buffer_load_dwordx4 v62, s[8:11], s69 offen offset:2048 lds
  v_mfma_f32_16x16x32_bf16 v[104:107], a[188:191], a[176:179], v[104:107]
  ds_read_b128 a[204:207], v77 offset:0
  buffer_load_dwordx4 v63, s[8:11], s69 offen offset:3072 lds
  v_mfma_f32_16x16x32_bf16 v[108:111], a[188:191], a[180:183], v[108:111]
  ds_read_b128 a[208:211], v77 offset:2048
  v_mfma_f32_16x16x32_bf16 v[112:115], a[188:191], a[184:187], v[112:115]
  ds_read_b128 a[212:215], v77 offset:4096
  s_add_u32 m0, s32, 0
  s_add_u32 s96, s30, 4096
  buffer_load_dwordx4 v4, s[12:15], s30 offen offset:0 nt lds
  v_mfma_f32_16x16x32_bf16 v[116:119], a[192:195], a[168:171], v[116:119]
  ds_read_b128 a[216:219], v77 offset:6144
  v_mfma_f32_16x16x32_bf16 v[120:123], a[192:195], a[172:175], v[120:123]
  ds_read_b128 a[220:223], v77 offset:8192
  buffer_load_dwordx4 v5, s[12:15], s30 offen offset:1024 nt lds
  v_mfma_f32_16x16x32_bf16 v[124:127], a[192:195], a[176:179], v[124:127]
  ds_read_b64_tr_b16 a[228:229], v79 offset:8192
  v_mfma_f32_16x16x32_bf16 v[128:131], a[192:195], a[180:183], v[128:131]
  ds_read_b64_tr_b16 a[230:231], v79 offset:9216
  buffer_load_dwordx4 v6, s[12:15], s30 offen offset:2048 nt lds
  v_mfma_f32_16x16x32_bf16 v[132:135], a[192:195], a[184:187], v[132:135]
  ds_read_b64_tr_b16 a[232:233], v80 offset:8192
  v_mfma_f32_16x16x32_bf16 v[136:139], a[196:199], a[168:171], v[136:139]
  ds_read_b64_tr_b16 a[234:235], v80 offset:9216
  buffer_load_dwordx4 v7, s[12:15], s30 offen offset:3072 nt lds
  v_mfma_f32_16x16x32_bf16 v[140:143], a[196:199], a[172:175], v[140:143]
  ds_read_b64_tr_b16 a[236:237], v81 offset:8192
  s_add_u32 m0, s32, 4096
  s_add_u32 s30, s30, 16384
  buffer_load_dwordx4 v4, s[12:15], s96 offen offset:0 nt lds
  v_mfma_f32_16x16x32_bf16 v[144:147], a[196:199], a[176:179], v[144:147]
  ds_read_b64_tr_b16 a[238:239], v81 offset:9216
  v_mfma_f32_16x16x32_bf16 v[148:151], a[196:199], a[180:183], v[148:151]
  buffer_load_dwordx4 v5, s[12:15], s96 offen offset:1024 nt lds
  v_mfma_f32_16x16x32_bf16 v[152:155], a[196:199], a[184:187], v[152:155]
  v_mfma_f32_16x16x32_bf16 v[156:159], a[200:203], a[168:171], v[156:159]
  buffer_load_dwordx4 v6, s[12:15], s96 offen offset:2048 nt lds
  v_mfma_f32_16x16x32_bf16 v[160:163], a[200:203], a[172:175], v[160:163]
  v_mfma_f32_16x16x32_bf16 v[164:167], a[200:203], a[176:179], v[164:167]
  buffer_load_dwordx4 v7, s[12:15], s96 offen offset:3072 nt lds
  v_mfma_f32_16x16x32_bf16 v[168:171], a[200:203], a[180:183], v[168:171]
  v_mfma_f32_16x16x32_bf16 v[172:175], a[200:203], a[184:187], v[172:175]
  s_waitcnt vmcnt(19)
  s_waitcnt lgkmcnt(0)
  s_barrier
  v_mfma_f32_16x16x32_bf16 v[96:99], a[224:227], a[204:207], v[96:99]
  ds_read_b64_tr_b16 a[188:189], v66 offset:0
  v_mfma_f32_16x16x32_bf16 v[100:103], a[224:227], a[208:211], v[100:103]
  ds_read_b64_tr_b16 a[190:191], v66 offset:1024
  s_lshl_b32 s39, s67, 7
  s_add_u32 s68, s34, s39
  s_add_u32 s3, s65, s39
  s_lshl_b32 s39, s67, 19
  s_add_u32 s69, s35, s39
  s_add_u32 s67, s67, 1
  s_cmp_eq_u32 s67, 9
  s_cselect_b32 s67, 0, s67
  v_mfma_f32_16x16x32_bf16 v[104:107], a[224:227], a[212:215], v[104:107]
  ds_read_b128 a[168:171], v64 offset:0
  v_mfma_f32_16x16x32_bf16 v[108:111], a[224:227], a[216:219], v[108:111]
  ds_read_b128 a[172:175], v64 offset:2048
  v_mfma_f32_16x16x32_bf16 v[112:115], a[224:227], a[220:223], v[112:115]
  ds_read_b128 a[176:179], v64 offset:4096
  s_add_u32 m0, s61, 120832
  s_nop 0
  buffer_load_dwordx4 v56, s[4:7], s68 offen offset:0 lds
  v_mfma_f32_16x16x32_bf16 v[116:119], a[228:231], a[204:207], v[116:119]
  ds_read_b128 a[180:183], v64 offset:6144
  v_mfma_f32_16x16x32_bf16 v[120:123], a[228:231], a[208:211], v[120:123]
  ds_read_b128 a[184:187], v64 offset:8192
  v_mfma_f32_16x16x32_bf16 v[124:127], a[228:231], a[212:215], v[124:127]
  ds_read_b64_tr_b16 a[192:193], v67 offset:0
  s_add_u32 m0, s61, 124928
  s_add_u32 s39, s68, 36864
  buffer_load_dwordx4 v56, s[4:7], s39 offen offset:0 lds
  v_mfma_f32_16x16x32_bf16 v[128:131], a[228:231], a[216:219], v[128:131]
  ds_read_b64_tr_b16 a[194:195], v67 offset:1024
  v_mfma_f32_16x16x32_bf16 v[132:135], a[228:231], a[220:223], v[132:135]
  ds_read_b64_tr_b16 a[196:197], v68 offset:0
  v_mfma_f32_16x16x32_bf16 v[136:139], a[232:235], a[204:207], v[136:139]
  ds_read_b64_tr_b16 a[198:199], v68 offset:1024
  s_add_u32 m0, s66, 120832
  s_nop 0
  buffer_load_dwordx4 v56, s[4:7], s3 offen offset:0 lds
  v_mfma_f32_16x16x32_bf16 v[140:143], a[232:235], a[208:211], v[140:143]
  ds_read_b64_tr_b16 a[200:201], v69 offset:0
  v_mfma_f32_16x16x32_bf16 v[144:147], a[232:235], a[212:215], v[144:147]
  ds_read_b64_tr_b16 a[202:203], v69 offset:1024
  v_mfma_f32_16x16x32_bf16 v[148:151], a[232:235], a[216:219], v[148:151]
  s_add_u32 m0, s62, 120832
  s_nop 0
  buffer_load_dwordx4 v60, s[8:11], s69 offen offset:0 lds
  v_mfma_f32_16x16x32_bf16 v[152:155], a[232:235], a[220:223], v[152:155]
  v_mfma_f32_16x16x32_bf16 v[156:159], a[236:239], a[204:207], v[156:159]
  v_mfma_f32_16x16x32_bf16 v[160:163], a[236:239], a[208:211], v[160:163]
  buffer_load_dwordx4 v61, s[8:11], s69 offen offset:1024 lds
  v_mfma_f32_16x16x32_bf16 v[164:167], a[236:239], a[212:215], v[164:167]
  v_mfma_f32_16x16x32_bf16 v[168:171], a[236:239], a[216:219], v[168:171]
  v_mfma_f32_16x16x32_bf16 v[172:175], a[236:239], a[220:223], v[172:175]
  s_waitcnt lgkmcnt(0)
  v_mfma_f32_16x16x32_bf16 v[96:99], a[188:191], a[168:171], v[96:99]
  ds_read_b64_tr_b16 a[224:225], v66 offset:8192
  v_mfma_f32_16x16x32_bf16 v[100:103], a[188:191], a[172:175], v[100:103]
  ds_read_b64_tr_b16 a[226:227], v66 offset:9216
  buffer_load_dwordx4 v62, s[8:11], s69 offen offset:2048 lds
  v_mfma_f32_16x16x32_bf16 v[104:107], a[188:191], a[176:179], v[104:107]
  ds_read_b128 a[204:207], v65 offset:0
  v_mfma_f32_16x16x32_bf16 v[108:111], a[188:191], a[180:183], v[108:111]
  ds_read_b128 a[208:211], v65 offset:2048
  v_mfma_f32_16x16x32_bf16 v[112:115], a[188:191], a[184:187], v[112:115]
  ds_read_b128 a[212:215], v65 offset:4096
  buffer_load_dwordx4 v63, s[8:11], s69 offen offset:3072 lds
  v_mfma_f32_16x16x32_bf16 v[116:119], a[192:195], a[168:171], v[116:119]
  ds_read_b128 a[216:219], v65 offset:6144
  v_mfma_f32_16x16x32_bf16 v[120:123], a[192:195], a[172:175], v[120:123]
  ds_read_b128 a[220:223], v65 offset:8192
  v_mfma_f32_16x16x32_bf16 v[124:127], a[192:195], a[176:179], v[124:127]
  ds_read_b64_tr_b16 a[228:229], v67 offset:8192
  s_add_u32 m0, s62, 124928
  s_add_u32 s69, s69, 131072
  buffer_load_dwordx4 v60, s[8:11], s69 offen offset:0 lds
  v_mfma_f32_16x16x32_bf16 v[128:131], a[192:195], a[180:183], v[128:131]
  ds_read_b64_tr_b16 a[230:231], v67 offset:9216
  v_mfma_f32_16x16x32_bf16 v[132:135], a[192:195], a[184:187], v[132:135]
  ds_read_b64_tr_b16 a[232:233], v68 offset:8192
  v_mfma_f32_16x16x32_bf16 v[136:139], a[196:199], a[168:171], v[136:139]
  ds_read_b64_tr_b16 a[234:235], v68 offset:9216
  buffer_load_dwordx4 v61, s[8:11], s69 offen offset:1024 lds
  v_mfma_f32_16x16x32_bf16 v[140:143], a[196:199], a[172:175], v[140:143]
  ds_read_b64_tr_b16 a[236:237], v69 offset:8192
  v_mfma_f32_16x16x32_bf16 v[144:147], a[196:199], a[176:179], v[144:147]
  ds_read_b64_tr_b16 a[238:239], v69 offset:9216
  v_mfma_f32_16x16x32_bf16 v[148:151], a[196:199], a[180:183], v[148:151]
  buffer_load_dwordx4 v62, s[8:11], s69 offen offset:2048 lds
  v_mfma_f32_16x16x32_bf16 v[152:155], a[196:199], a[184:187], v[152:155]
  v_mfma_f32_16x16x32_bf16 v[156:159], a[200:203], a[168:171], v[156:159]
  v_mfma_f32_16x16x32_bf16 v[160:163], a[200:203], a[172:175], v[160:163]
  buffer_load_dwordx4 v63, s[8:11], s69 offen offset:3072 lds
  v_mfma_f32_16x16x32_bf16 v[164:167], a[200:203], a[176:179], v[164:167]
  v_mfma_f32_16x16x32_bf16 v[168:171], a[200:203], a[180:183], v[168:171]
  v_mfma_f32_16x16x32_bf16 v[172:175], a[200:203], a[184:187], v[172:175]
  s_waitcnt vmcnt(19)
  s_waitcnt lgkmcnt(0)
  s_barrier
  v_mfma_f32_16x16x32_bf16 v[96:99], a[224:227], a[204:207], v[96:99]
  ds_read_b64_tr_b16 a[188:189], v72 offset:0
  v_mfma_f32_16x16x32_bf16 v[100:103], a[224:227], a[208:211], v[100:103]
  ds_read_b64_tr_b16 a[190:191], v72 offset:1024
  s_lshl_b32 s39, s67, 7
  s_add_u32 s68, s34, s39
  s_add_u32 s3, s65, s39
  s_lshl_b32 s39, s67, 19
  s_add_u32 s69, s35, s39
  s_add_u32 s67, s67, 1
  s_cmp_eq_u32 s67, 9
  s_cselect_b32 s67, 0, s67
  v_mfma_f32_16x16x32_bf16 v[104:107], a[224:227], a[212:215], v[104:107]
  ds_read_b128 a[168:171], v70 offset:0
  v_mfma_f32_16x16x32_bf16 v[108:111], a[224:227], a[216:219], v[108:111]
  ds_read_b128 a[172:175], v70 offset:2048
  v_mfma_f32_16x16x32_bf16 v[112:115], a[224:227], a[220:223], v[112:115]
  ds_read_b128 a[176:179], v70 offset:4096
  s_add_u32 m0, s61, 34816
  s_nop 0
  buffer_load_dwordx4 v56, s[4:7], s68 offen offset:0 lds
  v_mfma_f32_16x16x32_bf16 v[116:119], a[228:231], a[204:207], v[116:119]
  ds_read_b128 a[180:183], v70 offset:6144
  v_mfma_f32_16x16x32_bf16 v[120:123], a[228:231], a[208:211], v[120:123]
  ds_read_b128 a[184:187], v70 offset:8192
  v_mfma_f32_16x16x32_bf16 v[124:127], a[228:231], a[212:215], v[124:127]
  ds_read_b64_tr_b16 a[192:193], v73 offset:0
  s_add_u32 m0, s61, 38912
  s_add_u32 s39, s68, 36864
  buffer_load_dwordx4 v56, s[4:7], s39 offen offset:0 lds
  v_mfma_f32_16x16x32_bf16 v[128:131], a[228:231], a[216:219], v[128:131]
  ds_read_b64_tr_b16 a[194:195], v73 offset:1024
  v_mfma_f32_16x16x32_bf16 v[132:135], a[228:231], a[220:223], v[132:135]
  ds_read_b64_tr_b16 a[196:197], v74 offset:0
  v_mfma_f32_16x16x32_bf16 v[136:139], a[232:235], a[204:207], v[136:139]
  ds_read_b64_tr_b16 a[198:199], v74 offset:1024
  s_add_u32 m0, s66, 34816
  s_nop 0
  buffer_load_dwordx4 v56, s[4:7], s3 offen offset:0 lds
  v_mfma_f32_16x16x32_bf16 v[140:143], a[232:235], a[208:211], v[140:143]
  ds_read_b64_tr_b16 a[200:201], v75 offset:0
  v_mfma_f32_16x16x32_bf16 v[144:147], a[232:235], a[212:215], v[144:147]
  ds_read_b64_tr_b16 a[202:203], v75 offset:1024
  v_mfma_f32_16x16x32_bf16 v[148:151], a[232:235], a[216:219], v[148:151]
  s_add_u32 m0, s62, 34816
  s_nop 0
  buffer_load_dwordx4 v60, s[8:11], s69 offen offset:0 lds
  v_mfma_f32_16x16x32_bf16 v[152:155], a[232:235], a[220:223], v[152:155]
  v_mfma_f32_16x16x32_bf16 v[156:159], a[236:239], a[204:207], v[156:159]
  v_mfma_f32_16x16x32_bf16 v[160:163], a[236:239], a[208:211], v[160:163]
  buffer_load_dwordx4 v61, s[8:11], s69 offen offset:1024 lds
  v_mfma_f32_16x16x32_bf16 v[164:167], a[236:239], a[212:215], v[164:167]
  v_mfma_f32_16x16x32_bf16 v[168:171], a[236:239], a[216:219], v[168:171]
  v_mfma_f32_16x16x32_bf16 v[172:175], a[236:239], a[220:223], v[172:175]
  s_waitcnt lgkmcnt(0)
  v_mfma_f32_16x16x32_bf16 v[96:99], a[188:191], a[168:171], v[96:99]
  ds_read_b64_tr_b16 a[224:225], v72 offset:8192
  v_mfma_f32_16x16x32_bf16 v[100:103], a[188:191], a[172:175], v[100:103]
  ds_read_b64_tr_b16 a[226:227], v72 offset:9216
  buffer_load_dwordx4 v62, s[8:11], s69 offen offset:2048 lds
  v_mfma_f32_16x16x32_bf16 v[104:107], a[188:191], a[176:179], v[104:107]
  ds_read_b128 a[204:207], v71 offset:0
  v_mfma_f32_16x16x32_bf16 v[108:111], a[188:191], a[180:183], v[108:111]
  ds_read_b128 a[208:211], v71 offset:2048
  v_mfma_f32_16x16x32_bf16 v[112:115], a[188:191], a[184:187], v[112:115]
  ds_read_b128 a[212:215], v71 offset:4096
  buffer_load_dwordx4 v63, s[8:11], s69 offen offset:3072 lds
  v_mfma_f32_16x16x32_bf16 v[116:119], a[192:195], a[168:171], v[116:119]
  ds_read_b128 a[216:219], v71 offset:6144
  v_mfma_f32_16x16x32_bf16 v[120:123], a[192:195], a[172:175], v[120:123]
  ds_read_b128 a[220:223], v71 offset:8192
  v_mfma_f32_16x16x32_bf16 v[124:127], a[192:195], a[176:179], v[124:127]
  ds_read_b64_tr_b16 a[228:229], v73 offset:8192
  s_add_u32 m0, s62, 38912
  s_add_u32 s69, s69, 131072
  buffer_load_dwordx4 v60, s[8:11], s69 offen offset:0 lds
  v_mfma_f32_16x16x32_bf16 v[128:131], a[192:195], a[180:183], v[128:131]
  ds_read_b64_tr_b16 a[230:231], v73 offset:9216
  v_mfma_f32_16x16x32_bf16 v[132:135], a[192:195], a[184:187], v[132:135]
  ds_read_b64_tr_b16 a[232:233], v74 offset:8192
  v_mfma_f32_16x16x32_bf16 v[136:139], a[196:199], a[168:171], v[136:139]
  ds_read_b64_tr_b16 a[234:235], v74 offset:9216
  buffer_load_dwordx4 v61, s[8:11], s69 offen offset:1024 lds
  v_mfma_f32_16x16x32_bf16 v[140:143], a[196:199], a[172:175], v[140:143]
  ds_read_b64_tr_b16 a[236:237], v75 offset:8192
  v_mfma_f32_16x16x32_bf16 v[144:147], a[196:199], a[176:179], v[144:147]
  ds_read_b64_tr_b16 a[238:239], v75 offset:9216
  v_mfma_f32_16x16x32_bf16 v[148:151], a[196:199], a[180:183], v[148:151]
  buffer_load_dwordx4 v62, s[8:11], s69 offen offset:2048 lds
  v_mfma_f32_16x16x32_bf16 v[152:155], a[196:199], a[184:187], v[152:155]
  v_mfma_f32_16x16x32_bf16 v[156:159], a[200:203], a[168:171], v[156:159]
  v_mfma_f32_16x16x32_bf16 v[160:163], a[200:203], a[172:175], v[160:163]
  buffer_load_dwordx4 v63, s[8:11], s69 offen offset:3072 lds
  v_mfma_f32_16x16x32_bf16 v[164:167], a[200:203], a[176:179], v[164:167]
  v_mfma_f32_16x16x32_bf16 v[168:171], a[200:203], a[180:183], v[168:171]
  v_mfma_f32_16x16x32_bf16 v[172:175], a[200:203], a[184:187], v[172:175]
  s_waitcnt vmcnt(11)
  s_waitcnt lgkmcnt(0)
  s_barrier
  v_mfma_f32_16x16x32_bf16 v[96:99], a[224:227], a[204:207], v[96:99]
  ds_read_b64_tr_b16 a[188:189], v78 offset:0
  v_mfma_f32_16x16x32_bf16 v[100:103], a[224:227], a[208:211], v[100:103]
  ds_read_b64_tr_b16 a[190:191], v78 offset:1024
  s_lshl_b32 s39, s67, 7
  s_add_u32 s68, s34, s39
  s_add_u32 s3, s65, s39
  s_lshl_b32 s39, s67, 19
  s_add_u32 s69, s35, s39
  s_add_u32 s67, s67, 1
  s_cmp_eq_u32 s67, 9
  s_cselect_b32 s67, 0, s67
  v_mfma_f32_16x16x32_bf16 v[104:107], a[224:227], a[212:215], v[104:107]
  ds_read_b128 a[168:171], v76 offset:0
  v_mfma_f32_16x16x32_bf16 v[108:111], a[224:227], a[216:219], v[108:111]
  ds_read_b128 a[172:175], v76 offset:2048
  v_mfma_f32_16x16x32_bf16 v[112:115], a[224:227], a[220:223], v[112:115]
  ds_read_b128 a[176:179], v76 offset:4096
  s_add_u32 m0, s61, 77824
  s_nop 0
  buffer_load_dwordx4 v56, s[4:7], s68 offen offset:0 lds
  v_mfma_f32_16x16x32_bf16 v[116:119], a[228:231], a[204:207], v[116:119]
  ds_read_b128 a[180:183], v76 offset:6144
  v_mfma_f32_16x16x32_bf16 v[120:123], a[228:231], a[208:211], v[120:123]
  ds_read_b128 a[184:187], v76 offset:8192
  v_mfma_f32_16x16x32_bf16 v[124:127], a[228:231], a[212:215], v[124:127]
  ds_read_b64_tr_b16 a[192:193], v79 offset:0
  s_add_u32 m0, s61, 81920
  s_add_u32 s39, s68, 36864
  buffer_load_dwordx4 v56, s[4:7], s39 offen offset:0 lds
  v_mfma_f32_16x16x32_bf16 v[128:131], a[228:231], a[216:219], v[128:131]
  ds_read_b64_tr_b16 a[194:195], v79 offset:1024
  v_mfma_f32_16x16x32_bf16 v[132:135], a[228:231], a[220:223], v[132:135]
  ds_read_b64_tr_b16 a[196:197], v80 offset:0
  v_mfma_f32_16x16x32_bf16 v[136:139], a[232:235], a[204:207], v[136:139]
  ds_read_b64_tr_b16 a[198:199], v80 offset:1024
  s_add_u32 m0, s66, 77824
  s_nop 0
  buffer_load_dwordx4 v56, s[4:7], s3 offen offset:0 lds
  v_mfma_f32_16x16x32_bf16 v[140:143], a[232:235], a[208:211], v[140:143]
  ds_read_b64_tr_b16 a[200:201], v81 offset:0
  v_mfma_f32_16x16x32_bf16 v[144:147], a[232:235], a[212:215], v[144:147]
  ds_read_b64_tr_b16 a[202:203], v81 offset:1024
  v_mfma_f32_16x16x32_bf16 v[148:151], a[232:235], a[216:219], v[148:151]
  s_add_u32 m0, s62, 77824
  s_nop 0
  buffer_load_dwordx4 v60, s[8:11], s69 offen offset:0 lds
  v_mfma_f32_16x16x32_bf16 v[152:155], a[232:235], a[220:223], v[152:155]
  v_mfma_f32_16x16x32_bf16 v[156:159], a[236:239], a[204:207], v[156:159]
  v_mfma_f32_16x16x32_bf16 v[160:163], a[236:239], a[208:211], v[160:163]
  buffer_load_dwordx4 v61, s[8:11], s69 offen offset:1024 lds
  v_mfma_f32_16x16x32_bf16 v[164:167], a[236:239], a[212:215], v[164:167]
  v_mfma_f32_16x16x32_bf16 v[168:171], a[236:239], a[216:219], v[168:171]
  v_mfma_f32_16x16x32_bf16 v[172:175], a[236:239], a[220:223], v[172:175]
  s_waitcnt lgkmcnt(0)
  v_mfma_f32_16x16x32_bf16 v[96:99], a[188:191], a[168:171], v[96:99]
  ds_read_b64_tr_b16 a[224:225], v78 offset:8192
  v_mfma_f32_16x16x32_bf16 v[100:103], a[188:191], a[172:175], v[100:103]
  ds_read_b64_tr_b16 a[226:227], v78 offset:9216
  buffer_load_dwordx4 v62, s[8:11], s69 offen offset:2048 lds
  v_mfma_f32_16x16x32_bf16 v[104:107], a[188:191], a[176:179], v[104:107]
  ds_read_b128 a[204:207], v77 offset:0
  v_mfma_f32_16x16x32_bf16 v[108:111], a[188:191], a[180:183], v[108:111]
  ds_read_b128 a[208:211], v77 offset:2048
  v_mfma_f32_16x16x32_bf16 v[112:115], a[188:191], a[184:187], v[112:115]
  ds_read_b128 a[212:215], v77 offset:4096
  buffer_load_dwordx4 v63, s[8:11], s69 offen offset:3072 lds
  v_mfma_f32_16x16x32_bf16 v[116:119], a[192:195], a[168:171], v[116:119]
  ds_read_b128 a[216:219], v77 offset:6144
  v_mfma_f32_16x16x32_bf16 v[120:123], a[192:195], a[172:175], v[120:123]
  ds_read_b128 a[220:223], v77 offset:8192
  v_mfma_f32_16x16x32_bf16 v[124:127], a[192:195], a[176:179], v[124:127]
  ds_read_b64_tr_b16 a[228:229], v79 offset:8192
  s_add_u32 m0, s62, 81920
  s_add_u32 s69, s69, 131072
  buffer_load_dwordx4 v60, s[8:11], s69 offen offset:0 lds
  v_mfma_f32_16x16x32_bf16 v[128:131], a[192:195], a[180:183], v[128:131]
  ds_read_b64_tr_b16 a[230:231], v79 offset:9216
  v_mfma_f32_16x16x32_bf16 v[132:135], a[192:195], a[184:187], v[132:135]
  ds_read_b64_tr_b16 a[232:233], v80 offset:8192
  v_mfma_f32_16x16x32_bf16 v[136:139], a[196:199], a[168:171], v[136:139]
  ds_read_b64_tr_b16 a[234:235], v80 offset:9216
  buffer_load_dwordx4 v61, s[8:11], s69 offen offset:1024 lds
  v_mfma_f32_16x16x32_bf16 v[140:143], a[196:199], a[172:175], v[140:143]
  ds_read_b64_tr_b16 a[236:237], v81 offset:8192
  v_mfma_f32_16x16x32_bf16 v[144:147], a[196:199], a[176:179], v[144:147]
  ds_read_b64_tr_b16 a[238:239], v81 offset:9216
  v_mfma_f32_16x16x32_bf16 v[148:151], a[196:199], a[180:183], v[148:151]
  buffer_load_dwordx4 v62, s[8:11], s69 offen offset:2048 lds
  v_mfma_f32_16x16x32_bf16 v[152:155], a[196:199], a[184:187], v[152:155]
  v_mfma_f32_16x16x32_bf16 v[156:159], a[200:203], a[168:171], v[156:159]
  v_mfma_f32_16x16x32_bf16 v[160:163], a[200:203], a[172:175], v[160:163]
  buffer_load_dwordx4 v63, s[8:11], s69 offen offset:3072 lds
  v_mfma_f32_16x16x32_bf16 v[164:167], a[200:203], a[176:179], v[164:167]
  v_mfma_f32_16x16x32_bf16 v[168:171], a[200:203], a[180:183], v[168:171]
  v_mfma_f32_16x16x32_bf16 v[172:175], a[200:203], a[184:187], v[172:175]
  s_waitcnt vmcnt(11)
  s_waitcnt lgkmcnt(0)
  s_barrier
  v_mfma_f32_16x16x32_bf16 v[96:99], a[224:227], a[204:207], v[96:99]
  ds_read_b64_tr_b16 a[188:189], v66 offset:0
  v_mfma_f32_16x16x32_bf16 v[100:103], a[224:227], a[208:211], v[100:103]
  ds_read_b64_tr_b16 a[190:191], v66 offset:1024
  s_lshl_b32 s39, s67, 7
  s_add_u32 s68, s34, s39
  s_add_u32 s3, s65, s39
  s_lshl_b32 s39, s67, 19
  s_add_u32 s69, s35, s39
  s_add_u32 s67, s67, 1
  s_cmp_eq_u32 s67, 9
  s_cselect_b32 s67, 0, s67
  v_mfma_f32_16x16x32_bf16 v[104:107], a[224:227], a[212:215], v[104:107]
  ds_read_b128 a[168:171], v64 offset:0
  v_mfma_f32_16x16x32_bf16 v[108:111], a[224:227], a[216:219], v[108:111]
  ds_read_b128 a[172:175], v64 offset:2048
  v_mfma_f32_16x16x32_bf16 v[112:115], a[224:227], a[220:223], v[112:115]
  ds_read_b128 a[176:179], v64 offset:4096
  s_add_u32 m0, s61, 120832
  s_nop 0
  buffer_load_dwordx4 v56, s[4:7], s68 offen offset:0 lds
  v_mfma_f32_16x16x32_bf16 v[116:119], a[228:231], a[204:207], v[116:119]
  ds_read_b128 a[180:183], v64 offset:6144
  v_mfma_f32_16x16x32_bf16 v[120:123], a[228:231], a[208:211], v[120:123]
  ds_read_b128 a[184:187], v64 offset:8192
  v_mfma_f32_16x16x32_bf16 v[124:127], a[228:231], a[212:215], v[124:127]
  ds_read_b64_tr_b16 a[192:193], v67 offset:0
  s_add_u32 m0, s61, 124928
  s_add_u32 s39, s68, 36864
  buffer_load_dwordx4 v56, s[4:7], s39 offen offset:0 lds
  v_mfma_f32_16x16x32_bf16 v[128:131], a[228:231], a[216:219], v[128:131]
  ds_read_b64_tr_b16 a[194:195], v67 offset:1024
  v_mfma_f32_16x16x32_bf16 v[132:135], a[228:231], a[220:223], v[132:135]
  ds_read_b64_tr_b16 a[196:197], v68 offset:0
  v_mfma_f32_16x16x32_bf16 v[136:139], a[232:235], a[204:207], v[136:139]
  ds_read_b64_tr_b16 a[198:199], v68 offset:1024
  s_add_u32 m0, s66, 120832
  s_nop 0
  buffer_load_dwordx4 v56, s[4:7], s3 offen offset:0 lds
  v_mfma_f32_16x16x32_bf16 v[140:143], a[232:235], a[208:211], v[140:143]
  ds_read_b64_tr_b16 a[200:201], v69 offset:0
  v_mfma_f32_16x16x32_bf16 v[144:147], a[232:235], a[212:215], v[144:147]
  ds_read_b64_tr_b16 a[202:203], v69 offset:1024
  v_mfma_f32_16x16x32_bf16 v[148:151], a[232:235], a[216:219], v[148:151]
  s_add_u32 m0, s62, 120832
  s_nop 0
  buffer_load_dwordx4 v60, s[8:11], s69 offen offset:0 lds
  v_mfma_f32_16x16x32_bf16 v[152:155], a[232:235], a[220:223], v[152:155]
  v_mfma_f32_16x16x32_bf16 v[156:159], a[236:239], a[204:207], v[156:159]
  v_mfma_f32_16x16x32_bf16 v[160:163], a[236:239], a[208:211], v[160:163]
  buffer_load_dwordx4 v61, s[8:11], s69 offen offset:1024 lds
  v_mfma_f32_16x16x32_bf16 v[164:167], a[236:239], a[212:215], v[164:167]
  v_mfma_f32_16x16x32_bf16 v[168:171], a[236:239], a[216:219], v[168:171]
  v_mfma_f32_16x16x32_bf16 v[172:175], a[236:239], a[220:223], v[172:175]
  s_waitcnt lgkmcnt(0)
  v_mfma_f32_16x16x32_bf16 v[96:99], a[188:191], a[168:171], v[96:99]
  ds_read_b64_tr_b16 a[224:225], v66 offset:8192
  v_mfma_f32_16x16x32_bf16 v[100:103], a[188:191], a[172:175], v[100:103]
  ds_read_b64_tr_b16 a[226:227], v66 offset:9216
  buffer_load_dwordx4 v62, s[8:11], s69 offen offset:2048 lds
  v_mfma_f32_16x16x32_bf16 v[104:107], a[188:191], a[176:179], v[104:107]
  ds_read_b128 a[204:207], v65 offset:0
  v_mfma_f32_16x16x32_bf16 v[108:111], a[188:191], a[180:183], v[108:111]
  ds_read_b128 a[208:211], v65 offset:2048
  v_mfma_f32_16x16x32_bf16 v[112:115], a[188:191], a[184:187], v[112:115]
  ds_read_b128 a[212:215], v65 offset:4096
  buffer_load_dwordx4 v63, s[8:11], s69 offen offset:3072 lds
  v_mfma_f32_16x16x32_bf16 v[116:119], a[192:195], a[168:171], v[116:119]
  ds_read_b128 a[216:219], v65 offset:6144
  v_mfma_f32_16x16x32_bf16 v[120:123], a[192:195], a[172:175], v[120:123]
  ds_read_b128 a[220:223], v65 offset:8192
  v_mfma_f32_16x16x32_bf16 v[124:127], a[192:195], a[176:179], v[124:127]
  ds_read_b64_tr_b16 a[228:229], v67 offset:8192
  s_add_u32 m0, s62, 124928
  s_add_u32 s69, s69, 131072
  buffer_load_dwordx4 v60, s[8:11], s69 offen offset:0 lds
  v_mfma_f32_16x16x32_bf16 v[128:131], a[192:195], a[180:183], v[128:131]
  ds_read_b64_tr_b16 a[230:231], v67 offset:9216
  v_mfma_f32_16x16x32_bf16 v[132:135], a[192:195], a[184:187], v[132:135]
  ds_read_b64_tr_b16 a[232:233], v68 offset:8192
  v_mfma_f32_16x16x32_bf16 v[136:139], a[196:199], a[168:171], v[136:139]
  ds_read_b64_tr_b16 a[234:235], v68 offset:9216
  buffer_load_dwordx4 v61, s[8:11], s69 offen offset:1024 lds
  v_mfma_f32_16x16x32_bf16 v[140:143], a[196:199], a[172:175], v[140:143]
  ds_read_b64_tr_b16 a[236:237], v69 offset:8192
  v_mfma_f32_16x16x32_bf16 v[144:147], a[196:199], a[176:179], v[144:147]
  ds_read_b64_tr_b16 a[238:239], v69 offset:9216
  v_mfma_f32_16x16x32_bf16 v[148:151], a[196:199], a[180:183], v[148:151]
  buffer_load_dwordx4 v62, s[8:11], s69 offen offset:2048 lds
  v_mfma_f32_16x16x32_bf16 v[152:155], a[196:199], a[184:187], v[152:155]
  v_mfma_f32_16x16x32_bf16 v[156:159], a[200:203], a[168:171], v[156:159]
  v_mfma_f32_16x16x32_bf16 v[160:163], a[200:203], a[172:175], v[160:163]
  buffer_load_dwordx4 v63, s[8:11], s69 offen offset:3072 lds
  v_mfma_f32_16x16x32_bf16 v[164:167], a[200:203], a[176:179], v[164:167]
  v_mfma_f32_16x16x32_bf16 v[168:171], a[200:203], a[180:183], v[168:171]
  v_mfma_f32_16x16x32_bf16 v[172:175], a[200:203], a[184:187], v[172:175]
  s_waitcnt vmcnt(11)
  s_waitcnt lgkmcnt(0)
  s_barrier
  v_mfma_f32_16x16x32_bf16 v[96:99], a[224:227], a[204:207], v[96:99]
  ds_read_b64_tr_b16 a[188:189], v72 offset:0
  v_mfma_f32_16x16x32_bf16 v[100:103], a[224:227], a[208:211], v[100:103]
  ds_read_b64_tr_b16 a[190:191], v72 offset:1024
  s_add_u32 m0, s32, 32768
  s_add_u32 s96, s30, 4096
  buffer_load_dwordx4 v4, s[12:15], s30 offen offset:0 nt lds
  v_mfma_f32_16x16x32_bf16 v[104:107], a[224:227], a[212:215], v[104:107]
  ds_read_b128 a[168:171], v70 offset:0
  v_mfma_f32_16x16x32_bf16 v[108:111], a[224:227], a[216:219], v[108:111]
  ds_read_b128 a[172:175], v70 offset:2048
  v_mfma_f32_16x16x32_bf16 v[112:115], a[224:227], a[220:223], v[112:115]
  ds_read_b128 a[176:179], v70 offset:4096
  v_mfma_f32_16x16x32_bf16 v[116:119], a[228:231], a[204:207], v[116:119]
  ds_read_b128 a[180:183], v70 offset:6144
  buffer_load_dwordx4 v5, s[12:15], s30 offen offset:1024 nt lds
  v_mfma_f32_16x16x32_bf16 v[120:123], a[228:231], a[208:211], v[120:123]
  ds_read_b128 a[184:187], v70 offset:8192
  v_mfma_f32_16x16x32_bf16 v[124:127], a[228:231], a[212:215], v[124:127]
  ds_read_b64_tr_b16 a[192:193], v73 offset:0
  v_mfma_f32_16x16x32_bf16 v[128:131], a[228:231], a[216:219], v[128:131]
  ds_read_b64_tr_b16 a[194:195], v73 offset:1024
  v_mfma_f32_16x16x32_bf16 v[132:135], a[228:231], a[220:223], v[132:135]
  ds_read_b64_tr_b16 a[196:197], v74 offset:0
  v_mfma_f32_16x16x32_bf16 v[136:139], a[232:235], a[204:207], v[136:139]
  ds_read_b64_tr_b16 a[198:199], v74 offset:1024
  buffer_load_dwordx4 v6, s[12:15], s30 offen offset:2048 nt lds
  v_mfma_f32_16x16x32_bf16 v[140:143], a[232:235], a[208:211], v[140:143]
  ds_read_b64_tr_b16 a[200:201], v75 offset:0
  v_mfma_f32_16x16x32_bf16 v[144:147], a[232:235], a[212:215], v[144:147]
  ds_read_b64_tr_b16 a[202:203], v75 offset:1024
  v_mfma_f32_16x16x32_bf16 v[148:151], a[232:235], a[216:219], v[148:151]
  v_mfma_f32_16x16x32_bf16 v[152:155], a[232:235], a[220:223], v[152:155]
  buffer_load_dwordx4 v7, s[12:15], s30 offen offset:3072 nt lds
  v_mfma_f32_16x16x32_bf16 v[156:159], a[236:239], a[204:207], v[156:159]
  v_mfma_f32_16x16x32_bf16 v[160:163], a[236:239], a[208:211], v[160:163]
  v_mfma_f32_16x16x32_bf16 v[164:167], a[236:239], a[212:215], v[164:167]
  v_mfma_f32_16x16x32_bf16 v[168:171], a[236:239], a[216:219], v[168:171]
  v_mfma_f32_16x16x32_bf16 v[172:175], a[236:239], a[220:223], v[172:175]
  s_waitcnt lgkmcnt(0)
  v_mfma_f32_16x16x32_bf16 v[96:99], a[188:191], a[168:171], v[96:99]
  ds_read_b64_tr_b16 a[224:225], v72 offset:8192
  v_mfma_f32_16x16x32_bf16 v[100:103], a[188:191], a[172:175], v[100:103]
  ds_read_b64_tr_b16 a[226:227], v72 offset:9216
  s_add_u32 m0, s32, 36864
  s_add_u32 s30, s30, 16384
  buffer_load_dwordx4 v4, s[12:15], s96 offen offset:0 nt lds
  v_mfma_f32_16x16x32_bf16 v[104:107], a[188:191], a[176:179], v[104:107]
  ds_read_b128 a[204:207], v71 offset:0
  v_mfma_f32_16x16x32_bf16 v[108:111], a[188:191], a[180:183], v[108:111]
  ds_read_b128 a[208:211], v71 offset:2048
  v_mfma_f32_16x16x32_bf16 v[112:115], a[188:191], a[184:187], v[112:115]
  ds_read_b128 a[212:215], v71 offset:4096
  v_mfma_f32_16x16x32_bf16 v[116:119], a[192:195], a[168:171], v[116:119]
  ds_read_b128 a[216:219], v71 offset:6144
  buffer_load_dwordx4 v5, s[12:15], s96 offen offset:1024 nt lds
  v_mfma_f32_16x16x32_bf16 v[120:123], a[192:195], a[172:175], v[120:123]
  ds_read_b128 a[220:223], v71 offset:8192
  v_mfma_f32_16x16x32_bf16 v[124:127], a[192:195], a[176:179], v[124:127]
  ds_read_b64_tr_b16 a[228:229], v73 offset:8192
  v_mfma_f32_16x16x32_bf16 v[128:131], a[192:195], a[180:183], v[128:131]
  ds_read_b64_tr_b16 a[230:231], v73 offset:9216
  v_mfma_f32_16x16x32_bf16 v[132:135], a[192:195], a[184:187], v[132:135]
  ds_read_b64_tr_b16 a[232:233], v74 offset:8192
  v_mfma_f32_16x16x32_bf16 v[136:139], a[196:199], a[168:171], v[136:139]
  ds_read_b64_tr_b16 a[234:235], v74 offset:9216
  buffer_load_dwordx4 v6, s[12:15], s96 offen offset:2048 nt lds
  v_mfma_f32_16x16x32_bf16 v[140:143], a[196:199], a[172:175], v[140:143]
  ds_read_b64_tr_b16 a[236:237], v75 offset:8192
  v_mfma_f32_16x16x32_bf16 v[144:147], a[196:199], a[176:179], v[144:147]
  ds_read_b64_tr_b16 a[238:239], v75 offset:9216
  v_mfma_f32_16x16x32_bf16 v[148:151], a[196:199], a[180:183], v[148:151]
  v_mfma_f32_16x16x32_bf16 v[152:155], a[196:199], a[184:187], v[152:155]
  buffer_load_dwordx4 v7, s[12:15], s96 offen offset:3072 nt lds
  v_mfma_f32_16x16x32_bf16 v[156:159], a[200:203], a[168:171], v[156:159]
  v_mfma_f32_16x16x32_bf16 v[160:163], a[200:203], a[172:175], v[160:163]
  v_mfma_f32_16x16x32_bf16 v[164:167], a[200:203], a[176:179], v[164:167]
  v_mfma_f32_16x16x32_bf16 v[168:171], a[200:203], a[180:183], v[168:171]
  v_mfma_f32_16x16x32_bf16 v[172:175], a[200:203], a[184:187], v[172:175]
  s_waitcnt vmcnt(8)
  s_waitcnt lgkmcnt(0)
  s_barrier
  v_mfma_f32_16x16x32_bf16 v[96:99], a[224:227], a[204:207], v[96:99]
  ds_read_b64_tr_b16 a[188:189], v78 offset:0
  v_mfma_f32_16x16x32_bf16 v[100:103], a[224:227], a[208:211], v[100:103]
  ds_read_b64_tr_b16 a[190:191], v78 offset:1024
  s_add_u32 m0, s33, 0
  s_add_u32 s97, s31, 4096
  buffer_load_dwordx4 v8, s[16:19], s31 offen offset:0 nt lds
  v_mfma_f32_16x16x32_bf16 v[104:107], a[224:227], a[212:215], v[104:107]
  ds_read_b128 a[168:171], v76 offset:0
  v_mfma_f32_16x16x32_bf16 v[108:111], a[224:227], a[216:219], v[108:111]
  ds_read_b128 a[172:175], v76 offset:2048
  v_mfma_f32_16x16x32_bf16 v[112:115], a[224:227], a[220:223], v[112:115]
  ds_read_b128 a[176:179], v76 offset:4096
  v_mfma_f32_16x16x32_bf16 v[116:119], a[228:231], a[204:207], v[116:119]
  ds_read_b128 a[180:183], v76 offset:6144
  buffer_load_dwordx4 v9, s[16:19], s31 offen offset:1024 nt lds
  v_mfma_f32_16x16x32_bf16 v[120:123], a[228:231], a[208:211], v[120:123]
  ds_read_b128 a[184:187], v76 offset:8192
  v_mfma_f32_16x16x32_bf16 v[124:127], a[228:231], a[212:215], v[124:127]
  ds_read_b64_tr_b16 a[192:193], v79 offset:0
  v_mfma_f32_16x16x32_bf16 v[128:131], a[228:231], a[216:219], v[128:131]
  ds_read_b64_tr_b16 a[194:195], v79 offset:1024
  v_mfma_f32_16x16x32_bf16 v[132:135], a[228:231], a[220:223], v[132:135]
  ds_read_b64_tr_b16 a[196:197], v80 offset:0
  v_mfma_f32_16x16x32_bf16 v[136:139], a[232:235], a[204:207], v[136:139]
  ds_read_b64_tr_b16 a[198:199], v80 offset:1024
  buffer_load_dwordx4 v8, s[16:19], s31 offen offset:2048 nt lds
  v_mfma_f32_16x16x32_bf16 v[140:143], a[232:235], a[208:211], v[140:143]
  ds_read_b64_tr_b16 a[200:201], v81 offset:0
  v_mfma_f32_16x16x32_bf16 v[144:147], a[232:235], a[212:215], v[144:147]
  ds_read_b64_tr_b16 a[202:203], v81 offset:1024
  v_mfma_f32_16x16x32_bf16 v[148:151], a[232:235], a[216:219], v[148:151]
  v_mfma_f32_16x16x32_bf16 v[152:155], a[232:235], a[220:223], v[152:155]
  buffer_load_dwordx4 v9, s[16:19], s31 offen offset:3072 nt lds
  v_mfma_f32_16x16x32_bf16 v[156:159], a[236:239], a[204:207], v[156:159]
  v_mfma_f32_16x16x32_bf16 v[160:163], a[236:239], a[208:211], v[160:163]
  v_mfma_f32_16x16x32_bf16 v[164:167], a[236:239], a[212:215], v[164:167]
  v_mfma_f32_16x16x32_bf16 v[168:171], a[236:239], a[216:219], v[168:171]
  v_mfma_f32_16x16x32_bf16 v[172:175], a[236:239], a[220:223], v[172:175]
  s_waitcnt lgkmcnt(0)
  v_mfma_f32_16x16x32_bf16 v[96:99], a[188:191], a[168:171], v[96:99]
  ds_read_b64_tr_b16 a[224:225], v78 offset:8192
  v_mfma_f32_16x16x32_bf16 v[100:103], a[188:191], a[172:175], v[100:103]
  ds_read_b64_tr_b16 a[226:227], v78 offset:9216
  s_add_u32 m0, s33, 4096
  s_add_u32 s31, s31, 16384
  buffer_load_dwordx4 v8, s[16:19], s97 offen offset:0 nt lds
  v_mfma_f32_16x16x32_bf16 v[104:107], a[188:191], a[176:179], v[104:107]
  ds_read_b128 a[204:207], v77 offset:0
  v_mfma_f32_16x16x32_bf16 v[108:111], a[188:191], a[180:183], v[108:111]
  ds_read_b128 a[208:211], v77 offset:2048
  v_mfma_f32_16x16x32_bf16 v[112:115], a[188:191], a[184:187], v[112:115]
  ds_read_b128 a[212:215], v77 offset:4096
  v_mfma_f32_16x16x32_bf16 v[116:119], a[192:195], a[168:171], v[116:119]
  ds_read_b128 a[216:219], v77 offset:6144
  buffer_load_dwordx4 v9, s[16:19], s97 offen offset:1024 nt lds
  v_mfma_f32_16x16x32_bf16 v[120:123], a[192:195], a[172:175], v[120:123]
  ds_read_b128 a[220:223], v77 offset:8192
  v_mfma_f32_16x16x32_bf16 v[124:127], a[192:195], a[176:179], v[124:127]
  ds_read_b64_tr_b16 a[228:229], v79 offset:8192
  v_mfma_f32_16x16x32_bf16 v[128:131], a[192:195], a[180:183], v[128:131]
  ds_read_b64_tr_b16 a[230:231], v79 offset:9216
  v_mfma_f32_16x16x32_bf16 v[132:135], a[192:195], a[184:187], v[132:135]
  ds_read_b64_tr_b16 a[232:233], v80 offset:8192
  v_mfma_f32_16x16x32_bf16 v[136:139], a[196:199], a[168:171], v[136:139]
  ds_read_b64_tr_b16 a[234:235], v80 offset:9216
  buffer_load_dwordx4 v8, s[16:19], s97 offen offset:2048 nt lds
  v_mfma_f32_16x16x32_bf16 v[140:143], a[196:199], a[172:175], v[140:143]
  ds_read_b64_tr_b16 a[236:237], v81 offset:8192
  v_mfma_f32_16x16x32_bf16 v[144:147], a[196:199], a[176:179], v[144:147]
  ds_read_b64_tr_b16 a[238:239], v81 offset:9216
  v_mfma_f32_16x16x32_bf16 v[148:151], a[196:199], a[180:183], v[148:151]
  v_mfma_f32_16x16x32_bf16 v[152:155], a[196:199], a[184:187], v[152:155]
  buffer_load_dwordx4 v9, s[16:19], s97 offen offset:3072 nt lds
  v_mfma_f32_16x16x32_bf16 v[156:159], a[200:203], a[168:171], v[156:159]
  v_mfma_f32_16x16x32_bf16 v[160:163], a[200:203], a[172:175], v[160:163]
  v_mfma_f32_16x16x32_bf16 v[164:167], a[200:203], a[176:179], v[164:167]
  v_mfma_f32_16x16x32_bf16 v[168:171], a[200:203], a[180:183], v[168:171]
  v_mfma_f32_16x16x32_bf16 v[172:175], a[200:203], a[184:187], v[172:175]
  s_waitcnt lgkmcnt(0)
L_concat_heads__gqa_block_cached__mha_block_cached__near_ridge_kernel_qx:
  s_barrier
  s_mul_i32 s39, s24, 10240
  s_add_u32 s39, s39, 122880
  v_lshlrev_b32 v44, 4, v1
  v_add_u32 v48, s39, v44
  s_xor_b32 s38, s24, 1
  s_mul_i32 s38, s38, 10240
  s_add_u32 s38, s38, 122880
  v_add_u32 v49, s38, v44
  v_mov_b32 v52, s28
  v_mov_b32 v53, s28
  v_mfma_f32_16x16x32_bf16 v[96:99], a[224:227], a[204:207], v[96:99]
  v_mfma_f32_16x16x32_bf16 v[116:119], a[228:231], a[204:207], v[116:119]
  v_mfma_f32_16x16x32_bf16 v[100:103], a[224:227], a[208:211], v[100:103]
  v_mfma_f32_16x16x32_bf16 v[120:123], a[228:231], a[208:211], v[120:123]
  v_mfma_f32_16x16x32_bf16 v[104:107], a[224:227], a[212:215], v[104:107]
  v_mfma_f32_16x16x32_bf16 v[124:127], a[228:231], a[212:215], v[124:127]
  v_mfma_f32_16x16x32_bf16 v[108:111], a[224:227], a[216:219], v[108:111]
  v_mfma_f32_16x16x32_bf16 v[128:131], a[228:231], a[216:219], v[128:131]
  v_mfma_f32_16x16x32_bf16 v[112:115], a[224:227], a[220:223], v[112:115]
  v_pk_mul_f32 v[96:97], v[96:97], v[52:53]
  v_pk_mul_f32 v[98:99], v[98:99], v[52:53]
  v_pk_mul_f32 v[116:117], v[116:117], v[52:53]
  v_mfma_f32_16x16x32_bf16 v[132:135], a[228:231], a[220:223], v[132:135]
  v_pk_mul_f32 v[118:119], v[118:119], v[52:53]
  v_cvt_pk_bf16_f32 v96, v96, v97
  v_cvt_pk_bf16_f32 v97, v98, v99
  v_mfma_f32_16x16x32_bf16 v[136:139], a[232:235], a[204:207], v[136:139]
  v_cvt_pk_bf16_f32 v98, v116, v117
  v_cvt_pk_bf16_f32 v99, v118, v119
  ds_write_b128 v48, v[96:99] offset:0
  v_mfma_f32_16x16x32_bf16 v[156:159], a[236:239], a[204:207], v[156:159]
  v_accvgpr_write_b32 a0, v96
  v_accvgpr_write_b32 a1, v97
  v_accvgpr_write_b32 a2, v98
  v_mfma_f32_16x16x32_bf16 v[140:143], a[232:235], a[208:211], v[140:143]
  v_accvgpr_write_b32 a3, v99
  v_pk_mul_f32 v[100:101], v[100:101], v[52:53]
  v_pk_mul_f32 v[102:103], v[102:103], v[52:53]
  v_mfma_f32_16x16x32_bf16 v[160:163], a[236:239], a[208:211], v[160:163]
  v_pk_mul_f32 v[120:121], v[120:121], v[52:53]
  v_pk_mul_f32 v[122:123], v[122:123], v[52:53]
  v_cvt_pk_bf16_f32 v100, v100, v101
  v_mfma_f32_16x16x32_bf16 v[144:147], a[232:235], a[212:215], v[144:147]
  v_cvt_pk_bf16_f32 v101, v102, v103
  v_cvt_pk_bf16_f32 v102, v120, v121
  v_cvt_pk_bf16_f32 v103, v122, v123
  v_mfma_f32_16x16x32_bf16 v[164:167], a[236:239], a[212:215], v[164:167]
  ds_write_b128 v48, v[100:103] offset:2048
  v_accvgpr_write_b32 a16, v100
  v_accvgpr_write_b32 a17, v101
  v_mfma_f32_16x16x32_bf16 v[148:151], a[232:235], a[216:219], v[148:151]
  v_accvgpr_write_b32 a18, v102
  v_accvgpr_write_b32 a19, v103
  v_pk_mul_f32 v[104:105], v[104:105], v[52:53]
  v_mfma_f32_16x16x32_bf16 v[168:171], a[236:239], a[216:219], v[168:171]
  v_pk_mul_f32 v[106:107], v[106:107], v[52:53]
  v_pk_mul_f32 v[124:125], v[124:125], v[52:53]
  v_pk_mul_f32 v[126:127], v[126:127], v[52:53]
  v_mfma_f32_16x16x32_bf16 v[152:155], a[232:235], a[220:223], v[152:155]
  v_cvt_pk_bf16_f32 v104, v104, v105
  v_cvt_pk_bf16_f32 v105, v106, v107
  v_cvt_pk_bf16_f32 v106, v124, v125
  v_mfma_f32_16x16x32_bf16 v[172:175], a[236:239], a[220:223], v[172:175]
  v_cvt_pk_bf16_f32 v107, v126, v127
  ds_write_b128 v48, v[104:107] offset:4096
  v_accvgpr_write_b32 a32, v104
  v_accvgpr_write_b32 a33, v105
  v_accvgpr_write_b32 a34, v106
  v_accvgpr_write_b32 a35, v107
  v_pk_mul_f32 v[108:109], v[108:109], v[52:53]
  v_pk_mul_f32 v[110:111], v[110:111], v[52:53]
  v_pk_mul_f32 v[128:129], v[128:129], v[52:53]
  v_pk_mul_f32 v[130:131], v[130:131], v[52:53]
  v_cvt_pk_bf16_f32 v108, v108, v109
  v_cvt_pk_bf16_f32 v109, v110, v111
  v_cvt_pk_bf16_f32 v110, v128, v129
  v_cvt_pk_bf16_f32 v111, v130, v131
  ds_write_b128 v48, v[108:111] offset:6144
  v_accvgpr_write_b32 a48, v108
  v_accvgpr_write_b32 a49, v109
  v_accvgpr_write_b32 a50, v110
  v_accvgpr_write_b32 a51, v111
  v_pk_mul_f32 v[112:113], v[112:113], v[52:53]
  v_pk_mul_f32 v[114:115], v[114:115], v[52:53]
  v_pk_mul_f32 v[132:133], v[132:133], v[52:53]
  v_pk_mul_f32 v[134:135], v[134:135], v[52:53]
  v_cvt_pk_bf16_f32 v112, v112, v113
  v_cvt_pk_bf16_f32 v113, v114, v115
  v_cvt_pk_bf16_f32 v114, v132, v133
  v_cvt_pk_bf16_f32 v115, v134, v135
  ds_write_b128 v48, v[112:115] offset:8192
  v_accvgpr_write_b32 a64, v112
  v_accvgpr_write_b32 a65, v113
  v_accvgpr_write_b32 a66, v114
  v_accvgpr_write_b32 a67, v115
  v_pk_mul_f32 v[136:137], v[136:137], v[52:53]
  v_pk_mul_f32 v[138:139], v[138:139], v[52:53]
  v_pk_mul_f32 v[156:157], v[156:157], v[52:53]
  v_pk_mul_f32 v[158:159], v[158:159], v[52:53]
  v_cvt_pk_bf16_f32 v136, v136, v137
  v_cvt_pk_bf16_f32 v137, v138, v139
  v_cvt_pk_bf16_f32 v138, v156, v157
  v_cvt_pk_bf16_f32 v139, v158, v159
  ds_write_b128 v48, v[136:139] offset:1024
  v_accvgpr_write_b32 a4, v136
  v_accvgpr_write_b32 a5, v137
  v_accvgpr_write_b32 a6, v138
  v_accvgpr_write_b32 a7, v139
  v_pk_mul_f32 v[140:141], v[140:141], v[52:53]
  v_pk_mul_f32 v[142:143], v[142:143], v[52:53]
  v_pk_mul_f32 v[160:161], v[160:161], v[52:53]
  v_pk_mul_f32 v[162:163], v[162:163], v[52:53]
  v_cvt_pk_bf16_f32 v140, v140, v141
  v_cvt_pk_bf16_f32 v141, v142, v143
  v_cvt_pk_bf16_f32 v142, v160, v161
  v_cvt_pk_bf16_f32 v143, v162, v163
  ds_write_b128 v48, v[140:143] offset:3072
  v_accvgpr_write_b32 a20, v140
  v_accvgpr_write_b32 a21, v141
  v_accvgpr_write_b32 a22, v142
  v_accvgpr_write_b32 a23, v143
  v_pk_mul_f32 v[144:145], v[144:145], v[52:53]
  v_pk_mul_f32 v[146:147], v[146:147], v[52:53]
  v_pk_mul_f32 v[164:165], v[164:165], v[52:53]
  v_pk_mul_f32 v[166:167], v[166:167], v[52:53]
  v_cvt_pk_bf16_f32 v144, v144, v145
  v_cvt_pk_bf16_f32 v145, v146, v147
  v_cvt_pk_bf16_f32 v146, v164, v165
  v_cvt_pk_bf16_f32 v147, v166, v167
  ds_write_b128 v48, v[144:147] offset:5120
  v_accvgpr_write_b32 a36, v144
  v_accvgpr_write_b32 a37, v145
  v_accvgpr_write_b32 a38, v146
  v_accvgpr_write_b32 a39, v147
  v_pk_mul_f32 v[148:149], v[148:149], v[52:53]
  v_pk_mul_f32 v[150:151], v[150:151], v[52:53]
  v_pk_mul_f32 v[168:169], v[168:169], v[52:53]
  v_pk_mul_f32 v[170:171], v[170:171], v[52:53]
  v_cvt_pk_bf16_f32 v148, v148, v149
  v_cvt_pk_bf16_f32 v149, v150, v151
  v_cvt_pk_bf16_f32 v150, v168, v169
  v_cvt_pk_bf16_f32 v151, v170, v171
  ds_write_b128 v48, v[148:151] offset:7168
  v_accvgpr_write_b32 a52, v148
  v_accvgpr_write_b32 a53, v149
  v_accvgpr_write_b32 a54, v150
  v_accvgpr_write_b32 a55, v151
  v_pk_mul_f32 v[152:153], v[152:153], v[52:53]
  v_pk_mul_f32 v[154:155], v[154:155], v[52:53]
  v_pk_mul_f32 v[172:173], v[172:173], v[52:53]
  v_pk_mul_f32 v[174:175], v[174:175], v[52:53]
  v_cvt_pk_bf16_f32 v152, v152, v153
  v_cvt_pk_bf16_f32 v153, v154, v155
  v_cvt_pk_bf16_f32 v154, v172, v173
  v_cvt_pk_bf16_f32 v155, v174, v175
  ds_write_b128 v48, v[152:155] offset:9216
  v_accvgpr_write_b32 a68, v152
  v_accvgpr_write_b32 a69, v153
  v_accvgpr_write_b32 a70, v154
  v_accvgpr_write_b32 a71, v155
  s_waitcnt lgkmcnt(0)
  s_barrier
  ds_read_b128 a[8:11], v49 offset:0
  ds_read_b128 a[12:15], v49 offset:1024
  ds_read_b128 a[24:27], v49 offset:2048
  ds_read_b128 a[28:31], v49 offset:3072
  ds_read_b128 a[40:43], v49 offset:4096
  ds_read_b128 a[44:47], v49 offset:5120
  ds_read_b128 a[56:59], v49 offset:6144
  ds_read_b128 a[60:63], v49 offset:7168
  ds_read_b128 a[72:75], v49 offset:8192
  ds_read_b128 a[76:79], v49 offset:9216
  v_mov_b32 v44, 0x3f803f80
  v_accvgpr_write_b32 a164, v44
  v_accvgpr_write_b32 a165, v44
  v_accvgpr_write_b32 a166, v44
  v_accvgpr_write_b32 a167, v44
  s_waitcnt lgkmcnt(0)
  s_barrier
  s_add_u32 m0, s33, 32768
  s_add_u32 s97, s31, 4096
  buffer_load_dwordx4 v8, s[16:19], s31 offen offset:0 nt lds
  buffer_load_dwordx4 v9, s[16:19], s31 offen offset:1024 nt lds
  buffer_load_dwordx4 v8, s[16:19], s31 offen offset:2048 nt lds
  buffer_load_dwordx4 v9, s[16:19], s31 offen offset:3072 nt lds
  s_add_u32 m0, s33, 36864
  s_add_u32 s31, s31, 16384
  buffer_load_dwordx4 v8, s[16:19], s97 offen offset:0 nt lds
  buffer_load_dwordx4 v9, s[16:19], s97 offen offset:1024 nt lds
  buffer_load_dwordx4 v8, s[16:19], s97 offen offset:2048 nt lds
  buffer_load_dwordx4 v9, s[16:19], s97 offen offset:3072 nt lds
  ds_read_b128 a[80:83], v10 offset:0
  ds_read_b128 a[96:99], v10 offset:4096
  ds_read_b128 a[84:87], v11 offset:0
  ds_read_b128 a[100:103], v11 offset:4096
  ds_read_b128 a[88:91], v12 offset:0
  ds_read_b128 a[104:107], v12 offset:4096
  ds_read_b128 a[92:95], v13 offset:0
  ds_read_b128 a[108:111], v13 offset:4096
  s_waitcnt lgkmcnt(0)
  s_cmp_lg_u32 s27, 0
  s_cbranch_scc1 L_concat_heads__gqa_block_cached__mha_block_cached__near_ridge_kernel_nb1
  s_barrier
L_concat_heads__gqa_block_cached__mha_block_cached__near_ridge_kernel_nb1:
  v_mfma_f32_16x16x32_bf16 v[56:59], a[80:83], a[0:3], 0
  v_mfma_f32_16x16x32_bf16 v[60:63], a[96:99], a[0:3], 0
  s_add_u32 m0, s32, 0
  s_add_u32 s96, s30, 4096
  buffer_load_dwordx4 v4, s[12:15], s30 offen offset:0 nt lds
  v_mfma_f32_16x16x32_bf16 v[56:59], a[84:87], a[4:7], v[56:59]
  v_mfma_f32_16x16x32_bf16 v[60:63], a[100:103], a[4:7], v[60:63]
  v_mfma_f32_16x16x32_bf16 v[56:59], a[88:91], a[8:11], v[56:59]
  buffer_load_dwordx4 v5, s[12:15], s30 offen offset:1024 nt lds
  v_mfma_f32_16x16x32_bf16 v[60:63], a[104:107], a[8:11], v[60:63]
  v_mfma_f32_16x16x32_bf16 v[56:59], a[92:95], a[12:15], v[56:59]
  v_mfma_f32_16x16x32_bf16 v[60:63], a[108:111], a[12:15], v[60:63]
  v_mfma_f32_16x16x32_bf16 v[64:67], a[80:83], a[16:19], 0
  v_mfma_f32_16x16x32_bf16 v[68:71], a[96:99], a[16:19], 0
  buffer_load_dwordx4 v6, s[12:15], s30 offen offset:2048 nt lds
  v_mfma_f32_16x16x32_bf16 v[64:67], a[84:87], a[20:23], v[64:67]
  v_mfma_f32_16x16x32_bf16 v[68:71], a[100:103], a[20:23], v[68:71]
  v_mfma_f32_16x16x32_bf16 v[64:67], a[88:91], a[24:27], v[64:67]
  buffer_load_dwordx4 v7, s[12:15], s30 offen offset:3072 nt lds
  v_mfma_f32_16x16x32_bf16 v[68:71], a[104:107], a[24:27], v[68:71]
  v_mfma_f32_16x16x32_bf16 v[64:67], a[92:95], a[28:31], v[64:67]
  v_mfma_f32_16x16x32_bf16 v[68:71], a[108:111], a[28:31], v[68:71]
  v_mfma_f32_16x16x32_bf16 v[72:75], a[80:83], a[32:35], 0
  v_mfma_f32_16x16x32_bf16 v[76:79], a[96:99], a[32:35], 0
  s_add_u32 m0, s32, 4096
  s_add_u32 s30, s30, 16384
  buffer_load_dwordx4 v4, s[12:15], s96 offen offset:0 nt lds
  v_mfma_f32_16x16x32_bf16 v[72:75], a[84:87], a[36:39], v[72:75]
  buffer_load_dwordx4 v5, s[12:15], s96 offen offset:1024 nt lds
  v_mfma_f32_16x16x32_bf16 v[76:79], a[100:103], a[36:39], v[76:79]
  v_max3_f32 v44, v56, v57, v58
  v_mfma_f32_16x16x32_bf16 v[72:75], a[88:91], a[40:43], v[72:75]
  v_max3_f32 v44, v44, v59, v60
  v_mfma_f32_16x16x32_bf16 v[76:79], a[104:107], a[40:43], v[76:79]
  v_max3_f32 v44, v44, v61, v62
  v_mfma_f32_16x16x32_bf16 v[72:75], a[92:95], a[44:47], v[72:75]
  v_max_f32 v44, v44, v63
  v_mfma_f32_16x16x32_bf16 v[76:79], a[108:111], a[44:47], v[76:79]
  v_mfma_f32_16x16x32_bf16 v[80:83], a[80:83], a[48:51], 0
  v_mfma_f32_16x16x32_bf16 v[84:87], a[96:99], a[48:51], 0
  buffer_load_dwordx4 v6, s[12:15], s96 offen offset:2048 nt lds
  v_mfma_f32_16x16x32_bf16 v[80:83], a[84:87], a[52:55], v[80:83]
  buffer_load_dwordx4 v7, s[12:15], s96 offen offset:3072 nt lds
  v_mfma_f32_16x16x32_bf16 v[84:87], a[100:103], a[52:55], v[84:87]
  v_max3_f32 v45, v64, v65, v66
  v_mfma_f32_16x16x32_bf16 v[80:83], a[88:91], a[56:59], v[80:83]
  v_max3_f32 v45, v45, v67, v68
  v_mfma_f32_16x16x32_bf16 v[84:87], a[104:107], a[56:59], v[84:87]
  v_max3_f32 v45, v45, v69, v70
  v_mfma_f32_16x16x32_bf16 v[80:83], a[92:95], a[60:63], v[80:83]
  v_max_f32 v45, v45, v71
  v_mfma_f32_16x16x32_bf16 v[84:87], a[108:111], a[60:63], v[84:87]
  s_waitcnt vmcnt(16)
  v_mfma_f32_16x16x32_bf16 v[88:91], a[80:83], a[64:67], 0
  v_max3_f32 v46, v72, v73, v74
  v_max3_f32 v46, v46, v75, v76
  v_mfma_f32_16x16x32_bf16 v[92:95], a[96:99], a[64:67], 0
  ds_read_b64_tr_b16 a[112:113], v14 offset:0
  v_mfma_f32_16x16x32_bf16 v[88:91], a[84:87], a[68:71], v[88:91]
  ds_read_b64_tr_b16 a[114:115], v14 offset:4096
  ds_read_b64_tr_b16 a[116:117], v15 offset:0
  v_mfma_f32_16x16x32_bf16 v[92:95], a[100:103], a[68:71], v[92:95]
  ds_read_b64_tr_b16 a[118:119], v15 offset:4096
  v_mfma_f32_16x16x32_bf16 v[88:91], a[88:91], a[72:75], v[88:91]
  v_max3_f32 v46, v46, v77, v78
  v_max_f32 v46, v46, v79
  v_mfma_f32_16x16x32_bf16 v[92:95], a[104:107], a[72:75], v[92:95]
  ds_read_b64_tr_b16 a[120:121], v16 offset:0
  v_mfma_f32_16x16x32_bf16 v[88:91], a[92:95], a[76:79], v[88:91]
  ds_read_b64_tr_b16 a[122:123], v16 offset:4096
  ds_read_b64_tr_b16 a[124:125], v17 offset:0
  v_mfma_f32_16x16x32_bf16 v[92:95], a[108:111], a[76:79], v[92:95]
  ds_read_b64_tr_b16 a[126:127], v17 offset:4096
  ds_read_b64_tr_b16 a[128:129], v18 offset:0
  ds_read_b64_tr_b16 a[130:131], v18 offset:4096
  ds_read_b64_tr_b16 a[132:133], v19 offset:0
  ds_read_b64_tr_b16 a[134:135], v19 offset:4096
  ds_read_b64_tr_b16 a[136:137], v20 offset:0
  ds_read_b64_tr_b16 a[138:139], v20 offset:4096
  ds_read_b64_tr_b16 a[140:141], v21 offset:0
  ds_read_b64_tr_b16 a[142:143], v21 offset:4096
  v_max3_f32 v47, v80, v81, v82
  v_max3_f32 v47, v47, v83, v84
  v_max3_f32 v47, v47, v85, v86
  v_max_f32 v47, v47, v87
  v_max3_f32 v48, v88, v89, v90
  v_max3_f32 v48, v48, v91, v92
  v_max3_f32 v48, v48, v93, v94
  v_max_f32 v48, v48, v95
  v_mov_b32 v24, v44
  v_mov_b32 v28, v45
  v_mov_b32 v32, v46
  v_mov_b32 v36, v47
  v_mov_b32 v40, v48
  v_permlane16_swap_b32 v44, v24
  v_permlane16_swap_b32 v45, v28
  v_permlane16_swap_b32 v46, v32
  v_permlane16_swap_b32 v47, v36
  v_permlane16_swap_b32 v48, v40
  v_max_f32 v44, v44, v24
  v_max_f32 v45, v45, v28
  v_max_f32 v46, v46, v32
  v_max_f32 v47, v47, v36
  v_max_f32 v48, v48, v40
  v_mov_b32 v24, v44
  v_mov_b32 v28, v45
  v_mov_b32 v32, v46
  v_mov_b32 v36, v47
  v_mov_b32 v40, v48
  v_permlane32_swap_b32 v44, v24
  v_permlane32_swap_b32 v45, v28
  v_permlane32_swap_b32 v46, v32
  v_permlane32_swap_b32 v47, v36
  v_permlane32_swap_b32 v48, v40
  v_max_f32 v44, v44, v24
  v_max_f32 v45, v45, v28
  v_max_f32 v46, v46, v32
  v_max_f32 v47, v47, v36
  v_max_f32 v48, v48, v40
  v_sub_f32 v56, v56, v44
  v_sub_f32 v57, v57, v44
  v_sub_f32 v58, v58, v44
  v_sub_f32 v59, v59, v44
  v_sub_f32 v60, v60, v44
  v_sub_f32 v61, v61, v44
  v_sub_f32 v62, v62, v44
  v_sub_f32 v63, v63, v44
  v_sub_f32 v24, 0, v44
  v_sub_f32 v25, 0, v44
  v_sub_f32 v26, 0, v44
  v_sub_f32 v27, 0, v44
  v_sub_f32 v64, v64, v45
  v_sub_f32 v65, v65, v45
  v_sub_f32 v66, v66, v45
  v_sub_f32 v67, v67, v45
  v_sub_f32 v68, v68, v45
  v_sub_f32 v69, v69, v45
  v_sub_f32 v70, v70, v45
  v_sub_f32 v71, v71, v45
  v_sub_f32 v28, 0, v45
  v_sub_f32 v29, 0, v45
  v_sub_f32 v30, 0, v45
  v_sub_f32 v31, 0, v45
  v_sub_f32 v72, v72, v46
  v_sub_f32 v73, v73, v46
  v_sub_f32 v74, v74, v46
  v_sub_f32 v75, v75, v46
  v_sub_f32 v76, v76, v46
  v_sub_f32 v77, v77, v46
  v_sub_f32 v78, v78, v46
  v_sub_f32 v79, v79, v46
  v_sub_f32 v32, 0, v46
  v_sub_f32 v33, 0, v46
  v_sub_f32 v34, 0, v46
  v_sub_f32 v35, 0, v46
  v_sub_f32 v80, v80, v47
  v_sub_f32 v81, v81, v47
  v_sub_f32 v82, v82, v47
  v_sub_f32 v83, v83, v47
  v_sub_f32 v84, v84, v47
  v_sub_f32 v85, v85, v47
  v_sub_f32 v86, v86, v47
  v_sub_f32 v87, v87, v47
  v_sub_f32 v36, 0, v47
  v_sub_f32 v37, 0, v47
  v_sub_f32 v38, 0, v47
  v_sub_f32 v39, 0, v47
  v_sub_f32 v88, v88, v48
  v_sub_f32 v89, v89, v48
  v_sub_f32 v90, v90, v48
  v_sub_f32 v91, v91, v48
  v_sub_f32 v92, v92, v48
  v_sub_f32 v93, v93, v48
  v_sub_f32 v94, v94, v48
  v_sub_f32 v95, v95, v48
  v_sub_f32 v40, 0, v48
  v_sub_f32 v41, 0, v48
  v_sub_f32 v42, 0, v48
  v_sub_f32 v43, 0, v48
  v_exp_f32 v56, v56
  v_exp_f32 v57, v57
  v_exp_f32 v58, v58
  v_exp_f32 v59, v59
  v_exp_f32 v60, v60
  v_exp_f32 v61, v61
  v_exp_f32 v62, v62
  v_exp_f32 v63, v63
  v_cvt_pk_bf16_f32 v56, v56, v57
  v_cvt_pk_bf16_f32 v57, v58, v59
  v_cvt_pk_bf16_f32 v58, v60, v61
  v_cvt_pk_bf16_f32 v59, v62, v63
  s_waitcnt lgkmcnt(0)
  s_nop 0
  v_mfma_f32_16x16x32_bf16 v[96:99], a[112:115], v[56:59], 0
  v_exp_f32 v64, v64
  v_exp_f32 v65, v65
  v_mfma_f32_16x16x32_bf16 v[116:119], a[116:119], v[56:59], 0
  v_exp_f32 v66, v66
  v_exp_f32 v67, v67
  v_mfma_f32_16x16x32_bf16 v[136:139], a[120:123], v[56:59], 0
  s_add_u32 m0, s33, 0
  s_add_u32 s97, s31, 4096
  buffer_load_dwordx4 v8, s[16:19], s31 offen offset:0 nt lds
  v_exp_f32 v68, v68
  v_mfma_f32_16x16x32_bf16 v[156:159], a[124:127], v[56:59], 0
  v_exp_f32 v69, v69
  v_exp_f32 v70, v70
  v_mfma_f32_16x16x32_bf16 v[176:179], a[128:131], v[56:59], 0
  v_exp_f32 v71, v71
  buffer_load_dwordx4 v9, s[16:19], s31 offen offset:1024 nt lds
  v_mfma_f32_16x16x32_bf16 v[196:199], a[132:135], v[56:59], 0
  v_cvt_pk_bf16_f32 v64, v64, v65
  v_cvt_pk_bf16_f32 v65, v66, v67
  v_mfma_f32_16x16x32_bf16 v[216:219], a[136:139], v[56:59], 0
  v_cvt_pk_bf16_f32 v66, v68, v69
  v_cvt_pk_bf16_f32 v67, v70, v71
  v_mfma_f32_16x16x32_bf16 v[236:239], a[140:143], v[56:59], 0
  v_mfma_f32_16x16x32_bf16 a[144:147], a[164:167], v[56:59], 0
  v_mfma_f32_16x16x32_bf16 v[100:103], a[112:115], v[64:67], 0
  v_exp_f32 v72, v72
  v_exp_f32 v73, v73
  v_mfma_f32_16x16x32_bf16 v[120:123], a[116:119], v[64:67], 0
  v_exp_f32 v74, v74
  v_exp_f32 v75, v75
  v_mfma_f32_16x16x32_bf16 v[140:143], a[120:123], v[64:67], 0
  buffer_load_dwordx4 v8, s[16:19], s31 offen offset:2048 nt lds
  v_exp_f32 v76, v76
  v_mfma_f32_16x16x32_bf16 v[160:163], a[124:127], v[64:67], 0
  v_exp_f32 v77, v77
  v_exp_f32 v78, v78
  v_mfma_f32_16x16x32_bf16 v[180:183], a[128:131], v[64:67], 0
  v_exp_f32 v79, v79
  buffer_load_dwordx4 v9, s[16:19], s31 offen offset:3072 nt lds
  v_mfma_f32_16x16x32_bf16 v[200:203], a[132:135], v[64:67], 0
  v_cvt_pk_bf16_f32 v72, v72, v73
  v_cvt_pk_bf16_f32 v73, v74, v75
  v_mfma_f32_16x16x32_bf16 v[220:223], a[136:139], v[64:67], 0
  v_cvt_pk_bf16_f32 v74, v76, v77
  v_cvt_pk_bf16_f32 v75, v78, v79
  v_mfma_f32_16x16x32_bf16 v[240:243], a[140:143], v[64:67], 0
  v_mfma_f32_16x16x32_bf16 a[148:151], a[164:167], v[64:67], 0
  v_mfma_f32_16x16x32_bf16 v[104:107], a[112:115], v[72:75], 0
  v_exp_f32 v80, v80
  v_exp_f32 v81, v81
  v_mfma_f32_16x16x32_bf16 v[124:127], a[116:119], v[72:75], 0
  v_exp_f32 v82, v82
  v_exp_f32 v83, v83
  v_mfma_f32_16x16x32_bf16 v[144:147], a[120:123], v[72:75], 0
  s_add_u32 m0, s33, 4096
  s_add_u32 s31, s31, 16384
  buffer_load_dwordx4 v8, s[16:19], s97 offen offset:0 nt lds
  v_exp_f32 v84, v84
  v_mfma_f32_16x16x32_bf16 v[164:167], a[124:127], v[72:75], 0
  v_exp_f32 v85, v85
  v_exp_f32 v86, v86
  v_mfma_f32_16x16x32_bf16 v[184:187], a[128:131], v[72:75], 0
  v_exp_f32 v87, v87
  buffer_load_dwordx4 v9, s[16:19], s97 offen offset:1024 nt lds
  v_mfma_f32_16x16x32_bf16 v[204:207], a[132:135], v[72:75], 0
  v_cvt_pk_bf16_f32 v80, v80, v81
  v_cvt_pk_bf16_f32 v81, v82, v83
  v_mfma_f32_16x16x32_bf16 v[224:227], a[136:139], v[72:75], 0
  v_cvt_pk_bf16_f32 v82, v84, v85
  v_cvt_pk_bf16_f32 v83, v86, v87
  v_mfma_f32_16x16x32_bf16 v[244:247], a[140:143], v[72:75], 0
  v_mfma_f32_16x16x32_bf16 a[152:155], a[164:167], v[72:75], 0
  v_mfma_f32_16x16x32_bf16 v[108:111], a[112:115], v[80:83], 0
  v_exp_f32 v88, v88
  v_exp_f32 v89, v89
  v_mfma_f32_16x16x32_bf16 v[128:131], a[116:119], v[80:83], 0
  v_exp_f32 v90, v90
  v_exp_f32 v91, v91
  v_mfma_f32_16x16x32_bf16 v[148:151], a[120:123], v[80:83], 0
  buffer_load_dwordx4 v8, s[16:19], s97 offen offset:2048 nt lds
  v_exp_f32 v92, v92
  v_mfma_f32_16x16x32_bf16 v[168:171], a[124:127], v[80:83], 0
  v_exp_f32 v93, v93
  v_exp_f32 v94, v94
  v_mfma_f32_16x16x32_bf16 v[188:191], a[128:131], v[80:83], 0
  v_exp_f32 v95, v95
  buffer_load_dwordx4 v9, s[16:19], s97 offen offset:3072 nt lds
  v_mfma_f32_16x16x32_bf16 v[208:211], a[132:135], v[80:83], 0
  v_cvt_pk_bf16_f32 v88, v88, v89
  v_cvt_pk_bf16_f32 v89, v90, v91
  v_mfma_f32_16x16x32_bf16 v[228:231], a[136:139], v[80:83], 0
  v_cvt_pk_bf16_f32 v90, v92, v93
  v_cvt_pk_bf16_f32 v91, v94, v95
  v_mfma_f32_16x16x32_bf16 v[248:251], a[140:143], v[80:83], 0
  v_mfma_f32_16x16x32_bf16 a[156:159], a[164:167], v[80:83], 0
  ds_read_b128 a[80:83], v10 offset:32768
  ds_read_b128 a[96:99], v10 offset:36864
  ds_read_b128 a[84:87], v11 offset:32768
  ds_read_b128 a[100:103], v11 offset:36864
  ds_read_b128 a[88:91], v12 offset:32768
  ds_read_b128 a[104:107], v12 offset:36864
  ds_read_b128 a[92:95], v13 offset:32768
  ds_read_b128 a[108:111], v13 offset:36864
  v_mfma_f32_16x16x32_bf16 v[112:115], a[112:115], v[88:91], 0
  v_mfma_f32_16x16x32_bf16 v[132:135], a[116:119], v[88:91], 0
  v_mfma_f32_16x16x32_bf16 v[152:155], a[120:123], v[88:91], 0
  v_mfma_f32_16x16x32_bf16 v[172:175], a[124:127], v[88:91], 0
  v_mfma_f32_16x16x32_bf16 v[192:195], a[128:131], v[88:91], 0
  v_mfma_f32_16x16x32_bf16 v[212:215], a[132:135], v[88:91], 0
  v_mfma_f32_16x16x32_bf16 v[232:235], a[136:139], v[88:91], 0
  v_mfma_f32_16x16x32_bf16 v[252:255], a[140:143], v[88:91], 0
  v_mfma_f32_16x16x32_bf16 a[160:163], a[164:167], v[88:91], 0
  s_waitcnt lgkmcnt(0)
  s_cmp_lg_u32 s27, 0
  s_cbranch_scc1 L_concat_heads__gqa_block_cached__mha_block_cached__near_ridge_kernel_nb2
  s_barrier
L_concat_heads__gqa_block_cached__mha_block_cached__near_ridge_kernel_nb2:
  v_mfma_f32_16x16x32_bf16 v[56:59], a[80:83], a[0:3], v[24:27]
  v_mfma_f32_16x16x32_bf16 v[60:63], a[96:99], a[0:3], v[24:27]
  s_add_u32 m0, s32, 32768
  s_add_u32 s96, s30, 4096
  buffer_load_dwordx4 v4, s[12:15], s30 offen offset:0 nt lds
  v_mfma_f32_16x16x32_bf16 v[56:59], a[84:87], a[4:7], v[56:59]
  v_mfma_f32_16x16x32_bf16 v[60:63], a[100:103], a[4:7], v[60:63]
  v_mfma_f32_16x16x32_bf16 v[56:59], a[88:91], a[8:11], v[56:59]
  buffer_load_dwordx4 v5, s[12:15], s30 offen offset:1024 nt lds
  v_mfma_f32_16x16x32_bf16 v[60:63], a[104:107], a[8:11], v[60:63]
  v_mfma_f32_16x16x32_bf16 v[56:59], a[92:95], a[12:15], v[56:59]
  v_mfma_f32_16x16x32_bf16 v[60:63], a[108:111], a[12:15], v[60:63]
  v_mfma_f32_16x16x32_bf16 v[64:67], a[80:83], a[16:19], v[28:31]
  v_mfma_f32_16x16x32_bf16 v[68:71], a[96:99], a[16:19], v[28:31]
  buffer_load_dwordx4 v6, s[12:15], s30 offen offset:2048 nt lds
  v_mfma_f32_16x16x32_bf16 v[64:67], a[84:87], a[20:23], v[64:67]
  v_mfma_f32_16x16x32_bf16 v[68:71], a[100:103], a[20:23], v[68:71]
  v_mfma_f32_16x16x32_bf16 v[64:67], a[88:91], a[24:27], v[64:67]
  buffer_load_dwordx4 v7, s[12:15], s30 offen offset:3072 nt lds
  v_mfma_f32_16x16x32_bf16 v[68:71], a[104:107], a[24:27], v[68:71]
  v_mfma_f32_16x16x32_bf16 v[64:67], a[92:95], a[28:31], v[64:67]
  v_mfma_f32_16x16x32_bf16 v[68:71], a[108:111], a[28:31], v[68:71]
  v_mfma_f32_16x16x32_bf16 v[72:75], a[80:83], a[32:35], v[32:35]
  v_mfma_f32_16x16x32_bf16 v[76:79], a[96:99], a[32:35], v[32:35]
  s_add_u32 m0, s32, 36864
  s_add_u32 s30, s30, 16384
  buffer_load_dwordx4 v4, s[12:15], s96 offen offset:0 nt lds
  v_mfma_f32_16x16x32_bf16 v[72:75], a[84:87], a[36:39], v[72:75]
  buffer_load_dwordx4 v5, s[12:15], s96 offen offset:1024 nt lds
  v_mfma_f32_16x16x32_bf16 v[76:79], a[100:103], a[36:39], v[76:79]
  v_max3_f32 v44, v56, v57, v58
  v_mfma_f32_16x16x32_bf16 v[72:75], a[88:91], a[40:43], v[72:75]
  v_max3_f32 v44, v44, v59, v60
  v_mfma_f32_16x16x32_bf16 v[76:79], a[104:107], a[40:43], v[76:79]
  v_max3_f32 v44, v44, v61, v62
  v_mfma_f32_16x16x32_bf16 v[72:75], a[92:95], a[44:47], v[72:75]
  v_max_f32 v44, v44, v63
  v_mfma_f32_16x16x32_bf16 v[76:79], a[108:111], a[44:47], v[76:79]
  v_mfma_f32_16x16x32_bf16 v[80:83], a[80:83], a[48:51], v[36:39]
  v_mfma_f32_16x16x32_bf16 v[84:87], a[96:99], a[48:51], v[36:39]
  buffer_load_dwordx4 v6, s[12:15], s96 offen offset:2048 nt lds
  v_mfma_f32_16x16x32_bf16 v[80:83], a[84:87], a[52:55], v[80:83]
  buffer_load_dwordx4 v7, s[12:15], s96 offen offset:3072 nt lds
  v_mfma_f32_16x16x32_bf16 v[84:87], a[100:103], a[52:55], v[84:87]
  v_max3_f32 v45, v64, v65, v66
  v_mfma_f32_16x16x32_bf16 v[80:83], a[88:91], a[56:59], v[80:83]
  v_max3_f32 v45, v45, v67, v68
  v_mfma_f32_16x16x32_bf16 v[84:87], a[104:107], a[56:59], v[84:87]
  v_max3_f32 v45, v45, v69, v70
  v_mfma_f32_16x16x32_bf16 v[80:83], a[92:95], a[60:63], v[80:83]
  v_max_f32 v45, v45, v71
  v_mfma_f32_16x16x32_bf16 v[84:87], a[108:111], a[60:63], v[84:87]
  s_waitcnt vmcnt(24)
  v_mfma_f32_16x16x32_bf16 v[88:91], a[80:83], a[64:67], v[40:43]
  v_max3_f32 v46, v72, v73, v74
  v_max3_f32 v46, v46, v75, v76
  v_mfma_f32_16x16x32_bf16 v[92:95], a[96:99], a[64:67], v[40:43]
  ds_read_b64_tr_b16 a[112:113], v14 offset:32768
  v_mfma_f32_16x16x32_bf16 v[88:91], a[84:87], a[68:71], v[88:91]
  ds_read_b64_tr_b16 a[114:115], v14 offset:36864
  ds_read_b64_tr_b16 a[116:117], v15 offset:32768
  v_mfma_f32_16x16x32_bf16 v[92:95], a[100:103], a[68:71], v[92:95]
  ds_read_b64_tr_b16 a[118:119], v15 offset:36864
  v_mfma_f32_16x16x32_bf16 v[88:91], a[88:91], a[72:75], v[88:91]
  v_max3_f32 v46, v46, v77, v78
  v_max_f32 v46, v46, v79
  v_mfma_f32_16x16x32_bf16 v[92:95], a[104:107], a[72:75], v[92:95]
  ds_read_b64_tr_b16 a[120:121], v16 offset:32768
  v_mfma_f32_16x16x32_bf16 v[88:91], a[92:95], a[76:79], v[88:91]
  ds_read_b64_tr_b16 a[122:123], v16 offset:36864
  ds_read_b64_tr_b16 a[124:125], v17 offset:32768
  v_mfma_f32_16x16x32_bf16 v[92:95], a[108:111], a[76:79], v[92:95]
  ds_read_b64_tr_b16 a[126:127], v17 offset:36864
  ds_read_b64_tr_b16 a[128:129], v18 offset:32768
  ds_read_b64_tr_b16 a[130:131], v18 offset:36864
  ds_read_b64_tr_b16 a[132:133], v19 offset:32768
  ds_read_b64_tr_b16 a[134:135], v19 offset:36864
  ds_read_b64_tr_b16 a[136:137], v20 offset:32768
  ds_read_b64_tr_b16 a[138:139], v20 offset:36864
  ds_read_b64_tr_b16 a[140:141], v21 offset:32768
  ds_read_b64_tr_b16 a[142:143], v21 offset:36864
  v_max3_f32 v47, v80, v81, v82
  v_max3_f32 v47, v47, v83, v84
  v_max3_f32 v47, v47, v85, v86
  v_max_f32 v47, v47, v87
  v_max3_f32 v48, v88, v89, v90
  v_max3_f32 v48, v48, v91, v92
  v_max3_f32 v48, v48, v93, v94
  v_max_f32 v48, v48, v95
  v_max3_f32 v49, v44, v45, v46
  v_max3_f32 v49, v49, v47, v48
  v_cmp_lt_f32 vcc, s29, v49
  s_cbranch_vccnz L_concat_heads__gqa_block_cached__mha_block_cached__near_ridge_kernel_rare1
L_concat_heads__gqa_block_cached__mha_block_cached__near_ridge_kernel_back1:
  v_exp_f32 v56, v56
  v_exp_f32 v57, v57
  v_exp_f32 v58, v58
  v_exp_f32 v59, v59
  v_exp_f32 v60, v60
  v_exp_f32 v61, v61
  v_exp_f32 v62, v62
  v_exp_f32 v63, v63
  v_cvt_pk_bf16_f32 v56, v56, v57
  v_cvt_pk_bf16_f32 v57, v58, v59
  v_cvt_pk_bf16_f32 v58, v60, v61
  v_cvt_pk_bf16_f32 v59, v62, v63
  s_waitcnt lgkmcnt(0)
  s_nop 0
  v_mfma_f32_16x16x32_bf16 v[96:99], a[112:115], v[56:59], v[96:99]
  v_exp_f32 v64, v64
  v_exp_f32 v65, v65
  v_mfma_f32_16x16x32_bf16 v[116:119], a[116:119], v[56:59], v[116:119]
  v_exp_f32 v66, v66
  v_exp_f32 v67, v67
  v_mfma_f32_16x16x32_bf16 v[136:139], a[120:123], v[56:59], v[136:139]
  s_add_u32 m0, s33, 32768
  s_add_u32 s97, s31, 4096
  buffer_load_dwordx4 v8, s[16:19], s31 offen offset:0 nt lds
  v_exp_f32 v68, v68
  v_mfma_f32_16x16x32_bf16 v[156:159], a[124:127], v[56:59], v[156:159]
  v_exp_f32 v69, v69
  v_exp_f32 v70, v70
  v_mfma_f32_16x16x32_bf16 v[176:179], a[128:131], v[56:59], v[176:179]
  v_exp_f32 v71, v71
  buffer_load_dwordx4 v9, s[16:19], s31 offen offset:1024 nt lds
  v_mfma_f32_16x16x32_bf16 v[196:199], a[132:135], v[56:59], v[196:199]
  v_cvt_pk_bf16_f32 v64, v64, v65
  v_cvt_pk_bf16_f32 v65, v66, v67
  v_mfma_f32_16x16x32_bf16 v[216:219], a[136:139], v[56:59], v[216:219]
  v_cvt_pk_bf16_f32 v66, v68, v69
  v_cvt_pk_bf16_f32 v67, v70, v71
  v_mfma_f32_16x16x32_bf16 v[236:239], a[140:143], v[56:59], v[236:239]
  v_mfma_f32_16x16x32_bf16 a[144:147], a[164:167], v[56:59], a[144:147]
  v_mfma_f32_16x16x32_bf16 v[100:103], a[112:115], v[64:67], v[100:103]
  v_exp_f32 v72, v72
  v_exp_f32 v73, v73
  v_mfma_f32_16x16x32_bf16 v[120:123], a[116:119], v[64:67], v[120:123]
  v_exp_f32 v74, v74
  v_exp_f32 v75, v75
  v_mfma_f32_16x16x32_bf16 v[140:143], a[120:123], v[64:67], v[140:143]
  buffer_load_dwordx4 v8, s[16:19], s31 offen offset:2048 nt lds
  v_exp_f32 v76, v76
  v_mfma_f32_16x16x32_bf16 v[160:163], a[124:127], v[64:67], v[160:163]
  v_exp_f32 v77, v77
  v_exp_f32 v78, v78
  v_mfma_f32_16x16x32_bf16 v[180:183], a[128:131], v[64:67], v[180:183]
  v_exp_f32 v79, v79
  buffer_load_dwordx4 v9, s[16:19], s31 offen offset:3072 nt lds
  v_mfma_f32_16x16x32_bf16 v[200:203], a[132:135], v[64:67], v[200:203]
  v_cvt_pk_bf16_f32 v72, v72, v73
  v_cvt_pk_bf16_f32 v73, v74, v75
  v_mfma_f32_16x16x32_bf16 v[220:223], a[136:139], v[64:67], v[220:223]
  v_cvt_pk_bf16_f32 v74, v76, v77
  v_cvt_pk_bf16_f32 v75, v78, v79
  v_mfma_f32_16x16x32_bf16 v[240:243], a[140:143], v[64:67], v[240:243]
  v_mfma_f32_16x16x32_bf16 a[148:151], a[164:167], v[64:67], a[148:151]
  v_mfma_f32_16x16x32_bf16 v[104:107], a[112:115], v[72:75], v[104:107]
  v_exp_f32 v80, v80
  v_exp_f32 v81, v81
  v_mfma_f32_16x16x32_bf16 v[124:127], a[116:119], v[72:75], v[124:127]
  v_exp_f32 v82, v82
  v_exp_f32 v83, v83
  v_mfma_f32_16x16x32_bf16 v[144:147], a[120:123], v[72:75], v[144:147]
  s_add_u32 m0, s33, 36864
  s_add_u32 s31, s31, 16384
  buffer_load_dwordx4 v8, s[16:19], s97 offen offset:0 nt lds
  v_exp_f32 v84, v84
  v_mfma_f32_16x16x32_bf16 v[164:167], a[124:127], v[72:75], v[164:167]
  v_exp_f32 v85, v85
  v_exp_f32 v86, v86
  v_mfma_f32_16x16x32_bf16 v[184:187], a[128:131], v[72:75], v[184:187]
  v_exp_f32 v87, v87
  buffer_load_dwordx4 v9, s[16:19], s97 offen offset:1024 nt lds
  v_mfma_f32_16x16x32_bf16 v[204:207], a[132:135], v[72:75], v[204:207]
  v_cvt_pk_bf16_f32 v80, v80, v81
  v_cvt_pk_bf16_f32 v81, v82, v83
  v_mfma_f32_16x16x32_bf16 v[224:227], a[136:139], v[72:75], v[224:227]
  v_cvt_pk_bf16_f32 v82, v84, v85
  v_cvt_pk_bf16_f32 v83, v86, v87
  v_mfma_f32_16x16x32_bf16 v[244:247], a[140:143], v[72:75], v[244:247]
  v_mfma_f32_16x16x32_bf16 a[152:155], a[164:167], v[72:75], a[152:155]
  v_mfma_f32_16x16x32_bf16 v[108:111], a[112:115], v[80:83], v[108:111]
  v_exp_f32 v88, v88
  v_exp_f32 v89, v89
  v_mfma_f32_16x16x32_bf16 v[128:131], a[116:119], v[80:83], v[128:131]
  v_exp_f32 v90, v90
  v_exp_f32 v91, v91
  v_mfma_f32_16x16x32_bf16 v[148:151], a[120:123], v[80:83], v[148:151]
  buffer_load_dwordx4 v8, s[16:19], s97 offen offset:2048 nt lds
  v_exp_f32 v92, v92
  v_mfma_f32_16x16x32_bf16 v[168:171], a[124:127], v[80:83], v[168:171]
  v_exp_f32 v93, v93
  v_exp_f32 v94, v94
  v_mfma_f32_16x16x32_bf16 v[188:191], a[128:131], v[80:83], v[188:191]
  v_exp_f32 v95, v95
  buffer_load_dwordx4 v9, s[16:19], s97 offen offset:3072 nt lds
  v_mfma_f32_16x16x32_bf16 v[208:211], a[132:135], v[80:83], v[208:211]
  v_cvt_pk_bf16_f32 v88, v88, v89
  v_cvt_pk_bf16_f32 v89, v90, v91
  v_mfma_f32_16x16x32_bf16 v[228:231], a[136:139], v[80:83], v[228:231]
  v_cvt_pk_bf16_f32 v90, v92, v93
  v_cvt_pk_bf16_f32 v91, v94, v95
  v_mfma_f32_16x16x32_bf16 v[248:251], a[140:143], v[80:83], v[248:251]
  v_mfma_f32_16x16x32_bf16 a[156:159], a[164:167], v[80:83], a[156:159]
  s_waitcnt vmcnt(24)
  ds_read_b128 a[80:83], v10 offset:0
  ds_read_b128 a[96:99], v10 offset:4096
  ds_read_b128 a[84:87], v11 offset:0
  ds_read_b128 a[100:103], v11 offset:4096
  ds_read_b128 a[88:91], v12 offset:0
  ds_read_b128 a[104:107], v12 offset:4096
  ds_read_b128 a[92:95], v13 offset:0
  ds_read_b128 a[108:111], v13 offset:4096
  v_mfma_f32_16x16x32_bf16 v[112:115], a[112:115], v[88:91], v[112:115]
  v_mfma_f32_16x16x32_bf16 v[132:135], a[116:119], v[88:91], v[132:135]
  v_mfma_f32_16x16x32_bf16 v[152:155], a[120:123], v[88:91], v[152:155]
  v_mfma_f32_16x16x32_bf16 v[172:175], a[124:127], v[88:91], v[172:175]
  v_mfma_f32_16x16x32_bf16 v[192:195], a[128:131], v[88:91], v[192:195]
  v_mfma_f32_16x16x32_bf16 v[212:215], a[132:135], v[88:91], v[212:215]
  v_mfma_f32_16x16x32_bf16 v[232:235], a[136:139], v[88:91], v[232:235]
  v_mfma_f32_16x16x32_bf16 v[252:255], a[140:143], v[88:91], v[252:255]
  v_mfma_f32_16x16x32_bf16 a[160:163], a[164:167], v[88:91], a[160:163]
  s_mov_b32 s60, 6
L_concat_heads__gqa_block_cached__mha_block_cached__near_ridge_kernel_loop:
  s_waitcnt lgkmcnt(0)
  s_cmp_lg_u32 s27, 0
  s_cbranch_scc1 L_concat_heads__gqa_block_cached__mha_block_cached__near_ridge_kernel_nb3
  s_barrier
L_concat_heads__gqa_block_cached__mha_block_cached__near_ridge_kernel_nb3:
  v_mfma_f32_16x16x32_bf16 v[56:59], a[80:83], a[0:3], v[24:27]
  v_mfma_f32_16x16x32_bf16 v[60:63], a[96:99], a[0:3], v[24:27]
  s_add_u32 m0, s32, 0
  s_add_u32 s96, s30, 4096
  buffer_load_dwordx4 v4, s[12:15], s30 offen offset:0 nt lds
  v_mfma_f32_16x16x32_bf16 v[56:59], a[84:87], a[4:7], v[56:59]
  v_mfma_f32_16x16x32_bf16 v[60:63], a[100:103], a[4:7], v[60:63]
  v_mfma_f32_16x16x32_bf16 v[56:59], a[88:91], a[8:11], v[56:59]
  buffer_load_dwordx4 v5, s[12:15], s30 offen offset:1024 nt lds
  v_mfma_f32_16x16x32_bf16 v[60:63], a[104:107], a[8:11], v[60:63]
  v_mfma_f32_16x16x32_bf16 v[56:59], a[92:95], a[12:15], v[56:59]
  v_mfma_f32_16x16x32_bf16 v[60:63], a[108:111], a[12:15], v[60:63]
  v_mfma_f32_16x16x32_bf16 v[64:67], a[80:83], a[16:19], v[28:31]
  v_mfma_f32_16x16x32_bf16 v[68:71], a[96:99], a[16:19], v[28:31]
  buffer_load_dwordx4 v6, s[12:15], s30 offen offset:2048 nt lds
  v_mfma_f32_16x16x32_bf16 v[64:67], a[84:87], a[20:23], v[64:67]
  v_mfma_f32_16x16x32_bf16 v[68:71], a[100:103], a[20:23], v[68:71]
  v_mfma_f32_16x16x32_bf16 v[64:67], a[88:91], a[24:27], v[64:67]
  buffer_load_dwordx4 v7, s[12:15], s30 offen offset:3072 nt lds
  v_mfma_f32_16x16x32_bf16 v[68:71], a[104:107], a[24:27], v[68:71]
  v_mfma_f32_16x16x32_bf16 v[64:67], a[92:95], a[28:31], v[64:67]
  v_mfma_f32_16x16x32_bf16 v[68:71], a[108:111], a[28:31], v[68:71]
  v_mfma_f32_16x16x32_bf16 v[72:75], a[80:83], a[32:35], v[32:35]
  v_mfma_f32_16x16x32_bf16 v[76:79], a[96:99], a[32:35], v[32:35]
  s_add_u32 m0, s32, 4096
  s_add_u32 s30, s30, 16384
  buffer_load_dwordx4 v4, s[12:15], s96 offen offset:0 nt lds
  v_mfma_f32_16x16x32_bf16 v[72:75], a[84:87], a[36:39], v[72:75]
  buffer_load_dwordx4 v5, s[12:15], s96 offen offset:1024 nt lds
  v_mfma_f32_16x16x32_bf16 v[76:79], a[100:103], a[36:39], v[76:79]
  v_max3_f32 v44, v56, v57, v58
  v_mfma_f32_16x16x32_bf16 v[72:75], a[88:91], a[40:43], v[72:75]
  v_max3_f32 v44, v44, v59, v60
  v_mfma_f32_16x16x32_bf16 v[76:79], a[104:107], a[40:43], v[76:79]
  v_max3_f32 v44, v44, v61, v62
  v_mfma_f32_16x16x32_bf16 v[72:75], a[92:95], a[44:47], v[72:75]
  v_max_f32 v44, v44, v63
  v_mfma_f32_16x16x32_bf16 v[76:79], a[108:111], a[44:47], v[76:79]
  v_mfma_f32_16x16x32_bf16 v[80:83], a[80:83], a[48:51], v[36:39]
  v_mfma_f32_16x16x32_bf16 v[84:87], a[96:99], a[48:51], v[36:39]
  buffer_load_dwordx4 v6, s[12:15], s96 offen offset:2048 nt lds
  v_mfma_f32_16x16x32_bf16 v[80:83], a[84:87], a[52:55], v[80:83]
  buffer_load_dwordx4 v7, s[12:15], s96 offen offset:3072 nt lds
  v_mfma_f32_16x16x32_bf16 v[84:87], a[100:103], a[52:55], v[84:87]
  v_max3_f32 v45, v64, v65, v66
  v_mfma_f32_16x16x32_bf16 v[80:83], a[88:91], a[56:59], v[80:83]
  v_max3_f32 v45, v45, v67, v68
  v_mfma_f32_16x16x32_bf16 v[84:87], a[104:107], a[56:59], v[84:87]
  v_max3_f32 v45, v45, v69, v70
  v_mfma_f32_16x16x32_bf16 v[80:83], a[92:95], a[60:63], v[80:83]
  v_max_f32 v45, v45, v71
  v_mfma_f32_16x16x32_bf16 v[84:87], a[108:111], a[60:63], v[84:87]
  s_waitcnt vmcnt(24)
  v_mfma_f32_16x16x32_bf16 v[88:91], a[80:83], a[64:67], v[40:43]
  v_max3_f32 v46, v72, v73, v74
  v_max3_f32 v46, v46, v75, v76
  v_mfma_f32_16x16x32_bf16 v[92:95], a[96:99], a[64:67], v[40:43]
  ds_read_b64_tr_b16 a[112:113], v14 offset:0
  v_mfma_f32_16x16x32_bf16 v[88:91], a[84:87], a[68:71], v[88:91]
  ds_read_b64_tr_b16 a[114:115], v14 offset:4096
  ds_read_b64_tr_b16 a[116:117], v15 offset:0
  v_mfma_f32_16x16x32_bf16 v[92:95], a[100:103], a[68:71], v[92:95]
  ds_read_b64_tr_b16 a[118:119], v15 offset:4096
  v_mfma_f32_16x16x32_bf16 v[88:91], a[88:91], a[72:75], v[88:91]
  v_max3_f32 v46, v46, v77, v78
  v_max_f32 v46, v46, v79
  v_mfma_f32_16x16x32_bf16 v[92:95], a[104:107], a[72:75], v[92:95]
  ds_read_b64_tr_b16 a[120:121], v16 offset:0
  v_mfma_f32_16x16x32_bf16 v[88:91], a[92:95], a[76:79], v[88:91]
  ds_read_b64_tr_b16 a[122:123], v16 offset:4096
  ds_read_b64_tr_b16 a[124:125], v17 offset:0
  v_mfma_f32_16x16x32_bf16 v[92:95], a[108:111], a[76:79], v[92:95]
  ds_read_b64_tr_b16 a[126:127], v17 offset:4096
  ds_read_b64_tr_b16 a[128:129], v18 offset:0
  ds_read_b64_tr_b16 a[130:131], v18 offset:4096
  ds_read_b64_tr_b16 a[132:133], v19 offset:0
  ds_read_b64_tr_b16 a[134:135], v19 offset:4096
  ds_read_b64_tr_b16 a[136:137], v20 offset:0
  ds_read_b64_tr_b16 a[138:139], v20 offset:4096
  ds_read_b64_tr_b16 a[140:141], v21 offset:0
  ds_read_b64_tr_b16 a[142:143], v21 offset:4096
  v_max3_f32 v47, v80, v81, v82
  v_max3_f32 v47, v47, v83, v84
  v_max3_f32 v47, v47, v85, v86
  v_max_f32 v47, v47, v87
  v_max3_f32 v48, v88, v89, v90
  v_max3_f32 v48, v48, v91, v92
  v_max3_f32 v48, v48, v93, v94
  v_max_f32 v48, v48, v95
  v_max3_f32 v49, v44, v45, v46
  v_max3_f32 v49, v49, v47, v48
  v_cmp_lt_f32 vcc, s29, v49
  s_cbranch_vccnz L_concat_heads__gqa_block_cached__mha_block_cached__near_ridge_kernel_rare2
L_concat_heads__gqa_block_cached__mha_block_cached__near_ridge_kernel_back2:
  v_exp_f32 v56, v56
  v_exp_f32 v57, v57
  v_exp_f32 v58, v58
  v_exp_f32 v59, v59
  v_exp_f32 v60, v60
  v_exp_f32 v61, v61
  v_exp_f32 v62, v62
  v_exp_f32 v63, v63
  v_cvt_pk_bf16_f32 v56, v56, v57
  v_cvt_pk_bf16_f32 v57, v58, v59
  v_cvt_pk_bf16_f32 v58, v60, v61
  v_cvt_pk_bf16_f32 v59, v62, v63
  s_waitcnt lgkmcnt(0)
  s_nop 0
  v_mfma_f32_16x16x32_bf16 v[96:99], a[112:115], v[56:59], v[96:99]
  v_exp_f32 v64, v64
  v_exp_f32 v65, v65
  v_mfma_f32_16x16x32_bf16 v[116:119], a[116:119], v[56:59], v[116:119]
  v_exp_f32 v66, v66
  v_exp_f32 v67, v67
  v_mfma_f32_16x16x32_bf16 v[136:139], a[120:123], v[56:59], v[136:139]
  s_add_u32 m0, s33, 0
  s_add_u32 s97, s31, 4096
  buffer_load_dwordx4 v8, s[16:19], s31 offen offset:0 nt lds
  v_exp_f32 v68, v68
  v_mfma_f32_16x16x32_bf16 v[156:159], a[124:127], v[56:59], v[156:159]
  v_exp_f32 v69, v69
  v_exp_f32 v70, v70
  v_mfma_f32_16x16x32_bf16 v[176:179], a[128:131], v[56:59], v[176:179]
  v_exp_f32 v71, v71
  buffer_load_dwordx4 v9, s[16:19], s31 offen offset:1024 nt lds
  v_mfma_f32_16x16x32_bf16 v[196:199], a[132:135], v[56:59], v[196:199]
  v_cvt_pk_bf16_f32 v64, v64, v65
  v_cvt_pk_bf16_f32 v65, v66, v67
  v_mfma_f32_16x16x32_bf16 v[216:219], a[136:139], v[56:59], v[216:219]
  v_cvt_pk_bf16_f32 v66, v68, v69
  v_cvt_pk_bf16_f32 v67, v70, v71
  v_mfma_f32_16x16x32_bf16 v[236:239], a[140:143], v[56:59], v[236:239]
  v_mfma_f32_16x16x32_bf16 a[144:147], a[164:167], v[56:59], a[144:147]
  v_mfma_f32_16x16x32_bf16 v[100:103], a[112:115], v[64:67], v[100:103]
  v_exp_f32 v72, v72
  v_exp_f32 v73, v73
  v_mfma_f32_16x16x32_bf16 v[120:123], a[116:119], v[64:67], v[120:123]
  v_exp_f32 v74, v74
  v_exp_f32 v75, v75
  v_mfma_f32_16x16x32_bf16 v[140:143], a[120:123], v[64:67], v[140:143]
  buffer_load_dwordx4 v8, s[16:19], s31 offen offset:2048 nt lds
  v_exp_f32 v76, v76
  v_mfma_f32_16x16x32_bf16 v[160:163], a[124:127], v[64:67], v[160:163]
  v_exp_f32 v77, v77
  v_exp_f32 v78, v78
  v_mfma_f32_16x16x32_bf16 v[180:183], a[128:131], v[64:67], v[180:183]
  v_exp_f32 v79, v79
  buffer_load_dwordx4 v9, s[16:19], s31 offen offset:3072 nt lds
  v_mfma_f32_16x16x32_bf16 v[200:203], a[132:135], v[64:67], v[200:203]
  v_cvt_pk_bf16_f32 v72, v72, v73
  v_cvt_pk_bf16_f32 v73, v74, v75
  v_mfma_f32_16x16x32_bf16 v[220:223], a[136:139], v[64:67], v[220:223]
  v_cvt_pk_bf16_f32 v74, v76, v77
  v_cvt_pk_bf16_f32 v75, v78, v79
  v_mfma_f32_16x16x32_bf16 v[240:243], a[140:143], v[64:67], v[240:243]
  v_mfma_f32_16x16x32_bf16 a[148:151], a[164:167], v[64:67], a[148:151]
  v_mfma_f32_16x16x32_bf16 v[104:107], a[112:115], v[72:75], v[104:107]
  v_exp_f32 v80, v80
  v_exp_f32 v81, v81
  v_mfma_f32_16x16x32_bf16 v[124:127], a[116:119], v[72:75], v[124:127]
  v_exp_f32 v82, v82
  v_exp_f32 v83, v83
  v_mfma_f32_16x16x32_bf16 v[144:147], a[120:123], v[72:75], v[144:147]
  s_add_u32 m0, s33, 4096
  s_add_u32 s31, s31, 16384
  buffer_load_dwordx4 v8, s[16:19], s97 offen offset:0 nt lds
  v_exp_f32 v84, v84
  v_mfma_f32_16x16x32_bf16 v[164:167], a[124:127], v[72:75], v[164:167]
  v_exp_f32 v85, v85
  v_exp_f32 v86, v86
  v_mfma_f32_16x16x32_bf16 v[184:187], a[128:131], v[72:75], v[184:187]
  v_exp_f32 v87, v87
  buffer_load_dwordx4 v9, s[16:19], s97 offen offset:1024 nt lds
  v_mfma_f32_16x16x32_bf16 v[204:207], a[132:135], v[72:75], v[204:207]
  v_cvt_pk_bf16_f32 v80, v80, v81
  v_cvt_pk_bf16_f32 v81, v82, v83
  v_mfma_f32_16x16x32_bf16 v[224:227], a[136:139], v[72:75], v[224:227]
  v_cvt_pk_bf16_f32 v82, v84, v85
  v_cvt_pk_bf16_f32 v83, v86, v87
  v_mfma_f32_16x16x32_bf16 v[244:247], a[140:143], v[72:75], v[244:247]
  v_mfma_f32_16x16x32_bf16 a[152:155], a[164:167], v[72:75], a[152:155]
  v_mfma_f32_16x16x32_bf16 v[108:111], a[112:115], v[80:83], v[108:111]
  v_exp_f32 v88, v88
  v_exp_f32 v89, v89
  v_mfma_f32_16x16x32_bf16 v[128:131], a[116:119], v[80:83], v[128:131]
  v_exp_f32 v90, v90
  v_exp_f32 v91, v91
  v_mfma_f32_16x16x32_bf16 v[148:151], a[120:123], v[80:83], v[148:151]
  buffer_load_dwordx4 v8, s[16:19], s97 offen offset:2048 nt lds
  v_exp_f32 v92, v92
  v_mfma_f32_16x16x32_bf16 v[168:171], a[124:127], v[80:83], v[168:171]
  v_exp_f32 v93, v93
  v_exp_f32 v94, v94
  v_mfma_f32_16x16x32_bf16 v[188:191], a[128:131], v[80:83], v[188:191]
  v_exp_f32 v95, v95
  buffer_load_dwordx4 v9, s[16:19], s97 offen offset:3072 nt lds
  v_mfma_f32_16x16x32_bf16 v[208:211], a[132:135], v[80:83], v[208:211]
  v_cvt_pk_bf16_f32 v88, v88, v89
  v_cvt_pk_bf16_f32 v89, v90, v91
  v_mfma_f32_16x16x32_bf16 v[228:231], a[136:139], v[80:83], v[228:231]
  v_cvt_pk_bf16_f32 v90, v92, v93
  v_cvt_pk_bf16_f32 v91, v94, v95
  v_mfma_f32_16x16x32_bf16 v[248:251], a[140:143], v[80:83], v[248:251]
  v_mfma_f32_16x16x32_bf16 a[156:159], a[164:167], v[80:83], a[156:159]
  s_waitcnt vmcnt(24)
  ds_read_b128 a[80:83], v10 offset:32768
  ds_read_b128 a[96:99], v10 offset:36864
  ds_read_b128 a[84:87], v11 offset:32768
  ds_read_b128 a[100:103], v11 offset:36864
  ds_read_b128 a[88:91], v12 offset:32768
  ds_read_b128 a[104:107], v12 offset:36864
  ds_read_b128 a[92:95], v13 offset:32768
  ds_read_b128 a[108:111], v13 offset:36864
  v_mfma_f32_16x16x32_bf16 v[112:115], a[112:115], v[88:91], v[112:115]
  v_mfma_f32_16x16x32_bf16 v[132:135], a[116:119], v[88:91], v[132:135]
  v_mfma_f32_16x16x32_bf16 v[152:155], a[120:123], v[88:91], v[152:155]
  v_mfma_f32_16x16x32_bf16 v[172:175], a[124:127], v[88:91], v[172:175]
  v_mfma_f32_16x16x32_bf16 v[192:195], a[128:131], v[88:91], v[192:195]
  v_mfma_f32_16x16x32_bf16 v[212:215], a[132:135], v[88:91], v[212:215]
  v_mfma_f32_16x16x32_bf16 v[232:235], a[136:139], v[88:91], v[232:235]
  v_mfma_f32_16x16x32_bf16 v[252:255], a[140:143], v[88:91], v[252:255]
  v_mfma_f32_16x16x32_bf16 a[160:163], a[164:167], v[88:91], a[160:163]
  s_waitcnt lgkmcnt(0)
  s_cmp_lg_u32 s27, 0
  s_cbranch_scc1 L_concat_heads__gqa_block_cached__mha_block_cached__near_ridge_kernel_nb4
  s_barrier
L_concat_heads__gqa_block_cached__mha_block_cached__near_ridge_kernel_nb4:
  v_mfma_f32_16x16x32_bf16 v[56:59], a[80:83], a[0:3], v[24:27]
  v_mfma_f32_16x16x32_bf16 v[60:63], a[96:99], a[0:3], v[24:27]
  s_add_u32 m0, s32, 32768
  s_add_u32 s96, s30, 4096
  buffer_load_dwordx4 v4, s[12:15], s30 offen offset:0 nt lds
  v_mfma_f32_16x16x32_bf16 v[56:59], a[84:87], a[4:7], v[56:59]
  v_mfma_f32_16x16x32_bf16 v[60:63], a[100:103], a[4:7], v[60:63]
  v_mfma_f32_16x16x32_bf16 v[56:59], a[88:91], a[8:11], v[56:59]
  buffer_load_dwordx4 v5, s[12:15], s30 offen offset:1024 nt lds
  v_mfma_f32_16x16x32_bf16 v[60:63], a[104:107], a[8:11], v[60:63]
  v_mfma_f32_16x16x32_bf16 v[56:59], a[92:95], a[12:15], v[56:59]
  v_mfma_f32_16x16x32_bf16 v[60:63], a[108:111], a[12:15], v[60:63]
  v_mfma_f32_16x16x32_bf16 v[64:67], a[80:83], a[16:19], v[28:31]
  v_mfma_f32_16x16x32_bf16 v[68:71], a[96:99], a[16:19], v[28:31]
  buffer_load_dwordx4 v6, s[12:15], s30 offen offset:2048 nt lds
  v_mfma_f32_16x16x32_bf16 v[64:67], a[84:87], a[20:23], v[64:67]
  v_mfma_f32_16x16x32_bf16 v[68:71], a[100:103], a[20:23], v[68:71]
  v_mfma_f32_16x16x32_bf16 v[64:67], a[88:91], a[24:27], v[64:67]
  buffer_load_dwordx4 v7, s[12:15], s30 offen offset:3072 nt lds
  v_mfma_f32_16x16x32_bf16 v[68:71], a[104:107], a[24:27], v[68:71]
  v_mfma_f32_16x16x32_bf16 v[64:67], a[92:95], a[28:31], v[64:67]
  v_mfma_f32_16x16x32_bf16 v[68:71], a[108:111], a[28:31], v[68:71]
  v_mfma_f32_16x16x32_bf16 v[72:75], a[80:83], a[32:35], v[32:35]
  v_mfma_f32_16x16x32_bf16 v[76:79], a[96:99], a[32:35], v[32:35]
  s_add_u32 m0, s32, 36864
  s_add_u32 s30, s30, 16384
  buffer_load_dwordx4 v4, s[12:15], s96 offen offset:0 nt lds
  v_mfma_f32_16x16x32_bf16 v[72:75], a[84:87], a[36:39], v[72:75]
  buffer_load_dwordx4 v5, s[12:15], s96 offen offset:1024 nt lds
  v_mfma_f32_16x16x32_bf16 v[76:79], a[100:103], a[36:39], v[76:79]
  v_max3_f32 v44, v56, v57, v58
  v_mfma_f32_16x16x32_bf16 v[72:75], a[88:91], a[40:43], v[72:75]
  v_max3_f32 v44, v44, v59, v60
  v_mfma_f32_16x16x32_bf16 v[76:79], a[104:107], a[40:43], v[76:79]
  v_max3_f32 v44, v44, v61, v62
  v_mfma_f32_16x16x32_bf16 v[72:75], a[92:95], a[44:47], v[72:75]
  v_max_f32 v44, v44, v63
  v_mfma_f32_16x16x32_bf16 v[76:79], a[108:111], a[44:47], v[76:79]
  v_mfma_f32_16x16x32_bf16 v[80:83], a[80:83], a[48:51], v[36:39]
  v_mfma_f32_16x16x32_bf16 v[84:87], a[96:99], a[48:51], v[36:39]
  buffer_load_dwordx4 v6, s[12:15], s96 offen offset:2048 nt lds
  v_mfma_f32_16x16x32_bf16 v[80:83], a[84:87], a[52:55], v[80:83]
  buffer_load_dwordx4 v7, s[12:15], s96 offen offset:3072 nt lds
  v_mfma_f32_16x16x32_bf16 v[84:87], a[100:103], a[52:55], v[84:87]
  v_max3_f32 v45, v64, v65, v66
  v_mfma_f32_16x16x32_bf16 v[80:83], a[88:91], a[56:59], v[80:83]
  v_max3_f32 v45, v45, v67, v68
  v_mfma_f32_16x16x32_bf16 v[84:87], a[104:107], a[56:59], v[84:87]
  v_max3_f32 v45, v45, v69, v70
  v_mfma_f32_16x16x32_bf16 v[80:83], a[92:95], a[60:63], v[80:83]
  v_max_f32 v45, v45, v71
  v_mfma_f32_16x16x32_bf16 v[84:87], a[108:111], a[60:63], v[84:87]
  s_waitcnt vmcnt(24)
  v_mfma_f32_16x16x32_bf16 v[88:91], a[80:83], a[64:67], v[40:43]
  v_max3_f32 v46, v72, v73, v74
  v_max3_f32 v46, v46, v75, v76
  v_mfma_f32_16x16x32_bf16 v[92:95], a[96:99], a[64:67], v[40:43]
  ds_read_b64_tr_b16 a[112:113], v14 offset:32768
  v_mfma_f32_16x16x32_bf16 v[88:91], a[84:87], a[68:71], v[88:91]
  ds_read_b64_tr_b16 a[114:115], v14 offset:36864
  ds_read_b64_tr_b16 a[116:117], v15 offset:32768
  v_mfma_f32_16x16x32_bf16 v[92:95], a[100:103], a[68:71], v[92:95]
  ds_read_b64_tr_b16 a[118:119], v15 offset:36864
  v_mfma_f32_16x16x32_bf16 v[88:91], a[88:91], a[72:75], v[88:91]
  v_max3_f32 v46, v46, v77, v78
  v_max_f32 v46, v46, v79
  v_mfma_f32_16x16x32_bf16 v[92:95], a[104:107], a[72:75], v[92:95]
  ds_read_b64_tr_b16 a[120:121], v16 offset:32768
  v_mfma_f32_16x16x32_bf16 v[88:91], a[92:95], a[76:79], v[88:91]
  ds_read_b64_tr_b16 a[122:123], v16 offset:36864
  ds_read_b64_tr_b16 a[124:125], v17 offset:32768
  v_mfma_f32_16x16x32_bf16 v[92:95], a[108:111], a[76:79], v[92:95]
  ds_read_b64_tr_b16 a[126:127], v17 offset:36864
  ds_read_b64_tr_b16 a[128:129], v18 offset:32768
  ds_read_b64_tr_b16 a[130:131], v18 offset:36864
  ds_read_b64_tr_b16 a[132:133], v19 offset:32768
  ds_read_b64_tr_b16 a[134:135], v19 offset:36864
  ds_read_b64_tr_b16 a[136:137], v20 offset:32768
  ds_read_b64_tr_b16 a[138:139], v20 offset:36864
  ds_read_b64_tr_b16 a[140:141], v21 offset:32768
  ds_read_b64_tr_b16 a[142:143], v21 offset:36864
  v_max3_f32 v47, v80, v81, v82
  v_max3_f32 v47, v47, v83, v84
  v_max3_f32 v47, v47, v85, v86
  v_max_f32 v47, v47, v87
  v_max3_f32 v48, v88, v89, v90
  v_max3_f32 v48, v48, v91, v92
  v_max3_f32 v48, v48, v93, v94
  v_max_f32 v48, v48, v95
  v_max3_f32 v49, v44, v45, v46
  v_max3_f32 v49, v49, v47, v48
  v_cmp_lt_f32 vcc, s29, v49
  s_cbranch_vccnz L_concat_heads__gqa_block_cached__mha_block_cached__near_ridge_kernel_rare3
L_concat_heads__gqa_block_cached__mha_block_cached__near_ridge_kernel_back3:
  v_exp_f32 v56, v56
  v_exp_f32 v57, v57
  v_exp_f32 v58, v58
  v_exp_f32 v59, v59
  v_exp_f32 v60, v60
  v_exp_f32 v61, v61
  v_exp_f32 v62, v62
  v_exp_f32 v63, v63
  v_cvt_pk_bf16_f32 v56, v56, v57
  v_cvt_pk_bf16_f32 v57, v58, v59
  v_cvt_pk_bf16_f32 v58, v60, v61
  v_cvt_pk_bf16_f32 v59, v62, v63
  s_waitcnt lgkmcnt(0)
  s_nop 0
  v_mfma_f32_16x16x32_bf16 v[96:99], a[112:115], v[56:59], v[96:99]
  v_exp_f32 v64, v64
  v_exp_f32 v65, v65
  v_mfma_f32_16x16x32_bf16 v[116:119], a[116:119], v[56:59], v[116:119]
  v_exp_f32 v66, v66
  v_exp_f32 v67, v67
  v_mfma_f32_16x16x32_bf16 v[136:139], a[120:123], v[56:59], v[136:139]
  s_add_u32 m0, s33, 32768
  s_add_u32 s97, s31, 4096
  buffer_load_dwordx4 v8, s[16:19], s31 offen offset:0 nt lds
  v_exp_f32 v68, v68
  v_mfma_f32_16x16x32_bf16 v[156:159], a[124:127], v[56:59], v[156:159]
  v_exp_f32 v69, v69
  v_exp_f32 v70, v70
  v_mfma_f32_16x16x32_bf16 v[176:179], a[128:131], v[56:59], v[176:179]
  v_exp_f32 v71, v71
  buffer_load_dwordx4 v9, s[16:19], s31 offen offset:1024 nt lds
  v_mfma_f32_16x16x32_bf16 v[196:199], a[132:135], v[56:59], v[196:199]
  v_cvt_pk_bf16_f32 v64, v64, v65
  v_cvt_pk_bf16_f32 v65, v66, v67
  v_mfma_f32_16x16x32_bf16 v[216:219], a[136:139], v[56:59], v[216:219]
  v_cvt_pk_bf16_f32 v66, v68, v69
  v_cvt_pk_bf16_f32 v67, v70, v71
  v_mfma_f32_16x16x32_bf16 v[236:239], a[140:143], v[56:59], v[236:239]
  v_mfma_f32_16x16x32_bf16 a[144:147], a[164:167], v[56:59], a[144:147]
  v_mfma_f32_16x16x32_bf16 v[100:103], a[112:115], v[64:67], v[100:103]
  v_exp_f32 v72, v72
  v_exp_f32 v73, v73
  v_mfma_f32_16x16x32_bf16 v[120:123], a[116:119], v[64:67], v[120:123]
  v_exp_f32 v74, v74
  v_exp_f32 v75, v75
  v_mfma_f32_16x16x32_bf16 v[140:143], a[120:123], v[64:67], v[140:143]
  buffer_load_dwordx4 v8, s[16:19], s31 offen offset:2048 nt lds
  v_exp_f32 v76, v76
  v_mfma_f32_16x16x32_bf16 v[160:163], a[124:127], v[64:67], v[160:163]
  v_exp_f32 v77, v77
  v_exp_f32 v78, v78
  v_mfma_f32_16x16x32_bf16 v[180:183], a[128:131], v[64:67], v[180:183]
  v_exp_f32 v79, v79
  buffer_load_dwordx4 v9, s[16:19], s31 offen offset:3072 nt lds
  v_mfma_f32_16x16x32_bf16 v[200:203], a[132:135], v[64:67], v[200:203]
  v_cvt_pk_bf16_f32 v72, v72, v73
  v_cvt_pk_bf16_f32 v73, v74, v75
  v_mfma_f32_16x16x32_bf16 v[220:223], a[136:139], v[64:67], v[220:223]
  v_cvt_pk_bf16_f32 v74, v76, v77
  v_cvt_pk_bf16_f32 v75, v78, v79
  v_mfma_f32_16x16x32_bf16 v[240:243], a[140:143], v[64:67], v[240:243]
  v_mfma_f32_16x16x32_bf16 a[148:151], a[164:167], v[64:67], a[148:151]
  v_mfma_f32_16x16x32_bf16 v[104:107], a[112:115], v[72:75], v[104:107]
  v_exp_f32 v80, v80
  v_exp_f32 v81, v81
  v_mfma_f32_16x16x32_bf16 v[124:127], a[116:119], v[72:75], v[124:127]
  v_exp_f32 v82, v82
  v_exp_f32 v83, v83
  v_mfma_f32_16x16x32_bf16 v[144:147], a[120:123], v[72:75], v[144:147]
  s_add_u32 m0, s33, 36864
  s_add_u32 s31, s31, 16384
  buffer_load_dwordx4 v8, s[16:19], s97 offen offset:0 nt lds
  v_exp_f32 v84, v84
  v_mfma_f32_16x16x32_bf16 v[164:167], a[124:127], v[72:75], v[164:167]
  v_exp_f32 v85, v85
  v_exp_f32 v86, v86
  v_mfma_f32_16x16x32_bf16 v[184:187], a[128:131], v[72:75], v[184:187]
  v_exp_f32 v87, v87
  buffer_load_dwordx4 v9, s[16:19], s97 offen offset:1024 nt lds
  v_mfma_f32_16x16x32_bf16 v[204:207], a[132:135], v[72:75], v[204:207]
  v_cvt_pk_bf16_f32 v80, v80, v81
  v_cvt_pk_bf16_f32 v81, v82, v83
  v_mfma_f32_16x16x32_bf16 v[224:227], a[136:139], v[72:75], v[224:227]
  v_cvt_pk_bf16_f32 v82, v84, v85
  v_cvt_pk_bf16_f32 v83, v86, v87
  v_mfma_f32_16x16x32_bf16 v[244:247], a[140:143], v[72:75], v[244:247]
  v_mfma_f32_16x16x32_bf16 a[152:155], a[164:167], v[72:75], a[152:155]
  v_mfma_f32_16x16x32_bf16 v[108:111], a[112:115], v[80:83], v[108:111]
  v_exp_f32 v88, v88
  v_exp_f32 v89, v89
  v_mfma_f32_16x16x32_bf16 v[128:131], a[116:119], v[80:83], v[128:131]
  v_exp_f32 v90, v90
  v_exp_f32 v91, v91
  v_mfma_f32_16x16x32_bf16 v[148:151], a[120:123], v[80:83], v[148:151]
  buffer_load_dwordx4 v8, s[16:19], s97 offen offset:2048 nt lds
  v_exp_f32 v92, v92
  v_mfma_f32_16x16x32_bf16 v[168:171], a[124:127], v[80:83], v[168:171]
  v_exp_f32 v93, v93
  v_exp_f32 v94, v94
  v_mfma_f32_16x16x32_bf16 v[188:191], a[128:131], v[80:83], v[188:191]
  v_exp_f32 v95, v95
  buffer_load_dwordx4 v9, s[16:19], s97 offen offset:3072 nt lds
  v_mfma_f32_16x16x32_bf16 v[208:211], a[132:135], v[80:83], v[208:211]
  v_cvt_pk_bf16_f32 v88, v88, v89
  v_cvt_pk_bf16_f32 v89, v90, v91
  v_mfma_f32_16x16x32_bf16 v[228:231], a[136:139], v[80:83], v[228:231]
  v_cvt_pk_bf16_f32 v90, v92, v93
  v_cvt_pk_bf16_f32 v91, v94, v95
  v_mfma_f32_16x16x32_bf16 v[248:251], a[140:143], v[80:83], v[248:251]
  v_mfma_f32_16x16x32_bf16 a[156:159], a[164:167], v[80:83], a[156:159]
  s_waitcnt vmcnt(24)
  ds_read_b128 a[80:83], v10 offset:0
  ds_read_b128 a[96:99], v10 offset:4096
  ds_read_b128 a[84:87], v11 offset:0
  ds_read_b128 a[100:103], v11 offset:4096
  ds_read_b128 a[88:91], v12 offset:0
  ds_read_b128 a[104:107], v12 offset:4096
  ds_read_b128 a[92:95], v13 offset:0
  ds_read_b128 a[108:111], v13 offset:4096
  v_mfma_f32_16x16x32_bf16 v[112:115], a[112:115], v[88:91], v[112:115]
  v_mfma_f32_16x16x32_bf16 v[132:135], a[116:119], v[88:91], v[132:135]
  v_mfma_f32_16x16x32_bf16 v[152:155], a[120:123], v[88:91], v[152:155]
  v_mfma_f32_16x16x32_bf16 v[172:175], a[124:127], v[88:91], v[172:175]
  v_mfma_f32_16x16x32_bf16 v[192:195], a[128:131], v[88:91], v[192:195]
  v_mfma_f32_16x16x32_bf16 v[212:215], a[132:135], v[88:91], v[212:215]
  v_mfma_f32_16x16x32_bf16 v[232:235], a[136:139], v[88:91], v[232:235]
  v_mfma_f32_16x16x32_bf16 v[252:255], a[140:143], v[88:91], v[252:255]
  v_mfma_f32_16x16x32_bf16 a[160:163], a[164:167], v[88:91], a[160:163]
  s_sub_u32 s60, s60, 1
  s_cmp_lg_u32 s60, 0
  s_cbranch_scc1 L_concat_heads__gqa_block_cached__mha_block_cached__near_ridge_kernel_loop
  s_waitcnt lgkmcnt(0)
  v_mfma_f32_16x16x32_bf16 v[56:59], a[80:83], a[0:3], v[24:27]
  v_mfma_f32_16x16x32_bf16 v[60:63], a[96:99], a[0:3], v[24:27]
  v_mfma_f32_16x16x32_bf16 v[56:59], a[84:87], a[4:7], v[56:59]
  v_mfma_f32_16x16x32_bf16 v[60:63], a[100:103], a[4:7], v[60:63]
  v_mfma_f32_16x16x32_bf16 v[56:59], a[88:91], a[8:11], v[56:59]
  v_mfma_f32_16x16x32_bf16 v[60:63], a[104:107], a[8:11], v[60:63]
  v_mfma_f32_16x16x32_bf16 v[56:59], a[92:95], a[12:15], v[56:59]
  v_mfma_f32_16x16x32_bf16 v[60:63], a[108:111], a[12:15], v[60:63]
  v_mfma_f32_16x16x32_bf16 v[64:67], a[80:83], a[16:19], v[28:31]
  v_mfma_f32_16x16x32_bf16 v[68:71], a[96:99], a[16:19], v[28:31]
  v_mfma_f32_16x16x32_bf16 v[64:67], a[84:87], a[20:23], v[64:67]
  v_mfma_f32_16x16x32_bf16 v[68:71], a[100:103], a[20:23], v[68:71]
  v_mfma_f32_16x16x32_bf16 v[64:67], a[88:91], a[24:27], v[64:67]
  v_mfma_f32_16x16x32_bf16 v[68:71], a[104:107], a[24:27], v[68:71]
  v_mfma_f32_16x16x32_bf16 v[64:67], a[92:95], a[28:31], v[64:67]
  v_mfma_f32_16x16x32_bf16 v[68:71], a[108:111], a[28:31], v[68:71]
  v_mfma_f32_16x16x32_bf16 v[72:75], a[80:83], a[32:35], v[32:35]
  v_mfma_f32_16x16x32_bf16 v[76:79], a[96:99], a[32:35], v[32:35]
  v_max3_f32 v44, v56, v57, v58
  v_mfma_f32_16x16x32_bf16 v[72:75], a[84:87], a[36:39], v[72:75]
  v_max3_f32 v44, v44, v59, v60
  v_mfma_f32_16x16x32_bf16 v[76:79], a[100:103], a[36:39], v[76:79]
  v_mfma_f32_16x16x32_bf16 v[72:75], a[88:91], a[40:43], v[72:75]
  v_max3_f32 v44, v44, v61, v62
  v_mfma_f32_16x16x32_bf16 v[76:79], a[104:107], a[40:43], v[76:79]
  v_mfma_f32_16x16x32_bf16 v[72:75], a[92:95], a[44:47], v[72:75]
  v_max_f32 v44, v44, v63
  v_mfma_f32_16x16x32_bf16 v[76:79], a[108:111], a[44:47], v[76:79]
  v_mfma_f32_16x16x32_bf16 v[80:83], a[80:83], a[48:51], v[36:39]
  v_mfma_f32_16x16x32_bf16 v[84:87], a[96:99], a[48:51], v[36:39]
  v_max3_f32 v45, v64, v65, v66
  v_mfma_f32_16x16x32_bf16 v[80:83], a[84:87], a[52:55], v[80:83]
  v_max3_f32 v45, v45, v67, v68
  v_mfma_f32_16x16x32_bf16 v[84:87], a[100:103], a[52:55], v[84:87]
  v_mfma_f32_16x16x32_bf16 v[80:83], a[88:91], a[56:59], v[80:83]
  v_max3_f32 v45, v45, v69, v70
  v_mfma_f32_16x16x32_bf16 v[84:87], a[104:107], a[56:59], v[84:87]
  v_mfma_f32_16x16x32_bf16 v[80:83], a[92:95], a[60:63], v[80:83]
  v_max_f32 v45, v45, v71
  v_mfma_f32_16x16x32_bf16 v[84:87], a[108:111], a[60:63], v[84:87]
  s_waitcnt vmcnt(16)
  v_mfma_f32_16x16x32_bf16 v[88:91], a[80:83], a[64:67], v[40:43]
  v_max3_f32 v46, v72, v73, v74
  v_max3_f32 v46, v46, v75, v76
  v_mfma_f32_16x16x32_bf16 v[92:95], a[96:99], a[64:67], v[40:43]
  ds_read_b64_tr_b16 a[112:113], v14 offset:0
  v_mfma_f32_16x16x32_bf16 v[88:91], a[84:87], a[68:71], v[88:91]
  ds_read_b64_tr_b16 a[114:115], v14 offset:4096
  ds_read_b64_tr_b16 a[116:117], v15 offset:0
  v_mfma_f32_16x16x32_bf16 v[92:95], a[100:103], a[68:71], v[92:95]
  ds_read_b64_tr_b16 a[118:119], v15 offset:4096
  v_mfma_f32_16x16x32_bf16 v[88:91], a[88:91], a[72:75], v[88:91]
  v_max3_f32 v46, v46, v77, v78
  v_max_f32 v46, v46, v79
  v_mfma_f32_16x16x32_bf16 v[92:95], a[104:107], a[72:75], v[92:95]
  ds_read_b64_tr_b16 a[120:121], v16 offset:0
  v_mfma_f32_16x16x32_bf16 v[88:91], a[92:95], a[76:79], v[88:91]
  ds_read_b64_tr_b16 a[122:123], v16 offset:4096
  ds_read_b64_tr_b16 a[124:125], v17 offset:0
  v_mfma_f32_16x16x32_bf16 v[92:95], a[108:111], a[76:79], v[92:95]
  ds_read_b64_tr_b16 a[126:127], v17 offset:4096
  ds_read_b64_tr_b16 a[128:129], v18 offset:0
  ds_read_b64_tr_b16 a[130:131], v18 offset:4096
  ds_read_b64_tr_b16 a[132:133], v19 offset:0
  ds_read_b64_tr_b16 a[134:135], v19 offset:4096
  ds_read_b64_tr_b16 a[136:137], v20 offset:0
  ds_read_b64_tr_b16 a[138:139], v20 offset:4096
  ds_read_b64_tr_b16 a[140:141], v21 offset:0
  ds_read_b64_tr_b16 a[142:143], v21 offset:4096
  v_max3_f32 v47, v80, v81, v82
  v_max3_f32 v47, v47, v83, v84
  v_max3_f32 v47, v47, v85, v86
  v_max_f32 v47, v47, v87
  v_max3_f32 v48, v88, v89, v90
  v_max3_f32 v48, v48, v91, v92
  v_max3_f32 v48, v48, v93, v94
  v_max_f32 v48, v48, v95
  v_max3_f32 v49, v44, v45, v46
  v_max3_f32 v49, v49, v47, v48
  v_cmp_lt_f32 vcc, s29, v49
  s_cbranch_vccnz L_concat_heads__gqa_block_cached__mha_block_cached__near_ridge_kernel_rare4
L_concat_heads__gqa_block_cached__mha_block_cached__near_ridge_kernel_back4:
  v_exp_f32 v56, v56
  v_exp_f32 v57, v57
  v_exp_f32 v58, v58
  v_exp_f32 v59, v59
  v_exp_f32 v60, v60
  v_exp_f32 v61, v61
  v_exp_f32 v62, v62
  v_exp_f32 v63, v63
  v_cvt_pk_bf16_f32 v56, v56, v57
  v_cvt_pk_bf16_f32 v57, v58, v59
  v_cvt_pk_bf16_f32 v58, v60, v61
  v_cvt_pk_bf16_f32 v59, v62, v63
  s_waitcnt lgkmcnt(0)
  s_nop 0
  v_mfma_f32_16x16x32_bf16 v[96:99], a[112:115], v[56:59], v[96:99]
  v_exp_f32 v64, v64
  v_exp_f32 v65, v65
  v_mfma_f32_16x16x32_bf16 v[116:119], a[116:119], v[56:59], v[116:119]
  v_exp_f32 v66, v66
  v_exp_f32 v67, v67
  v_mfma_f32_16x16x32_bf16 v[136:139], a[120:123], v[56:59], v[136:139]
  v_exp_f32 v68, v68
  v_exp_f32 v69, v69
  v_mfma_f32_16x16x32_bf16 v[156:159], a[124:127], v[56:59], v[156:159]
  v_exp_f32 v70, v70
  v_mfma_f32_16x16x32_bf16 v[176:179], a[128:131], v[56:59], v[176:179]
  v_exp_f32 v71, v71
  v_cvt_pk_bf16_f32 v64, v64, v65
  v_mfma_f32_16x16x32_bf16 v[196:199], a[132:135], v[56:59], v[196:199]
  v_cvt_pk_bf16_f32 v65, v66, v67
  v_cvt_pk_bf16_f32 v66, v68, v69
  v_mfma_f32_16x16x32_bf16 v[216:219], a[136:139], v[56:59], v[216:219]
  v_cvt_pk_bf16_f32 v67, v70, v71
  v_mfma_f32_16x16x32_bf16 v[236:239], a[140:143], v[56:59], v[236:239]
  v_mfma_f32_16x16x32_bf16 a[144:147], a[164:167], v[56:59], a[144:147]
  v_mfma_f32_16x16x32_bf16 v[100:103], a[112:115], v[64:67], v[100:103]
  v_exp_f32 v72, v72
  v_exp_f32 v73, v73
  v_mfma_f32_16x16x32_bf16 v[120:123], a[116:119], v[64:67], v[120:123]
  v_exp_f32 v74, v74
  v_exp_f32 v75, v75
  v_mfma_f32_16x16x32_bf16 v[140:143], a[120:123], v[64:67], v[140:143]
  v_exp_f32 v76, v76
  v_exp_f32 v77, v77
  v_mfma_f32_16x16x32_bf16 v[160:163], a[124:127], v[64:67], v[160:163]
  v_exp_f32 v78, v78
  v_mfma_f32_16x16x32_bf16 v[180:183], a[128:131], v[64:67], v[180:183]
  v_exp_f32 v79, v79
  v_cvt_pk_bf16_f32 v72, v72, v73
  v_mfma_f32_16x16x32_bf16 v[200:203], a[132:135], v[64:67], v[200:203]
  v_cvt_pk_bf16_f32 v73, v74, v75
  v_cvt_pk_bf16_f32 v74, v76, v77
  v_mfma_f32_16x16x32_bf16 v[220:223], a[136:139], v[64:67], v[220:223]
  v_cvt_pk_bf16_f32 v75, v78, v79
  v_mfma_f32_16x16x32_bf16 v[240:243], a[140:143], v[64:67], v[240:243]
  v_mfma_f32_16x16x32_bf16 a[148:151], a[164:167], v[64:67], a[148:151]
  v_mfma_f32_16x16x32_bf16 v[104:107], a[112:115], v[72:75], v[104:107]
  v_exp_f32 v80, v80
  v_exp_f32 v81, v81
  v_mfma_f32_16x16x32_bf16 v[124:127], a[116:119], v[72:75], v[124:127]
  v_exp_f32 v82, v82
  v_exp_f32 v83, v83
  v_mfma_f32_16x16x32_bf16 v[144:147], a[120:123], v[72:75], v[144:147]
  v_exp_f32 v84, v84
  v_exp_f32 v85, v85
  v_mfma_f32_16x16x32_bf16 v[164:167], a[124:127], v[72:75], v[164:167]
  v_exp_f32 v86, v86
  v_mfma_f32_16x16x32_bf16 v[184:187], a[128:131], v[72:75], v[184:187]
  v_exp_f32 v87, v87
  v_cvt_pk_bf16_f32 v80, v80, v81
  v_mfma_f32_16x16x32_bf16 v[204:207], a[132:135], v[72:75], v[204:207]
  v_cvt_pk_bf16_f32 v81, v82, v83
  v_cvt_pk_bf16_f32 v82, v84, v85
  v_mfma_f32_16x16x32_bf16 v[224:227], a[136:139], v[72:75], v[224:227]
  v_cvt_pk_bf16_f32 v83, v86, v87
  v_mfma_f32_16x16x32_bf16 v[244:247], a[140:143], v[72:75], v[244:247]
  v_mfma_f32_16x16x32_bf16 a[152:155], a[164:167], v[72:75], a[152:155]
  v_mfma_f32_16x16x32_bf16 v[108:111], a[112:115], v[80:83], v[108:111]
  v_exp_f32 v88, v88
  v_exp_f32 v89, v89
  v_mfma_f32_16x16x32_bf16 v[128:131], a[116:119], v[80:83], v[128:131]
  v_exp_f32 v90, v90
  v_exp_f32 v91, v91
  v_mfma_f32_16x16x32_bf16 v[148:151], a[120:123], v[80:83], v[148:151]
  v_exp_f32 v92, v92
  v_exp_f32 v93, v93
  v_mfma_f32_16x16x32_bf16 v[168:171], a[124:127], v[80:83], v[168:171]
  v_exp_f32 v94, v94
  v_mfma_f32_16x16x32_bf16 v[188:191], a[128:131], v[80:83], v[188:191]
  v_exp_f32 v95, v95
  v_cvt_pk_bf16_f32 v88, v88, v89
  v_mfma_f32_16x16x32_bf16 v[208:211], a[132:135], v[80:83], v[208:211]
  v_cvt_pk_bf16_f32 v89, v90, v91
  v_cvt_pk_bf16_f32 v90, v92, v93
  v_mfma_f32_16x16x32_bf16 v[228:231], a[136:139], v[80:83], v[228:231]
  v_cvt_pk_bf16_f32 v91, v94, v95
  v_mfma_f32_16x16x32_bf16 v[248:251], a[140:143], v[80:83], v[248:251]
  v_mfma_f32_16x16x32_bf16 a[156:159], a[164:167], v[80:83], a[156:159]
  s_waitcnt vmcnt(8)
  ds_read_b128 a[80:83], v10 offset:32768
  ds_read_b128 a[96:99], v10 offset:36864
  ds_read_b128 a[84:87], v11 offset:32768
  ds_read_b128 a[100:103], v11 offset:36864
  ds_read_b128 a[88:91], v12 offset:32768
  ds_read_b128 a[104:107], v12 offset:36864
  ds_read_b128 a[92:95], v13 offset:32768
  ds_read_b128 a[108:111], v13 offset:36864
  v_mfma_f32_16x16x32_bf16 v[112:115], a[112:115], v[88:91], v[112:115]
  v_mfma_f32_16x16x32_bf16 v[132:135], a[116:119], v[88:91], v[132:135]
  v_mfma_f32_16x16x32_bf16 v[152:155], a[120:123], v[88:91], v[152:155]
  v_mfma_f32_16x16x32_bf16 v[172:175], a[124:127], v[88:91], v[172:175]
  v_mfma_f32_16x16x32_bf16 v[192:195], a[128:131], v[88:91], v[192:195]
  v_mfma_f32_16x16x32_bf16 v[212:215], a[132:135], v[88:91], v[212:215]
  v_mfma_f32_16x16x32_bf16 v[232:235], a[136:139], v[88:91], v[232:235]
  v_mfma_f32_16x16x32_bf16 v[252:255], a[140:143], v[88:91], v[252:255]
  v_mfma_f32_16x16x32_bf16 a[160:163], a[164:167], v[88:91], a[160:163]
  v_lshlrev_b32 v53, 4, v1
  v_add_u32 v53, s32, v53
  v_add_u32 v54, 65536, v53
  s_waitcnt lgkmcnt(0)
  v_mfma_f32_16x16x32_bf16 v[56:59], a[80:83], a[0:3], v[24:27]
  v_mfma_f32_16x16x32_bf16 v[60:63], a[96:99], a[0:3], v[24:27]
  v_mfma_f32_16x16x32_bf16 v[56:59], a[84:87], a[4:7], v[56:59]
  v_mfma_f32_16x16x32_bf16 v[60:63], a[100:103], a[4:7], v[60:63]
  v_mfma_f32_16x16x32_bf16 v[56:59], a[88:91], a[8:11], v[56:59]
  v_mfma_f32_16x16x32_bf16 v[60:63], a[104:107], a[8:11], v[60:63]
  v_mfma_f32_16x16x32_bf16 v[56:59], a[92:95], a[12:15], v[56:59]
  v_mfma_f32_16x16x32_bf16 v[60:63], a[108:111], a[12:15], v[60:63]
  v_mfma_f32_16x16x32_bf16 v[64:67], a[80:83], a[16:19], v[28:31]
  v_mfma_f32_16x16x32_bf16 v[68:71], a[96:99], a[16:19], v[28:31]
  v_mfma_f32_16x16x32_bf16 v[64:67], a[84:87], a[20:23], v[64:67]
  v_mfma_f32_16x16x32_bf16 v[68:71], a[100:103], a[20:23], v[68:71]
  v_mfma_f32_16x16x32_bf16 v[64:67], a[88:91], a[24:27], v[64:67]
  v_mfma_f32_16x16x32_bf16 v[68:71], a[104:107], a[24:27], v[68:71]
  v_mfma_f32_16x16x32_bf16 v[64:67], a[92:95], a[28:31], v[64:67]
  v_mfma_f32_16x16x32_bf16 v[68:71], a[108:111], a[28:31], v[68:71]
  v_mfma_f32_16x16x32_bf16 v[72:75], a[80:83], a[32:35], v[32:35]
  v_mfma_f32_16x16x32_bf16 v[76:79], a[96:99], a[32:35], v[32:35]
  v_max3_f32 v44, v56, v57, v58
  v_mfma_f32_16x16x32_bf16 v[72:75], a[84:87], a[36:39], v[72:75]
  v_max3_f32 v44, v44, v59, v60
  v_mfma_f32_16x16x32_bf16 v[76:79], a[100:103], a[36:39], v[76:79]
  v_mfma_f32_16x16x32_bf16 v[72:75], a[88:91], a[40:43], v[72:75]
  v_max3_f32 v44, v44, v61, v62
  v_mfma_f32_16x16x32_bf16 v[76:79], a[104:107], a[40:43], v[76:79]
  v_mfma_f32_16x16x32_bf16 v[72:75], a[92:95], a[44:47], v[72:75]
  v_max_f32 v44, v44, v63
  v_mfma_f32_16x16x32_bf16 v[76:79], a[108:111], a[44:47], v[76:79]
  v_mfma_f32_16x16x32_bf16 v[80:83], a[80:83], a[48:51], v[36:39]
  v_mfma_f32_16x16x32_bf16 v[84:87], a[96:99], a[48:51], v[36:39]
  v_max3_f32 v45, v64, v65, v66
  v_mfma_f32_16x16x32_bf16 v[80:83], a[84:87], a[52:55], v[80:83]
  v_max3_f32 v45, v45, v67, v68
  v_mfma_f32_16x16x32_bf16 v[84:87], a[100:103], a[52:55], v[84:87]
  v_mfma_f32_16x16x32_bf16 v[80:83], a[88:91], a[56:59], v[80:83]
  v_max3_f32 v45, v45, v69, v70
  v_mfma_f32_16x16x32_bf16 v[84:87], a[104:107], a[56:59], v[84:87]
  v_mfma_f32_16x16x32_bf16 v[80:83], a[92:95], a[60:63], v[80:83]
  v_max_f32 v45, v45, v71
  v_mfma_f32_16x16x32_bf16 v[84:87], a[108:111], a[60:63], v[84:87]
  s_waitcnt vmcnt(0)
  v_mfma_f32_16x16x32_bf16 v[88:91], a[80:83], a[64:67], v[40:43]
  v_max3_f32 v46, v72, v73, v74
  v_max3_f32 v46, v46, v75, v76
  v_mfma_f32_16x16x32_bf16 v[92:95], a[96:99], a[64:67], v[40:43]
  ds_read_b64_tr_b16 a[112:113], v14 offset:32768
  v_mfma_f32_16x16x32_bf16 v[88:91], a[84:87], a[68:71], v[88:91]
  ds_read_b64_tr_b16 a[114:115], v14 offset:36864
  ds_read_b64_tr_b16 a[116:117], v15 offset:32768
  v_mfma_f32_16x16x32_bf16 v[92:95], a[100:103], a[68:71], v[92:95]
  ds_read_b64_tr_b16 a[118:119], v15 offset:36864
  v_mfma_f32_16x16x32_bf16 v[88:91], a[88:91], a[72:75], v[88:91]
  v_max3_f32 v46, v46, v77, v78
  v_max_f32 v46, v46, v79
  v_mfma_f32_16x16x32_bf16 v[92:95], a[104:107], a[72:75], v[92:95]
  ds_read_b64_tr_b16 a[120:121], v16 offset:32768
  v_mfma_f32_16x16x32_bf16 v[88:91], a[92:95], a[76:79], v[88:91]
  ds_read_b64_tr_b16 a[122:123], v16 offset:36864
  ds_read_b64_tr_b16 a[124:125], v17 offset:32768
  v_mfma_f32_16x16x32_bf16 v[92:95], a[108:111], a[76:79], v[92:95]
  ds_read_b64_tr_b16 a[126:127], v17 offset:36864
  ds_read_b64_tr_b16 a[128:129], v18 offset:32768
  ds_read_b64_tr_b16 a[130:131], v18 offset:36864
  ds_read_b64_tr_b16 a[132:133], v19 offset:32768
  ds_read_b64_tr_b16 a[134:135], v19 offset:36864
  ds_read_b64_tr_b16 a[136:137], v20 offset:32768
  ds_read_b64_tr_b16 a[138:139], v20 offset:36864
  ds_read_b64_tr_b16 a[140:141], v21 offset:32768
  ds_read_b64_tr_b16 a[142:143], v21 offset:36864
  v_max3_f32 v47, v80, v81, v82
  v_max3_f32 v47, v47, v83, v84
  v_max3_f32 v47, v47, v85, v86
  v_max_f32 v47, v47, v87
  v_max3_f32 v48, v88, v89, v90
  v_max3_f32 v48, v48, v91, v92
  v_max3_f32 v48, v48, v93, v94
  v_max_f32 v48, v48, v95
  v_max3_f32 v49, v44, v45, v46
  v_max3_f32 v49, v49, v47, v48
  v_cmp_lt_f32 vcc, s29, v49
  s_cbranch_vccnz L_concat_heads__gqa_block_cached__mha_block_cached__near_ridge_kernel_rare5
L_concat_heads__gqa_block_cached__mha_block_cached__near_ridge_kernel_back5:
  v_exp_f32 v56, v56
  v_exp_f32 v57, v57
  v_exp_f32 v58, v58
  v_exp_f32 v59, v59
  v_exp_f32 v60, v60
  v_exp_f32 v61, v61
  v_exp_f32 v62, v62
  v_exp_f32 v63, v63
  v_cvt_pk_bf16_f32 v56, v56, v57
  v_cvt_pk_bf16_f32 v57, v58, v59
  v_cvt_pk_bf16_f32 v58, v60, v61
  v_cvt_pk_bf16_f32 v59, v62, v63
  s_waitcnt lgkmcnt(0)
  s_nop 0
  v_mfma_f32_16x16x32_bf16 v[96:99], a[112:115], v[56:59], v[96:99]
  v_exp_f32 v64, v64
  v_exp_f32 v65, v65
  v_mfma_f32_16x16x32_bf16 v[116:119], a[116:119], v[56:59], v[116:119]
  v_exp_f32 v66, v66
  v_exp_f32 v67, v67
  v_mfma_f32_16x16x32_bf16 v[136:139], a[120:123], v[56:59], v[136:139]
  v_exp_f32 v68, v68
  v_exp_f32 v69, v69
  v_mfma_f32_16x16x32_bf16 v[156:159], a[124:127], v[56:59], v[156:159]
  v_exp_f32 v70, v70
  v_mfma_f32_16x16x32_bf16 v[176:179], a[128:131], v[56:59], v[176:179]
  v_exp_f32 v71, v71
  v_cvt_pk_bf16_f32 v64, v64, v65
  v_mfma_f32_16x16x32_bf16 v[196:199], a[132:135], v[56:59], v[196:199]
  v_cvt_pk_bf16_f32 v65, v66, v67
  v_cvt_pk_bf16_f32 v66, v68, v69
  v_mfma_f32_16x16x32_bf16 v[216:219], a[136:139], v[56:59], v[216:219]
  v_cvt_pk_bf16_f32 v67, v70, v71
  v_mfma_f32_16x16x32_bf16 v[236:239], a[140:143], v[56:59], v[236:239]
  v_mfma_f32_16x16x32_bf16 a[144:147], a[164:167], v[56:59], a[144:147]
  v_mfma_f32_16x16x32_bf16 v[100:103], a[112:115], v[64:67], v[100:103]
  v_exp_f32 v72, v72
  v_exp_f32 v73, v73
  v_exp_f32 v74, v74
  v_mfma_f32_16x16x32_bf16 v[120:123], a[116:119], v[64:67], v[120:123]
  v_exp_f32 v75, v75
  v_exp_f32 v76, v76
  v_mfma_f32_16x16x32_bf16 v[140:143], a[120:123], v[64:67], v[140:143]
  v_exp_f32 v77, v77
  v_exp_f32 v78, v78
  v_mfma_f32_16x16x32_bf16 v[160:163], a[124:127], v[64:67], v[160:163]
  v_exp_f32 v79, v79
  ds_write_b128 v53, v[176:179] offset:0
  ds_write_b128 v53, v[196:199] offset:1024
  v_mfma_f32_16x16x32_bf16 v[180:183], a[128:131], v[64:67], v[180:183]
  v_cvt_pk_bf16_f32 v72, v72, v73
  v_cvt_pk_bf16_f32 v73, v74, v75
  v_mfma_f32_16x16x32_bf16 v[200:203], a[132:135], v[64:67], v[200:203]
  v_cvt_pk_bf16_f32 v74, v76, v77
  v_cvt_pk_bf16_f32 v75, v78, v79
  v_mfma_f32_16x16x32_bf16 v[220:223], a[136:139], v[64:67], v[220:223]
  ds_write_b128 v53, v[216:219] offset:2048
  ds_write_b128 v53, v[236:239] offset:3072
  v_mfma_f32_16x16x32_bf16 v[240:243], a[140:143], v[64:67], v[240:243]
  v_mfma_f32_16x16x32_bf16 a[148:151], a[164:167], v[64:67], a[148:151]
  v_mfma_f32_16x16x32_bf16 v[104:107], a[112:115], v[72:75], v[104:107]
  v_exp_f32 v80, v80
  v_exp_f32 v81, v81
  v_exp_f32 v82, v82
  v_mfma_f32_16x16x32_bf16 v[124:127], a[116:119], v[72:75], v[124:127]
  v_exp_f32 v83, v83
  v_exp_f32 v84, v84
  v_mfma_f32_16x16x32_bf16 v[144:147], a[120:123], v[72:75], v[144:147]
  v_exp_f32 v85, v85
  v_exp_f32 v86, v86
  v_mfma_f32_16x16x32_bf16 v[164:167], a[124:127], v[72:75], v[164:167]
  v_exp_f32 v87, v87
  ds_write_b128 v53, v[180:183] offset:4096
  ds_write_b128 v53, v[200:203] offset:5120
  v_mfma_f32_16x16x32_bf16 v[184:187], a[128:131], v[72:75], v[184:187]
  v_cvt_pk_bf16_f32 v80, v80, v81
  v_cvt_pk_bf16_f32 v81, v82, v83
  v_mfma_f32_16x16x32_bf16 v[204:207], a[132:135], v[72:75], v[204:207]
  v_cvt_pk_bf16_f32 v82, v84, v85
  v_cvt_pk_bf16_f32 v83, v86, v87
  v_mfma_f32_16x16x32_bf16 v[224:227], a[136:139], v[72:75], v[224:227]
  ds_write_b128 v53, v[220:223] offset:6144
  ds_write_b128 v53, v[240:243] offset:7168
  v_mfma_f32_16x16x32_bf16 v[244:247], a[140:143], v[72:75], v[244:247]
  v_mfma_f32_16x16x32_bf16 a[152:155], a[164:167], v[72:75], a[152:155]
  v_mfma_f32_16x16x32_bf16 v[108:111], a[112:115], v[80:83], v[108:111]
  v_exp_f32 v88, v88
  v_exp_f32 v89, v89
  v_exp_f32 v90, v90
  v_mfma_f32_16x16x32_bf16 v[128:131], a[116:119], v[80:83], v[128:131]
  v_exp_f32 v91, v91
  v_exp_f32 v92, v92
  v_mfma_f32_16x16x32_bf16 v[148:151], a[120:123], v[80:83], v[148:151]
  v_exp_f32 v93, v93
  v_exp_f32 v94, v94
  v_mfma_f32_16x16x32_bf16 v[168:171], a[124:127], v[80:83], v[168:171]
  v_exp_f32 v95, v95
  ds_write_b128 v53, v[184:187] offset:32768
  ds_write_b128 v53, v[204:207] offset:33792
  v_mfma_f32_16x16x32_bf16 v[188:191], a[128:131], v[80:83], v[188:191]
  v_cvt_pk_bf16_f32 v88, v88, v89
  v_cvt_pk_bf16_f32 v89, v90, v91
  v_mfma_f32_16x16x32_bf16 v[208:211], a[132:135], v[80:83], v[208:211]
  v_cvt_pk_bf16_f32 v90, v92, v93
  v_cvt_pk_bf16_f32 v91, v94, v95
  v_mfma_f32_16x16x32_bf16 v[228:231], a[136:139], v[80:83], v[228:231]
  ds_write_b128 v53, v[224:227] offset:34816
  ds_write_b128 v53, v[244:247] offset:35840
  v_mfma_f32_16x16x32_bf16 v[248:251], a[140:143], v[80:83], v[248:251]
  v_mfma_f32_16x16x32_bf16 a[156:159], a[164:167], v[80:83], a[156:159]
  v_mfma_f32_16x16x32_bf16 v[112:115], a[112:115], v[88:91], v[112:115]
  v_mfma_f32_16x16x32_bf16 v[132:135], a[116:119], v[88:91], v[132:135]
  v_mfma_f32_16x16x32_bf16 v[152:155], a[120:123], v[88:91], v[152:155]
  v_mfma_f32_16x16x32_bf16 v[172:175], a[124:127], v[88:91], v[172:175]
  ds_write_b128 v53, v[188:191] offset:36864
  v_mfma_f32_16x16x32_bf16 v[192:195], a[128:131], v[88:91], v[192:195]
  ds_write_b128 v53, v[208:211] offset:37888
  v_mfma_f32_16x16x32_bf16 v[212:215], a[132:135], v[88:91], v[212:215]
  v_mfma_f32_16x16x32_bf16 v[232:235], a[136:139], v[88:91], v[232:235]
  ds_write_b128 v53, v[228:231] offset:38912
  v_mfma_f32_16x16x32_bf16 v[252:255], a[140:143], v[88:91], v[252:255]
  ds_write_b128 v53, v[248:251] offset:39936
  v_mfma_f32_16x16x32_bf16 a[160:163], a[164:167], v[88:91], a[160:163]
  s_nop 0
  ds_write_b128 v54, v[192:195] offset:0
  s_nop 0
  ds_write_b128 v54, v[212:215] offset:1024
  ds_write_b128 v54, v[232:235] offset:2048
  s_nop 0
  ds_write_b128 v54, v[252:255] offset:3072
  v_sub_f32 v86, 0, v24
  v_accvgpr_read_b32 v91, a144
  v_sub_f32 v87, 0, v28
  v_accvgpr_read_b32 v92, a148
  v_sub_f32 v88, 0, v32
  v_accvgpr_read_b32 v93, a152
  v_sub_f32 v89, 0, v36
  v_accvgpr_read_b32 v94, a156
  v_sub_f32 v90, 0, v40
  v_accvgpr_read_b32 v95, a160
  s_mul_i32 s37, s24, 640
  s_add_u32 s37, s37, 131072
  v_lshlrev_b32 v44, 3, v2
  v_add_u32 v46, s37, v44
  s_xor_b32 s38, s24, 1
  s_mul_i32 s39, s38, 640
  s_add_u32 s39, s39, 131072
  v_add_u32 v47, s39, v44
  ds_write2_b32 v46, v86, v91 offset0:0 offset1:1
  ds_write2_b32 v46, v87, v92 offset0:32 offset1:33
  ds_write2_b32 v46, v88, v93 offset0:64 offset1:65
  ds_write2_b32 v46, v89, v94 offset0:96 offset1:97
  ds_write2_b32 v46, v90, v95 offset0:128 offset1:129
  s_lshl_b32 s38, s38, 13
  v_lshlrev_b32 v44, 4, v1
  v_add_u32 v23, s38, v44
  v_add_u32 v45, 65536, v23
  s_waitcnt lgkmcnt(0)
  s_barrier
  ds_read_b64 v[56:57], v47 offset:0
  ds_read_b64 v[58:59], v47 offset:128
  ds_read_b64 v[60:61], v47 offset:256
  ds_read_b64 v[62:63], v47 offset:384
  ds_read_b64 v[64:65], v47 offset:512
  ds_read_b128 v[176:179], v23 offset:0
  ds_read_b128 v[196:199], v23 offset:1024
  ds_read_b128 v[216:219], v23 offset:2048
  ds_read_b128 v[236:239], v23 offset:3072
  ds_read_b128 v[180:183], v23 offset:4096
  ds_read_b128 v[200:203], v23 offset:5120
  ds_read_b128 v[220:223], v23 offset:6144
  ds_read_b128 v[240:243], v23 offset:7168
  s_waitcnt lgkmcnt(8)
  v_max_f32 v66, v86, v56
  v_max_f32 v67, v87, v58
  v_max_f32 v68, v88, v60
  v_max_f32 v69, v89, v62
  v_max_f32 v70, v90, v64
  v_sub_f32 v48, v86, v66
  v_sub_f32 v56, v56, v66
  v_sub_f32 v49, v87, v67
  v_sub_f32 v58, v58, v67
  v_sub_f32 v50, v88, v68
  v_sub_f32 v60, v60, v68
  v_sub_f32 v51, v89, v69
  v_sub_f32 v62, v62, v69
  v_sub_f32 v52, v90, v70
  v_sub_f32 v64, v64, v70
  v_exp_f32 v48, v48
  v_exp_f32 v56, v56
  v_exp_f32 v49, v49
  v_exp_f32 v58, v58
  v_exp_f32 v50, v50
  v_exp_f32 v60, v60
  v_exp_f32 v51, v51
  v_exp_f32 v62, v62
  v_exp_f32 v52, v52
  v_exp_f32 v64, v64
  v_mul_f32 v57, v57, v56
  v_mul_f32 v59, v59, v58
  v_mul_f32 v61, v61, v60
  v_mul_f32 v63, v63, v62
  v_mul_f32 v65, v65, v64
  v_fma_f32 v57, v91, v48, v57
  v_fma_f32 v59, v92, v49, v59
  v_fma_f32 v61, v93, v50, v61
  v_fma_f32 v63, v94, v51, v63
  v_fma_f32 v65, v95, v52, v65
  v_rcp_f32 v57, v57
  v_rcp_f32 v59, v59
  v_rcp_f32 v61, v61
  v_rcp_f32 v63, v63
  v_rcp_f32 v65, v65
  v_mul_f32 v72, v48, v57
  v_mul_f32 v56, v56, v57
  v_mul_f32 v74, v49, v59
  v_mul_f32 v58, v58, v59
  v_mul_f32 v76, v50, v61
  v_mul_f32 v60, v60, v61
  v_mul_f32 v78, v51, v63
  v_mul_f32 v62, v62, v63
  v_mul_f32 v80, v52, v65
  v_mul_f32 v64, v64, v65
  v_lshlrev_b32 v50, 4, v1
  ds_read_b128 v[184:187], v23 offset:32768
  ds_read_b128 v[204:207], v23 offset:33792
  ds_read_b128 v[224:227], v23 offset:34816
  ds_read_b128 v[244:247], v23 offset:35840
  s_waitcnt lgkmcnt(8)
  v_pk_mul_f32 v[176:177], v[176:177], v[56:57] op_sel_hi:[1,0]
  v_pk_mul_f32 v[178:179], v[178:179], v[56:57] op_sel_hi:[1,0]
  v_pk_fma_f32 v[96:97], v[96:97], v[72:73], v[176:177] op_sel_hi:[1,0,1]
  v_pk_fma_f32 v[98:99], v[98:99], v[72:73], v[178:179] op_sel_hi:[1,0,1]
  v_pk_mul_f32 v[196:197], v[196:197], v[56:57] op_sel_hi:[1,0]
  v_pk_mul_f32 v[198:199], v[198:199], v[56:57] op_sel_hi:[1,0]
  v_pk_fma_f32 v[116:117], v[116:117], v[72:73], v[196:197] op_sel_hi:[1,0,1]
  v_pk_fma_f32 v[118:119], v[118:119], v[72:73], v[198:199] op_sel_hi:[1,0,1]
  v_pk_mul_f32 v[216:217], v[216:217], v[56:57] op_sel_hi:[1,0]
  v_pk_mul_f32 v[218:219], v[218:219], v[56:57] op_sel_hi:[1,0]
  v_pk_fma_f32 v[136:137], v[136:137], v[72:73], v[216:217] op_sel_hi:[1,0,1]
  v_pk_fma_f32 v[138:139], v[138:139], v[72:73], v[218:219] op_sel_hi:[1,0,1]
  v_pk_mul_f32 v[236:237], v[236:237], v[56:57] op_sel_hi:[1,0]
  v_pk_mul_f32 v[238:239], v[238:239], v[56:57] op_sel_hi:[1,0]
  v_pk_fma_f32 v[156:157], v[156:157], v[72:73], v[236:237] op_sel_hi:[1,0,1]
  v_pk_fma_f32 v[158:159], v[158:159], v[72:73], v[238:239] op_sel_hi:[1,0,1]
  v_cvt_pk_bf16_f32 v96, v96, v97
  v_cvt_pk_bf16_f32 v97, v98, v99
  v_cvt_pk_bf16_f32 v98, v116, v117
  v_cvt_pk_bf16_f32 v99, v118, v119
  buffer_store_dwordx4 v[96:99], v50, s[20:23], s36 offen offset:0 sc1
  v_cvt_pk_bf16_f32 v136, v136, v137
  v_cvt_pk_bf16_f32 v137, v138, v139
  v_cvt_pk_bf16_f32 v138, v156, v157
  v_cvt_pk_bf16_f32 v139, v158, v159
  buffer_store_dwordx4 v[136:139], v50, s[20:23], s36 offen offset:1024 sc1
  s_add_u32 s36, s36, 131072
  ds_read_b128 v[188:191], v23 offset:36864
  ds_read_b128 v[208:211], v23 offset:37888
  ds_read_b128 v[228:231], v23 offset:38912
  ds_read_b128 v[248:251], v23 offset:39936
  s_waitcnt lgkmcnt(8)
  v_pk_mul_f32 v[180:181], v[180:181], v[58:59] op_sel_hi:[1,0]
  v_pk_mul_f32 v[182:183], v[182:183], v[58:59] op_sel_hi:[1,0]
  v_pk_fma_f32 v[100:101], v[100:101], v[74:75], v[180:181] op_sel_hi:[1,0,1]
  v_pk_fma_f32 v[102:103], v[102:103], v[74:75], v[182:183] op_sel_hi:[1,0,1]
  v_pk_mul_f32 v[200:201], v[200:201], v[58:59] op_sel_hi:[1,0]
  v_pk_mul_f32 v[202:203], v[202:203], v[58:59] op_sel_hi:[1,0]
  v_pk_fma_f32 v[120:121], v[120:121], v[74:75], v[200:201] op_sel_hi:[1,0,1]
  v_pk_fma_f32 v[122:123], v[122:123], v[74:75], v[202:203] op_sel_hi:[1,0,1]
  v_pk_mul_f32 v[220:221], v[220:221], v[58:59] op_sel_hi:[1,0]
  v_pk_mul_f32 v[222:223], v[222:223], v[58:59] op_sel_hi:[1,0]
  v_pk_fma_f32 v[140:141], v[140:141], v[74:75], v[220:221] op_sel_hi:[1,0,1]
  v_pk_fma_f32 v[142:143], v[142:143], v[74:75], v[222:223] op_sel_hi:[1,0,1]
  v_pk_mul_f32 v[240:241], v[240:241], v[58:59] op_sel_hi:[1,0]
  v_pk_mul_f32 v[242:243], v[242:243], v[58:59] op_sel_hi:[1,0]
  v_pk_fma_f32 v[160:161], v[160:161], v[74:75], v[240:241] op_sel_hi:[1,0,1]
  v_pk_fma_f32 v[162:163], v[162:163], v[74:75], v[242:243] op_sel_hi:[1,0,1]
  v_cvt_pk_bf16_f32 v100, v100, v101
  v_cvt_pk_bf16_f32 v101, v102, v103
  v_cvt_pk_bf16_f32 v102, v120, v121
  v_cvt_pk_bf16_f32 v103, v122, v123
  buffer_store_dwordx4 v[100:103], v50, s[20:23], s36 offen offset:0 sc1
  v_cvt_pk_bf16_f32 v140, v140, v141
  v_cvt_pk_bf16_f32 v141, v142, v143
  v_cvt_pk_bf16_f32 v142, v160, v161
  v_cvt_pk_bf16_f32 v143, v162, v163
  buffer_store_dwordx4 v[140:143], v50, s[20:23], s36 offen offset:1024 sc1
  s_add_u32 s36, s36, 131072
  ds_read_b128 v[192:195], v45 offset:0
  ds_read_b128 v[212:215], v45 offset:1024
  ds_read_b128 v[232:235], v45 offset:2048
  ds_read_b128 v[252:255], v45 offset:3072
  s_waitcnt lgkmcnt(8)
  v_pk_mul_f32 v[184:185], v[184:185], v[60:61] op_sel_hi:[1,0]
  v_pk_mul_f32 v[186:187], v[186:187], v[60:61] op_sel_hi:[1,0]
  v_pk_fma_f32 v[104:105], v[104:105], v[76:77], v[184:185] op_sel_hi:[1,0,1]
  v_pk_fma_f32 v[106:107], v[106:107], v[76:77], v[186:187] op_sel_hi:[1,0,1]
  v_pk_mul_f32 v[204:205], v[204:205], v[60:61] op_sel_hi:[1,0]
  v_pk_mul_f32 v[206:207], v[206:207], v[60:61] op_sel_hi:[1,0]
  v_pk_fma_f32 v[124:125], v[124:125], v[76:77], v[204:205] op_sel_hi:[1,0,1]
  v_pk_fma_f32 v[126:127], v[126:127], v[76:77], v[206:207] op_sel_hi:[1,0,1]
  v_pk_mul_f32 v[224:225], v[224:225], v[60:61] op_sel_hi:[1,0]
  v_pk_mul_f32 v[226:227], v[226:227], v[60:61] op_sel_hi:[1,0]
  v_pk_fma_f32 v[144:145], v[144:145], v[76:77], v[224:225] op_sel_hi:[1,0,1]
  v_pk_fma_f32 v[146:147], v[146:147], v[76:77], v[226:227] op_sel_hi:[1,0,1]
  v_pk_mul_f32 v[244:245], v[244:245], v[60:61] op_sel_hi:[1,0]
  v_pk_mul_f32 v[246:247], v[246:247], v[60:61] op_sel_hi:[1,0]
  v_pk_fma_f32 v[164:165], v[164:165], v[76:77], v[244:245] op_sel_hi:[1,0,1]
  v_pk_fma_f32 v[166:167], v[166:167], v[76:77], v[246:247] op_sel_hi:[1,0,1]
  v_cvt_pk_bf16_f32 v104, v104, v105
  v_cvt_pk_bf16_f32 v105, v106, v107
  v_cvt_pk_bf16_f32 v106, v124, v125
  v_cvt_pk_bf16_f32 v107, v126, v127
  buffer_store_dwordx4 v[104:107], v50, s[20:23], s36 offen offset:0 sc1
  v_cvt_pk_bf16_f32 v144, v144, v145
  v_cvt_pk_bf16_f32 v145, v146, v147
  v_cvt_pk_bf16_f32 v146, v164, v165
  v_cvt_pk_bf16_f32 v147, v166, v167
  buffer_store_dwordx4 v[144:147], v50, s[20:23], s36 offen offset:1024 sc1
  s_add_u32 s36, s36, 131072
  s_waitcnt lgkmcnt(4)
  v_pk_mul_f32 v[188:189], v[188:189], v[62:63] op_sel_hi:[1,0]
  v_pk_mul_f32 v[190:191], v[190:191], v[62:63] op_sel_hi:[1,0]
  v_pk_fma_f32 v[108:109], v[108:109], v[78:79], v[188:189] op_sel_hi:[1,0,1]
  v_pk_fma_f32 v[110:111], v[110:111], v[78:79], v[190:191] op_sel_hi:[1,0,1]
  v_pk_mul_f32 v[208:209], v[208:209], v[62:63] op_sel_hi:[1,0]
  v_pk_mul_f32 v[210:211], v[210:211], v[62:63] op_sel_hi:[1,0]
  v_pk_fma_f32 v[128:129], v[128:129], v[78:79], v[208:209] op_sel_hi:[1,0,1]
  v_pk_fma_f32 v[130:131], v[130:131], v[78:79], v[210:211] op_sel_hi:[1,0,1]
  v_pk_mul_f32 v[228:229], v[228:229], v[62:63] op_sel_hi:[1,0]
  v_pk_mul_f32 v[230:231], v[230:231], v[62:63] op_sel_hi:[1,0]
  v_pk_fma_f32 v[148:149], v[148:149], v[78:79], v[228:229] op_sel_hi:[1,0,1]
  v_pk_fma_f32 v[150:151], v[150:151], v[78:79], v[230:231] op_sel_hi:[1,0,1]
  v_pk_mul_f32 v[248:249], v[248:249], v[62:63] op_sel_hi:[1,0]
  v_pk_mul_f32 v[250:251], v[250:251], v[62:63] op_sel_hi:[1,0]
  v_pk_fma_f32 v[168:169], v[168:169], v[78:79], v[248:249] op_sel_hi:[1,0,1]
  v_pk_fma_f32 v[170:171], v[170:171], v[78:79], v[250:251] op_sel_hi:[1,0,1]
  v_cvt_pk_bf16_f32 v108, v108, v109
  v_cvt_pk_bf16_f32 v109, v110, v111
  v_cvt_pk_bf16_f32 v110, v128, v129
  v_cvt_pk_bf16_f32 v111, v130, v131
  buffer_store_dwordx4 v[108:111], v50, s[20:23], s36 offen offset:0 sc1
  v_cvt_pk_bf16_f32 v148, v148, v149
  v_cvt_pk_bf16_f32 v149, v150, v151
  v_cvt_pk_bf16_f32 v150, v168, v169
  v_cvt_pk_bf16_f32 v151, v170, v171
  buffer_store_dwordx4 v[148:151], v50, s[20:23], s36 offen offset:1024 sc1
  s_add_u32 s36, s36, 131072
  s_waitcnt lgkmcnt(0)
  v_pk_mul_f32 v[192:193], v[192:193], v[64:65] op_sel_hi:[1,0]
  v_pk_mul_f32 v[194:195], v[194:195], v[64:65] op_sel_hi:[1,0]
  v_pk_fma_f32 v[112:113], v[112:113], v[80:81], v[192:193] op_sel_hi:[1,0,1]
  v_pk_fma_f32 v[114:115], v[114:115], v[80:81], v[194:195] op_sel_hi:[1,0,1]
  v_pk_mul_f32 v[212:213], v[212:213], v[64:65] op_sel_hi:[1,0]
  v_pk_mul_f32 v[214:215], v[214:215], v[64:65] op_sel_hi:[1,0]
  v_pk_fma_f32 v[132:133], v[132:133], v[80:81], v[212:213] op_sel_hi:[1,0,1]
  v_pk_fma_f32 v[134:135], v[134:135], v[80:81], v[214:215] op_sel_hi:[1,0,1]
  v_pk_mul_f32 v[232:233], v[232:233], v[64:65] op_sel_hi:[1,0]
  v_pk_mul_f32 v[234:235], v[234:235], v[64:65] op_sel_hi:[1,0]
  v_pk_fma_f32 v[152:153], v[152:153], v[80:81], v[232:233] op_sel_hi:[1,0,1]
  v_pk_fma_f32 v[154:155], v[154:155], v[80:81], v[234:235] op_sel_hi:[1,0,1]
  v_pk_mul_f32 v[252:253], v[252:253], v[64:65] op_sel_hi:[1,0]
  v_pk_mul_f32 v[254:255], v[254:255], v[64:65] op_sel_hi:[1,0]
  v_pk_fma_f32 v[172:173], v[172:173], v[80:81], v[252:253] op_sel_hi:[1,0,1]
  v_pk_fma_f32 v[174:175], v[174:175], v[80:81], v[254:255] op_sel_hi:[1,0,1]
  v_cvt_pk_bf16_f32 v112, v112, v113
  v_cvt_pk_bf16_f32 v113, v114, v115
  v_cvt_pk_bf16_f32 v114, v132, v133
  v_cvt_pk_bf16_f32 v115, v134, v135
  buffer_store_dwordx4 v[112:115], v50, s[20:23], s36 offen offset:0 sc1
  v_cvt_pk_bf16_f32 v152, v152, v153
  v_cvt_pk_bf16_f32 v153, v154, v155
  v_cvt_pk_bf16_f32 v154, v172, v173
  v_cvt_pk_bf16_f32 v155, v174, v175
  buffer_store_dwordx4 v[152:155], v50, s[20:23], s36 offen offset:1024 sc1
  s_load_dwordx2 s[42:43], s[0:1], 72
  s_load_dwordx4 s[44:47], s[0:1], 80
  s_mov_b32 s64, 0
  s_and_b32 s37, s2, 7
  s_lshr_b32 s38, s2, 3
  s_lshr_b32 s4, s37, 2
  s_and_b32 s33, s37, 1
  s_bfe_u32 s34, s37, 0x10001
  s_mul_i32 s33, s33, 7
  s_cmp_lt_u32 s38, 28
  s_cbranch_scc0 L_concat_heads__gqa_block_cached__mha_block_cached__near_ridge_kernel_extra
  s_lshr_b32 s61, s38, 2
  s_add_u32 s61, s61, s33
  s_and_b32 s62, s38, 3
  s_mul_i32 s34, s34, 5
  s_add_u32 s62, s62, s34
  s_branch L_concat_heads__gqa_block_cached__mha_block_cached__near_ridge_kernel_dec
L_concat_heads__gqa_block_cached__mha_block_cached__near_ridge_kernel_extra:
  s_sub_u32 s38, s38, 28
  s_lshl_b32 s35, s34, 2
  s_add_u32 s61, s38, s35
  s_cmp_ge_u32 s61, 7
  s_cselect_b32 s64, 1, 0
  s_cselect_b32 s61, 0, s61
  s_add_u32 s61, s61, s33
  s_mov_b32 s62, 4
L_concat_heads__gqa_block_cached__mha_block_cached__near_ridge_kernel_dec:
  s_lshl_b32 s6, s62, 6
  s_mul_i32 s5, s61, 3
  s_add_u32 s65, s61, s62
  s_mul_i32 s38, s65, 37
  s_lshr_b32 s38, s38, 8
  s_mul_i32 s38, s38, 7
  s_sub_u32 s65, s65, s38
  s_mul_i32 s65, s65, 147
  s_lshr_b32 s65, s65, 6
  s_mov_b32 s98, 0
  s_mov_b32 s99, 0
  s_movk_i32 s38, 1152
  v_lshrrev_b32 v4, 3, v1
  v_mul_lo_u32 v4, v4, s38
  v_lshlrev_b32 v5, 1, v3
  v_and_b32 v6, 7, v1
  v_xor_b32 v5, v5, v6
  v_lshl_add_u32 v10, v5, 4, v4
  v_add_u32 v11, 8192, v10
  v_add_u32 v12, 16384, v10
  v_add_u32 v13, 24576, v10
  v_lshlrev_b32 v14, 4, v1
  s_mul_i32 s31, s24, 40960
  v_bfe_u32 v4, v1, 2, 2
  v_lshl_add_u32 v4, v3, 2, v4
  v_bfe_u32 v5, v4, 1, 2
  v_lshlrev_b32 v5, 1, v5
  v_bfe_u32 v6, v1, 1, 1
  v_xor_b32 v5, v5, v6
  v_and_b32 v6, 1, v1
  v_lshlrev_b32 v6, 3, v6
  v_lshl_add_u32 v6, v4, 7, v6
  v_add_u32 v6, s31, v6
  s_xor_b32 s37, s24, 0
  s_lshl_b32 s37, s37, 1
  v_xor_b32 v4, s37, v5
  v_lshl_add_u32 v16, v4, 4, v6
  s_xor_b32 s37, s24, 1
  s_lshl_b32 s37, s37, 1
  v_xor_b32 v4, s37, v5
  v_lshl_add_u32 v17, v4, 4, v6
  s_xor_b32 s37, s24, 2
  s_lshl_b32 s37, s37, 1
  v_xor_b32 v4, s37, v5
  v_lshl_add_u32 v18, v4, 4, v6
  s_xor_b32 s37, s24, 3
  s_lshl_b32 s37, s37, 1
  v_xor_b32 v4, s37, v5
  v_lshl_add_u32 v19, v4, 4, v6
  s_waitcnt lgkmcnt(0)
  s_cmp_eq_u32 s4, 0
  s_cselect_b32 s40, s48, s42
  s_cselect_b32 s41, s49, s43
  s_mov_b32 s8, s40
  s_mov_b32 s9, s41
  s_mov_b32 s10, 4718592
  s_mov_b32 s11, 0x00020000
  s_mov_b32 s12, s44
  s_mov_b32 s13, s45
  s_mov_b32 s14, 1474560
  s_mov_b32 s15, 0x00020000
  s_mul_i32 s30, s24, 1179648
  s_lshl_b32 s37, s6, 1
  s_add_u32 s30, s30, s37
  s_mul_i32 s7, s4, 5242880
  s_lshl_b32 s37, s5, 17
  s_add_u32 s7, s7, s37
  s_lshl_b32 s37, s24, 15
  s_add_u32 s7, s7, s37
  s_add_u32 s33, s7, 0
  s_add_u32 s34, s7, 131072
  s_add_u32 s35, s7, 262144
  s_mov_b32 s16, s46
  s_mov_b32 s17, s47
  s_mov_b32 s18, 256
  s_mov_b32 s19, 0x00020000
  s_waitcnt vmcnt(0)
  s_barrier
  s_cmp_lg_u32 s24, 0
  s_cbranch_scc1 L_concat_heads__gqa_block_cached__mha_block_cached__near_ridge_kernel_nosig
  v_mov_b32 v4, 0
  v_mov_b32 v5, 1
  s_mov_b64 exec, 1
  buffer_atomic_add v5, v4, s[16:19], 0 offen sc0 sc1
  s_waitcnt vmcnt(0)
  v_readfirstlane_b32 s37, v5
  s_nop 1
  s_cmp_lg_u32 s37, 255
  s_cbranch_scc1 L_concat_heads__gqa_block_cached__mha_block_cached__near_ridge_kernel_notlast
  v_mov_b32 v5, 1
  buffer_store_dword v5, v4, s[16:19], 0 offen offset:128 sc1
L_concat_heads__gqa_block_cached__mha_block_cached__near_ridge_kernel_notlast:
  s_mov_b64 exec, -1
L_concat_heads__gqa_block_cached__mha_block_cached__near_ridge_kernel_nosig:
  s_cmp_lg_u32 s64, 0
  s_cbranch_scc1 L_concat_heads__gqa_block_cached__mha_block_cached__near_ridge_kernel_end
  s_add_u32 s66, s98, s65
  s_and_b32 s66, s66, 15
  s_and_b32 s37, s98, 16
  s_or_b32 s66, s66, s37
  s_lshl_b32 s66, s66, 10
  s_add_u32 s98, s98, 1
  s_add_u32 m0, s31, 0
  s_mul_i32 s66, s66, 36
  s_add_u32 s66, s66, s30
  buffer_load_dwordx4 v10, s[8:11], s66 offen offset:0 lds
  buffer_load_dwordx4 v11, s[8:11], s66 offen offset:1024 lds
  buffer_load_dwordx4 v12, s[8:11], s66 offen offset:2048 lds
  buffer_load_dwordx4 v13, s[8:11], s66 offen offset:3072 lds
  s_add_u32 s66, s98, s65
  s_and_b32 s66, s66, 15
  s_and_b32 s37, s98, 16
  s_or_b32 s66, s66, s37
  s_lshl_b32 s66, s66, 10
  s_add_u32 s98, s98, 1
  s_add_u32 m0, s31, 4096
  s_mul_i32 s66, s66, 36
  s_add_u32 s66, s66, s30
  buffer_load_dwordx4 v10, s[8:11], s66 offen offset:0 lds
  buffer_load_dwordx4 v11, s[8:11], s66 offen offset:1024 lds
  buffer_load_dwordx4 v12, s[8:11], s66 offen offset:2048 lds
  buffer_load_dwordx4 v13, s[8:11], s66 offen offset:3072 lds
  s_add_u32 s66, s98, s65
  s_and_b32 s66, s66, 15
  s_and_b32 s37, s98, 16
  s_or_b32 s66, s66, s37
  s_lshl_b32 s66, s66, 10
  s_add_u32 s98, s98, 1
  s_add_u32 m0, s31, 8192
  s_mul_i32 s66, s66, 36
  s_add_u32 s66, s66, s30
  buffer_load_dwordx4 v10, s[8:11], s66 offen offset:0 lds
  buffer_load_dwordx4 v11, s[8:11], s66 offen offset:1024 lds
  buffer_load_dwordx4 v12, s[8:11], s66 offen offset:2048 lds
  buffer_load_dwordx4 v13, s[8:11], s66 offen offset:3072 lds
  s_add_u32 s66, s98, s65
  s_and_b32 s66, s66, 15
  s_and_b32 s37, s98, 16
  s_or_b32 s66, s66, s37
  s_lshl_b32 s66, s66, 10
  s_add_u32 s98, s98, 1
  s_add_u32 m0, s31, 12288
  s_mul_i32 s66, s66, 36
  s_add_u32 s66, s66, s30
  buffer_load_dwordx4 v10, s[8:11], s66 offen offset:0 lds
  buffer_load_dwordx4 v11, s[8:11], s66 offen offset:1024 lds
  buffer_load_dwordx4 v12, s[8:11], s66 offen offset:2048 lds
  buffer_load_dwordx4 v13, s[8:11], s66 offen offset:3072 lds
  s_add_u32 s66, s98, s65
  s_and_b32 s66, s66, 15
  s_and_b32 s37, s98, 16
  s_or_b32 s66, s66, s37
  s_lshl_b32 s66, s66, 10
  s_add_u32 s98, s98, 1
  s_add_u32 m0, s31, 16384
  s_mul_i32 s66, s66, 36
  s_add_u32 s66, s66, s30
  buffer_load_dwordx4 v10, s[8:11], s66 offen offset:0 lds
  buffer_load_dwordx4 v11, s[8:11], s66 offen offset:1024 lds
  buffer_load_dwordx4 v12, s[8:11], s66 offen offset:2048 lds
  buffer_load_dwordx4 v13, s[8:11], s66 offen offset:3072 lds
  s_add_u32 s66, s98, s65
  s_and_b32 s66, s66, 15
  s_and_b32 s37, s98, 16
  s_or_b32 s66, s66, s37
  s_lshl_b32 s66, s66, 10
  s_add_u32 s98, s98, 1
  s_add_u32 m0, s31, 20480
  s_mul_i32 s66, s66, 36
  s_add_u32 s66, s66, s30
  buffer_load_dwordx4 v10, s[8:11], s66 offen offset:0 lds
  buffer_load_dwordx4 v11, s[8:11], s66 offen offset:1024 lds
  buffer_load_dwordx4 v12, s[8:11], s66 offen offset:2048 lds
  buffer_load_dwordx4 v13, s[8:11], s66 offen offset:3072 lds
  s_add_u32 s66, s98, s65
  s_and_b32 s66, s66, 15
  s_and_b32 s37, s98, 16
  s_or_b32 s66, s66, s37
  s_lshl_b32 s66, s66, 10
  s_add_u32 s98, s98, 1
  s_add_u32 m0, s31, 24576
  s_mul_i32 s66, s66, 36
  s_add_u32 s66, s66, s30
  buffer_load_dwordx4 v10, s[8:11], s66 offen offset:0 lds
  buffer_load_dwordx4 v11, s[8:11], s66 offen offset:1024 lds
  buffer_load_dwordx4 v12, s[8:11], s66 offen offset:2048 lds
  buffer_load_dwordx4 v13, s[8:11], s66 offen offset:3072 lds
  s_add_u32 s66, s98, s65
  s_and_b32 s66, s66, 15
  s_and_b32 s37, s98, 16
  s_or_b32 s66, s66, s37
  s_lshl_b32 s66, s66, 10
  s_add_u32 s98, s98, 1
  s_add_u32 m0, s31, 28672
  s_mul_i32 s66, s66, 36
  s_add_u32 s66, s66, s30
  buffer_load_dwordx4 v10, s[8:11], s66 offen offset:0 lds
  buffer_load_dwordx4 v11, s[8:11], s66 offen offset:1024 lds
  buffer_load_dwordx4 v12, s[8:11], s66 offen offset:2048 lds
  buffer_load_dwordx4 v13, s[8:11], s66 offen offset:3072 lds
  s_add_u32 s66, s98, s65
  s_and_b32 s66, s66, 15
  s_and_b32 s37, s98, 16
  s_or_b32 s66, s66, s37
  s_lshl_b32 s66, s66, 10
  s_add_u32 s98, s98, 1
  s_add_u32 m0, s31, 32768
  s_mul_i32 s66, s66, 36
  s_add_u32 s66, s66, s30
  buffer_load_dwordx4 v10, s[8:11], s66 offen offset:0 lds
  buffer_load_dwordx4 v11, s[8:11], s66 offen offset:1024 lds
  buffer_load_dwordx4 v12, s[8:11], s66 offen offset:2048 lds
  buffer_load_dwordx4 v13, s[8:11], s66 offen offset:3072 lds
  s_add_u32 s66, s98, s65
  s_and_b32 s66, s66, 15
  s_and_b32 s37, s98, 16
  s_or_b32 s66, s66, s37
  s_lshl_b32 s66, s66, 10
  s_add_u32 s98, s98, 1
  s_add_u32 m0, s31, 36864
  s_mul_i32 s66, s66, 36
  s_add_u32 s66, s66, s30
  buffer_load_dwordx4 v10, s[8:11], s66 offen offset:0 lds
  buffer_load_dwordx4 v11, s[8:11], s66 offen offset:1024 lds
  buffer_load_dwordx4 v12, s[8:11], s66 offen offset:2048 lds
  buffer_load_dwordx4 v13, s[8:11], s66 offen offset:3072 lds
  s_cmp_lg_u32 s24, 1
  s_cbranch_scc1 L_concat_heads__gqa_block_cached__mha_block_cached__near_ridge_kernel_nopoll
  v_mov_b32 v4, 128
  s_mov_b32 s32, 0
L_concat_heads__gqa_block_cached__mha_block_cached__near_ridge_kernel_poll:
  buffer_load_dword v6, v4, s[16:19], 0 offen sc1
  s_waitcnt vmcnt(0)
  v_readfirstlane_b32 s37, v6
  s_nop 1
  s_cmp_lg_u32 s37, 0
  s_cbranch_scc1 L_concat_heads__gqa_block_cached__mha_block_cached__near_ridge_kernel_nopoll
  s_add_u32 s32, s32, 1
  s_cmp_lt_u32 s32, 0x20000
  s_cbranch_scc0 L_concat_heads__gqa_block_cached__mha_block_cached__near_ridge_kernel_nopoll
  s_sleep 1
  s_branch L_concat_heads__gqa_block_cached__mha_block_cached__near_ridge_kernel_poll
L_concat_heads__gqa_block_cached__mha_block_cached__near_ridge_kernel_nopoll:
  s_barrier
  s_add_u32 s3, s99, s65
  s_and_b32 s3, s3, 15
  s_and_b32 s38, s99, 16
  s_or_b32 s3, s3, s38
  s_lshl_b32 s3, s3, 10
  s_add_u32 s99, s99, 1
  s_add_u32 s67, s33, s3
  s_add_u32 s68, s34, s3
  s_add_u32 s69, s35, s3
  buffer_load_dwordx4 v[84:87], v14, s[20:23], s67 offen sc1
  buffer_load_dwordx4 v[88:91], v14, s[20:23], s68 offen sc1
  buffer_load_dwordx4 v[92:95], v14, s[20:23], s69 offen sc1
  s_add_u32 s3, s99, s65
  s_and_b32 s3, s3, 15
  s_and_b32 s38, s99, 16
  s_or_b32 s3, s3, s38
  s_lshl_b32 s3, s3, 10
  s_add_u32 s99, s99, 1
  s_add_u32 s67, s33, s3
  s_add_u32 s68, s34, s3
  s_add_u32 s69, s35, s3
  buffer_load_dwordx4 v[96:99], v14, s[20:23], s67 offen sc1
  buffer_load_dwordx4 v[100:103], v14, s[20:23], s68 offen sc1
  buffer_load_dwordx4 v[104:107], v14, s[20:23], s69 offen sc1
  s_add_u32 s3, s99, s65
  s_and_b32 s3, s3, 15
  s_and_b32 s38, s99, 16
  s_or_b32 s3, s3, s38
  s_lshl_b32 s3, s3, 10
  s_add_u32 s99, s99, 1
  s_add_u32 s67, s33, s3
  s_add_u32 s68, s34, s3
  s_add_u32 s69, s35, s3
  buffer_load_dwordx4 v[108:111], v14, s[20:23], s67 offen sc1
  buffer_load_dwordx4 v[112:115], v14, s[20:23], s68 offen sc1
  buffer_load_dwordx4 v[116:119], v14, s[20:23], s69 offen sc1
  s_add_u32 s3, s99, s65
  s_and_b32 s3, s3, 15
  s_and_b32 s38, s99, 16
  s_or_b32 s3, s3, s38
  s_lshl_b32 s3, s3, 10
  s_add_u32 s99, s99, 1
  s_add_u32 s67, s33, s3
  s_add_u32 s68, s34, s3
  s_add_u32 s69, s35, s3
  buffer_load_dwordx4 v[120:123], v14, s[20:23], s67 offen sc1
  buffer_load_dwordx4 v[124:127], v14, s[20:23], s68 offen sc1
  buffer_load_dwordx4 v[128:131], v14, s[20:23], s69 offen sc1
  s_waitcnt vmcnt(48)
  ds_read_b64_tr_b16 v[68:69], v16 offset:0
  ds_read_b64_tr_b16 v[70:71], v16 offset:2048
  ds_read_b64_tr_b16 v[72:73], v17 offset:0
  ds_read_b64_tr_b16 v[74:75], v17 offset:2048
  ds_read_b64_tr_b16 v[76:77], v18 offset:0
  ds_read_b64_tr_b16 v[78:79], v18 offset:2048
  ds_read_b64_tr_b16 v[80:81], v19 offset:0
  ds_read_b64_tr_b16 v[82:83], v19 offset:2048
  s_waitcnt lgkmcnt(0)
  s_waitcnt vmcnt(9)
  v_mfma_f32_16x16x32_bf16 v[20:23], v[68:71], v[84:87], 0
  ds_read_b64_tr_b16 v[140:141], v16 offset:4096
  ds_read_b64_tr_b16 v[142:143], v16 offset:6144
  v_mfma_f32_16x16x32_bf16 v[24:27], v[68:71], v[88:91], 0
  ds_read_b64_tr_b16 v[144:145], v17 offset:4096
  ds_read_b64_tr_b16 v[146:147], v17 offset:6144
  v_mfma_f32_16x16x32_bf16 v[28:31], v[68:71], v[92:95], 0
  ds_read_b64_tr_b16 v[148:149], v18 offset:4096
  ds_read_b64_tr_b16 v[150:151], v18 offset:6144
  v_mfma_f32_16x16x32_bf16 v[32:35], v[72:75], v[84:87], 0
  ds_read_b64_tr_b16 v[152:153], v19 offset:4096
  ds_read_b64_tr_b16 v[154:155], v19 offset:6144
  v_mfma_f32_16x16x32_bf16 v[36:39], v[72:75], v[88:91], 0
  s_add_u32 s66, s98, s65
  s_and_b32 s66, s66, 15
  s_and_b32 s37, s98, 16
  s_or_b32 s66, s66, s37
  s_lshl_b32 s66, s66, 10
  s_add_u32 s98, s98, 1
  s_add_u32 m0, s31, 0
  s_mul_i32 s66, s66, 36
  s_add_u32 s66, s66, s30
  v_mfma_f32_16x16x32_bf16 v[40:43], v[72:75], v[92:95], 0
  buffer_load_dwordx4 v10, s[8:11], s66 offen offset:0 lds
  v_mfma_f32_16x16x32_bf16 v[44:47], v[76:79], v[84:87], 0
  buffer_load_dwordx4 v11, s[8:11], s66 offen offset:1024 lds
  v_mfma_f32_16x16x32_bf16 v[48:51], v[76:79], v[88:91], 0
  v_mfma_f32_16x16x32_bf16 v[52:55], v[76:79], v[92:95], 0
  buffer_load_dwordx4 v12, s[8:11], s66 offen offset:2048 lds
  v_mfma_f32_16x16x32_bf16 v[56:59], v[80:83], v[84:87], 0
  buffer_load_dwordx4 v13, s[8:11], s66 offen offset:3072 lds
  v_mfma_f32_16x16x32_bf16 v[60:63], v[80:83], v[88:91], 0
  s_add_u32 s3, s99, s65
  s_and_b32 s3, s3, 15
  s_and_b32 s38, s99, 16
  s_or_b32 s3, s3, s38
  s_lshl_b32 s3, s3, 10
  s_add_u32 s99, s99, 1
  s_add_u32 s67, s33, s3
  s_add_u32 s68, s34, s3
  s_add_u32 s69, s35, s3
  v_mfma_f32_16x16x32_bf16 v[64:67], v[80:83], v[92:95], 0
  buffer_load_dwordx4 v[84:87], v14, s[20:23], s67 offen sc1
  buffer_load_dwordx4 v[88:91], v14, s[20:23], s68 offen sc1
  buffer_load_dwordx4 v[92:95], v14, s[20:23], s69 offen sc1
  s_waitcnt lgkmcnt(0)
  s_waitcnt vmcnt(13)
  v_mfma_f32_16x16x32_bf16 v[20:23], v[140:143], v[96:99], v[20:23]
  ds_read_b64_tr_b16 v[68:69], v16 offset:8192
  ds_read_b64_tr_b16 v[70:71], v16 offset:10240
  v_mfma_f32_16x16x32_bf16 v[24:27], v[140:143], v[100:103], v[24:27]
  ds_read_b64_tr_b16 v[72:73], v17 offset:8192
  ds_read_b64_tr_b16 v[74:75], v17 offset:10240
  v_mfma_f32_16x16x32_bf16 v[28:31], v[140:143], v[104:107], v[28:31]
  ds_read_b64_tr_b16 v[76:77], v18 offset:8192
  ds_read_b64_tr_b16 v[78:79], v18 offset:10240
  v_mfma_f32_16x16x32_bf16 v[32:35], v[144:147], v[96:99], v[32:35]
  ds_read_b64_tr_b16 v[80:81], v19 offset:8192
  ds_read_b64_tr_b16 v[82:83], v19 offset:10240
  v_mfma_f32_16x16x32_bf16 v[36:39], v[144:147], v[100:103], v[36:39]
  s_add_u32 s66, s98, s65
  s_and_b32 s66, s66, 15
  s_and_b32 s37, s98, 16
  s_or_b32 s66, s66, s37
  s_lshl_b32 s66, s66, 10
  s_add_u32 s98, s98, 1
  s_add_u32 m0, s31, 4096
  s_mul_i32 s66, s66, 36
  s_add_u32 s66, s66, s30
  v_mfma_f32_16x16x32_bf16 v[40:43], v[144:147], v[104:107], v[40:43]
  buffer_load_dwordx4 v10, s[8:11], s66 offen offset:0 lds
  v_mfma_f32_16x16x32_bf16 v[44:47], v[148:151], v[96:99], v[44:47]
  buffer_load_dwordx4 v11, s[8:11], s66 offen offset:1024 lds
  v_mfma_f32_16x16x32_bf16 v[48:51], v[148:151], v[100:103], v[48:51]
  v_mfma_f32_16x16x32_bf16 v[52:55], v[148:151], v[104:107], v[52:55]
  buffer_load_dwordx4 v12, s[8:11], s66 offen offset:2048 lds
  v_mfma_f32_16x16x32_bf16 v[56:59], v[152:155], v[96:99], v[56:59]
  buffer_load_dwordx4 v13, s[8:11], s66 offen offset:3072 lds
  v_mfma_f32_16x16x32_bf16 v[60:63], v[152:155], v[100:103], v[60:63]
  s_add_u32 s3, s99, s65
  s_and_b32 s3, s3, 15
  s_and_b32 s38, s99, 16
  s_or_b32 s3, s3, s38
  s_lshl_b32 s3, s3, 10
  s_add_u32 s99, s99, 1
  s_add_u32 s67, s33, s3
  s_add_u32 s68, s34, s3
  s_add_u32 s69, s35, s3
  v_mfma_f32_16x16x32_bf16 v[64:67], v[152:155], v[104:107], v[64:67]
  buffer_load_dwordx4 v[96:99], v14, s[20:23], s67 offen sc1
  buffer_load_dwordx4 v[100:103], v14, s[20:23], s68 offen sc1
  buffer_load_dwordx4 v[104:107], v14, s[20:23], s69 offen sc1
  s_waitcnt lgkmcnt(0)
  s_waitcnt vmcnt(17)
  v_mfma_f32_16x16x32_bf16 v[20:23], v[68:71], v[108:111], v[20:23]
  ds_read_b64_tr_b16 v[140:141], v16 offset:12288
  ds_read_b64_tr_b16 v[142:143], v16 offset:14336
  v_mfma_f32_16x16x32_bf16 v[24:27], v[68:71], v[112:115], v[24:27]
  ds_read_b64_tr_b16 v[144:145], v17 offset:12288
  ds_read_b64_tr_b16 v[146:147], v17 offset:14336
  v_mfma_f32_16x16x32_bf16 v[28:31], v[68:71], v[116:119], v[28:31]
  ds_read_b64_tr_b16 v[148:149], v18 offset:12288
  ds_read_b64_tr_b16 v[150:151], v18 offset:14336
  v_mfma_f32_16x16x32_bf16 v[32:35], v[72:75], v[108:111], v[32:35]
  ds_read_b64_tr_b16 v[152:153], v19 offset:12288
  ds_read_b64_tr_b16 v[154:155], v19 offset:14336
  v_mfma_f32_16x16x32_bf16 v[36:39], v[72:75], v[112:115], v[36:39]
  s_add_u32 s66, s98, s65
  s_and_b32 s66, s66, 15
  s_and_b32 s37, s98, 16
  s_or_b32 s66, s66, s37
  s_lshl_b32 s66, s66, 10
  s_add_u32 s98, s98, 1
  s_add_u32 m0, s31, 8192
  s_mul_i32 s66, s66, 36
  s_add_u32 s66, s66, s30
  v_mfma_f32_16x16x32_bf16 v[40:43], v[72:75], v[116:119], v[40:43]
  buffer_load_dwordx4 v10, s[8:11], s66 offen offset:0 lds
  v_mfma_f32_16x16x32_bf16 v[44:47], v[76:79], v[108:111], v[44:47]
  buffer_load_dwordx4 v11, s[8:11], s66 offen offset:1024 lds
  v_mfma_f32_16x16x32_bf16 v[48:51], v[76:79], v[112:115], v[48:51]
  v_mfma_f32_16x16x32_bf16 v[52:55], v[76:79], v[116:119], v[52:55]
  buffer_load_dwordx4 v12, s[8:11], s66 offen offset:2048 lds
  v_mfma_f32_16x16x32_bf16 v[56:59], v[80:83], v[108:111], v[56:59]
  buffer_load_dwordx4 v13, s[8:11], s66 offen offset:3072 lds
  v_mfma_f32_16x16x32_bf16 v[60:63], v[80:83], v[112:115], v[60:63]
  s_add_u32 s3, s99, s65
  s_and_b32 s3, s3, 15
  s_and_b32 s38, s99, 16
  s_or_b32 s3, s3, s38
  s_lshl_b32 s3, s3, 10
  s_add_u32 s99, s99, 1
  s_add_u32 s67, s33, s3
  s_add_u32 s68, s34, s3
  s_add_u32 s69, s35, s3
  v_mfma_f32_16x16x32_bf16 v[64:67], v[80:83], v[116:119], v[64:67]
  buffer_load_dwordx4 v[108:111], v14, s[20:23], s67 offen sc1
  buffer_load_dwordx4 v[112:115], v14, s[20:23], s68 offen sc1
  buffer_load_dwordx4 v[116:119], v14, s[20:23], s69 offen sc1
  s_waitcnt lgkmcnt(0)
  s_waitcnt vmcnt(21)
  v_mfma_f32_16x16x32_bf16 v[20:23], v[140:143], v[120:123], v[20:23]
  ds_read_b64_tr_b16 v[68:69], v16 offset:16384
  ds_read_b64_tr_b16 v[70:71], v16 offset:18432
  v_mfma_f32_16x16x32_bf16 v[24:27], v[140:143], v[124:127], v[24:27]
  ds_read_b64_tr_b16 v[72:73], v17 offset:16384
  ds_read_b64_tr_b16 v[74:75], v17 offset:18432
  v_mfma_f32_16x16x32_bf16 v[28:31], v[140:143], v[128:131], v[28:31]
  ds_read_b64_tr_b16 v[76:77], v18 offset:16384
  ds_read_b64_tr_b16 v[78:79], v18 offset:18432
  v_mfma_f32_16x16x32_bf16 v[32:35], v[144:147], v[120:123], v[32:35]
  ds_read_b64_tr_b16 v[80:81], v19 offset:16384
  ds_read_b64_tr_b16 v[82:83], v19 offset:18432
  v_mfma_f32_16x16x32_bf16 v[36:39], v[144:147], v[124:127], v[36:39]
  s_add_u32 s66, s98, s65
  s_and_b32 s66, s66, 15
  s_and_b32 s37, s98, 16
  s_or_b32 s66, s66, s37
  s_lshl_b32 s66, s66, 10
  s_add_u32 s98, s98, 1
  s_add_u32 m0, s31, 12288
  s_mul_i32 s66, s66, 36
  s_add_u32 s66, s66, s30
  v_mfma_f32_16x16x32_bf16 v[40:43], v[144:147], v[128:131], v[40:43]
  buffer_load_dwordx4 v10, s[8:11], s66 offen offset:0 lds
  v_mfma_f32_16x16x32_bf16 v[44:47], v[148:151], v[120:123], v[44:47]
  buffer_load_dwordx4 v11, s[8:11], s66 offen offset:1024 lds
  v_mfma_f32_16x16x32_bf16 v[48:51], v[148:151], v[124:127], v[48:51]
  v_mfma_f32_16x16x32_bf16 v[52:55], v[148:151], v[128:131], v[52:55]
  buffer_load_dwordx4 v12, s[8:11], s66 offen offset:2048 lds
  v_mfma_f32_16x16x32_bf16 v[56:59], v[152:155], v[120:123], v[56:59]
  buffer_load_dwordx4 v13, s[8:11], s66 offen offset:3072 lds
  v_mfma_f32_16x16x32_bf16 v[60:63], v[152:155], v[124:127], v[60:63]
  s_add_u32 s3, s99, s65
  s_and_b32 s3, s3, 15
  s_and_b32 s38, s99, 16
  s_or_b32 s3, s3, s38
  s_lshl_b32 s3, s3, 10
  s_add_u32 s99, s99, 1
  s_add_u32 s67, s33, s3
  s_add_u32 s68, s34, s3
  s_add_u32 s69, s35, s3
  v_mfma_f32_16x16x32_bf16 v[64:67], v[152:155], v[128:131], v[64:67]
  buffer_load_dwordx4 v[120:123], v14, s[20:23], s67 offen sc1
  buffer_load_dwordx4 v[124:127], v14, s[20:23], s68 offen sc1
  buffer_load_dwordx4 v[128:131], v14, s[20:23], s69 offen sc1
  s_waitcnt lgkmcnt(0)
  s_waitcnt vmcnt(21)
  v_mfma_f32_16x16x32_bf16 v[20:23], v[68:71], v[84:87], v[20:23]
  ds_read_b64_tr_b16 v[140:141], v16 offset:20480
  ds_read_b64_tr_b16 v[142:143], v16 offset:22528
  v_mfma_f32_16x16x32_bf16 v[24:27], v[68:71], v[88:91], v[24:27]
  ds_read_b64_tr_b16 v[144:145], v17 offset:20480
  ds_read_b64_tr_b16 v[146:147], v17 offset:22528
  v_mfma_f32_16x16x32_bf16 v[28:31], v[68:71], v[92:95], v[28:31]
  ds_read_b64_tr_b16 v[148:149], v18 offset:20480
  ds_read_b64_tr_b16 v[150:151], v18 offset:22528
  v_mfma_f32_16x16x32_bf16 v[32:35], v[72:75], v[84:87], v[32:35]
  ds_read_b64_tr_b16 v[152:153], v19 offset:20480
  ds_read_b64_tr_b16 v[154:155], v19 offset:22528
  v_mfma_f32_16x16x32_bf16 v[36:39], v[72:75], v[88:91], v[36:39]
  s_add_u32 s66, s98, s65
  s_and_b32 s66, s66, 15
  s_and_b32 s37, s98, 16
  s_or_b32 s66, s66, s37
  s_lshl_b32 s66, s66, 10
  s_add_u32 s98, s98, 1
  s_add_u32 m0, s31, 16384
  s_mul_i32 s66, s66, 36
  s_add_u32 s66, s66, s30
  v_mfma_f32_16x16x32_bf16 v[40:43], v[72:75], v[92:95], v[40:43]
  buffer_load_dwordx4 v10, s[8:11], s66 offen offset:0 lds
  v_mfma_f32_16x16x32_bf16 v[44:47], v[76:79], v[84:87], v[44:47]
  buffer_load_dwordx4 v11, s[8:11], s66 offen offset:1024 lds
  v_mfma_f32_16x16x32_bf16 v[48:51], v[76:79], v[88:91], v[48:51]
  v_mfma_f32_16x16x32_bf16 v[52:55], v[76:79], v[92:95], v[52:55]
  buffer_load_dwordx4 v12, s[8:11], s66 offen offset:2048 lds
  v_mfma_f32_16x16x32_bf16 v[56:59], v[80:83], v[84:87], v[56:59]
  buffer_load_dwordx4 v13, s[8:11], s66 offen offset:3072 lds
  v_mfma_f32_16x16x32_bf16 v[60:63], v[80:83], v[88:91], v[60:63]
  s_add_u32 s3, s99, s65
  s_and_b32 s3, s3, 15
  s_and_b32 s38, s99, 16
  s_or_b32 s3, s3, s38
  s_lshl_b32 s3, s3, 10
  s_add_u32 s99, s99, 1
  s_add_u32 s67, s33, s3
  s_add_u32 s68, s34, s3
  s_add_u32 s69, s35, s3
  v_mfma_f32_16x16x32_bf16 v[64:67], v[80:83], v[92:95], v[64:67]
  buffer_load_dwordx4 v[84:87], v14, s[20:23], s67 offen sc1
  buffer_load_dwordx4 v[88:91], v14, s[20:23], s68 offen sc1
  buffer_load_dwordx4 v[92:95], v14, s[20:23], s69 offen sc1
  s_waitcnt lgkmcnt(0)
  s_waitcnt vmcnt(21)
  v_mfma_f32_16x16x32_bf16 v[20:23], v[140:143], v[96:99], v[20:23]
  ds_read_b64_tr_b16 v[68:69], v16 offset:24576
  ds_read_b64_tr_b16 v[70:71], v16 offset:26624
  v_mfma_f32_16x16x32_bf16 v[24:27], v[140:143], v[100:103], v[24:27]
  ds_read_b64_tr_b16 v[72:73], v17 offset:24576
  ds_read_b64_tr_b16 v[74:75], v17 offset:26624
  v_mfma_f32_16x16x32_bf16 v[28:31], v[140:143], v[104:107], v[28:31]
  ds_read_b64_tr_b16 v[76:77], v18 offset:24576
  ds_read_b64_tr_b16 v[78:79], v18 offset:26624
  v_mfma_f32_16x16x32_bf16 v[32:35], v[144:147], v[96:99], v[32:35]
  ds_read_b64_tr_b16 v[80:81], v19 offset:24576
  ds_read_b64_tr_b16 v[82:83], v19 offset:26624
  v_mfma_f32_16x16x32_bf16 v[36:39], v[144:147], v[100:103], v[36:39]
  s_add_u32 s66, s98, s65
  s_and_b32 s66, s66, 15
  s_and_b32 s37, s98, 16
  s_or_b32 s66, s66, s37
  s_lshl_b32 s66, s66, 10
  s_add_u32 s98, s98, 1
  s_add_u32 m0, s31, 20480
  s_mul_i32 s66, s66, 36
  s_add_u32 s66, s66, s30
  v_mfma_f32_16x16x32_bf16 v[40:43], v[144:147], v[104:107], v[40:43]
  buffer_load_dwordx4 v10, s[8:11], s66 offen offset:0 lds
  v_mfma_f32_16x16x32_bf16 v[44:47], v[148:151], v[96:99], v[44:47]
  buffer_load_dwordx4 v11, s[8:11], s66 offen offset:1024 lds
  v_mfma_f32_16x16x32_bf16 v[48:51], v[148:151], v[100:103], v[48:51]
  v_mfma_f32_16x16x32_bf16 v[52:55], v[148:151], v[104:107], v[52:55]
  buffer_load_dwordx4 v12, s[8:11], s66 offen offset:2048 lds
  v_mfma_f32_16x16x32_bf16 v[56:59], v[152:155], v[96:99], v[56:59]
  buffer_load_dwordx4 v13, s[8:11], s66 offen offset:3072 lds
  v_mfma_f32_16x16x32_bf16 v[60:63], v[152:155], v[100:103], v[60:63]
  s_add_u32 s3, s99, s65
  s_and_b32 s3, s3, 15
  s_and_b32 s38, s99, 16
  s_or_b32 s3, s3, s38
  s_lshl_b32 s3, s3, 10
  s_add_u32 s99, s99, 1
  s_add_u32 s67, s33, s3
  s_add_u32 s68, s34, s3
  s_add_u32 s69, s35, s3
  v_mfma_f32_16x16x32_bf16 v[64:67], v[152:155], v[104:107], v[64:67]
  buffer_load_dwordx4 v[96:99], v14, s[20:23], s67 offen sc1
  buffer_load_dwordx4 v[100:103], v14, s[20:23], s68 offen sc1
  buffer_load_dwordx4 v[104:107], v14, s[20:23], s69 offen sc1
  s_waitcnt lgkmcnt(0)
  s_waitcnt vmcnt(21)
  v_mfma_f32_16x16x32_bf16 v[20:23], v[68:71], v[108:111], v[20:23]
  ds_read_b64_tr_b16 v[140:141], v16 offset:28672
  ds_read_b64_tr_b16 v[142:143], v16 offset:30720
  v_mfma_f32_16x16x32_bf16 v[24:27], v[68:71], v[112:115], v[24:27]
  ds_read_b64_tr_b16 v[144:145], v17 offset:28672
  ds_read_b64_tr_b16 v[146:147], v17 offset:30720
  v_mfma_f32_16x16x32_bf16 v[28:31], v[68:71], v[116:119], v[28:31]
  ds_read_b64_tr_b16 v[148:149], v18 offset:28672
  ds_read_b64_tr_b16 v[150:151], v18 offset:30720
  v_mfma_f32_16x16x32_bf16 v[32:35], v[72:75], v[108:111], v[32:35]
  ds_read_b64_tr_b16 v[152:153], v19 offset:28672
  ds_read_b64_tr_b16 v[154:155], v19 offset:30720
  v_mfma_f32_16x16x32_bf16 v[36:39], v[72:75], v[112:115], v[36:39]
  s_add_u32 s66, s98, s65
  s_and_b32 s66, s66, 15
  s_and_b32 s37, s98, 16
  s_or_b32 s66, s66, s37
  s_lshl_b32 s66, s66, 10
  s_add_u32 s98, s98, 1
  s_add_u32 m0, s31, 24576
  s_mul_i32 s66, s66, 36
  s_add_u32 s66, s66, s30
  v_mfma_f32_16x16x32_bf16 v[40:43], v[72:75], v[116:119], v[40:43]
  buffer_load_dwordx4 v10, s[8:11], s66 offen offset:0 lds
  v_mfma_f32_16x16x32_bf16 v[44:47], v[76:79], v[108:111], v[44:47]
  buffer_load_dwordx4 v11, s[8:11], s66 offen offset:1024 lds
  v_mfma_f32_16x16x32_bf16 v[48:51], v[76:79], v[112:115], v[48:51]
  v_mfma_f32_16x16x32_bf16 v[52:55], v[76:79], v[116:119], v[52:55]
  buffer_load_dwordx4 v12, s[8:11], s66 offen offset:2048 lds
  v_mfma_f32_16x16x32_bf16 v[56:59], v[80:83], v[108:111], v[56:59]
  buffer_load_dwordx4 v13, s[8:11], s66 offen offset:3072 lds
  v_mfma_f32_16x16x32_bf16 v[60:63], v[80:83], v[112:115], v[60:63]
  s_add_u32 s3, s99, s65
  s_and_b32 s3, s3, 15
  s_and_b32 s38, s99, 16
  s_or_b32 s3, s3, s38
  s_lshl_b32 s3, s3, 10
  s_add_u32 s99, s99, 1
  s_add_u32 s67, s33, s3
  s_add_u32 s68, s34, s3
  s_add_u32 s69, s35, s3
  v_mfma_f32_16x16x32_bf16 v[64:67], v[80:83], v[116:119], v[64:67]
  buffer_load_dwordx4 v[108:111], v14, s[20:23], s67 offen sc1
  buffer_load_dwordx4 v[112:115], v14, s[20:23], s68 offen sc1
  buffer_load_dwordx4 v[116:119], v14, s[20:23], s69 offen sc1
  s_waitcnt lgkmcnt(0)
  s_waitcnt vmcnt(21)
  v_mfma_f32_16x16x32_bf16 v[20:23], v[140:143], v[120:123], v[20:23]
  ds_read_b64_tr_b16 v[68:69], v16 offset:32768
  ds_read_b64_tr_b16 v[70:71], v16 offset:34816
  v_mfma_f32_16x16x32_bf16 v[24:27], v[140:143], v[124:127], v[24:27]
  ds_read_b64_tr_b16 v[72:73], v17 offset:32768
  ds_read_b64_tr_b16 v[74:75], v17 offset:34816
  v_mfma_f32_16x16x32_bf16 v[28:31], v[140:143], v[128:131], v[28:31]
  ds_read_b64_tr_b16 v[76:77], v18 offset:32768
  ds_read_b64_tr_b16 v[78:79], v18 offset:34816
  v_mfma_f32_16x16x32_bf16 v[32:35], v[144:147], v[120:123], v[32:35]
  ds_read_b64_tr_b16 v[80:81], v19 offset:32768
  ds_read_b64_tr_b16 v[82:83], v19 offset:34816
  v_mfma_f32_16x16x32_bf16 v[36:39], v[144:147], v[124:127], v[36:39]
  s_add_u32 s66, s98, s65
  s_and_b32 s66, s66, 15
  s_and_b32 s37, s98, 16
  s_or_b32 s66, s66, s37
  s_lshl_b32 s66, s66, 10
  s_add_u32 s98, s98, 1
  s_add_u32 m0, s31, 28672
  s_mul_i32 s66, s66, 36
  s_add_u32 s66, s66, s30
  v_mfma_f32_16x16x32_bf16 v[40:43], v[144:147], v[128:131], v[40:43]
  buffer_load_dwordx4 v10, s[8:11], s66 offen offset:0 lds
  v_mfma_f32_16x16x32_bf16 v[44:47], v[148:151], v[120:123], v[44:47]
  buffer_load_dwordx4 v11, s[8:11], s66 offen offset:1024 lds
  v_mfma_f32_16x16x32_bf16 v[48:51], v[148:151], v[124:127], v[48:51]
  v_mfma_f32_16x16x32_bf16 v[52:55], v[148:151], v[128:131], v[52:55]
  buffer_load_dwordx4 v12, s[8:11], s66 offen offset:2048 lds
  v_mfma_f32_16x16x32_bf16 v[56:59], v[152:155], v[120:123], v[56:59]
  buffer_load_dwordx4 v13, s[8:11], s66 offen offset:3072 lds
  v_mfma_f32_16x16x32_bf16 v[60:63], v[152:155], v[124:127], v[60:63]
  s_add_u32 s3, s99, s65
  s_and_b32 s3, s3, 15
  s_and_b32 s38, s99, 16
  s_or_b32 s3, s3, s38
  s_lshl_b32 s3, s3, 10
  s_add_u32 s99, s99, 1
  s_add_u32 s67, s33, s3
  s_add_u32 s68, s34, s3
  s_add_u32 s69, s35, s3
  v_mfma_f32_16x16x32_bf16 v[64:67], v[152:155], v[128:131], v[64:67]
  buffer_load_dwordx4 v[120:123], v14, s[20:23], s67 offen sc1
  buffer_load_dwordx4 v[124:127], v14, s[20:23], s68 offen sc1
  buffer_load_dwordx4 v[128:131], v14, s[20:23], s69 offen sc1
  s_waitcnt lgkmcnt(0)
  s_waitcnt vmcnt(21)
  v_mfma_f32_16x16x32_bf16 v[20:23], v[68:71], v[84:87], v[20:23]
  ds_read_b64_tr_b16 v[140:141], v16 offset:36864
  ds_read_b64_tr_b16 v[142:143], v16 offset:38912
  v_mfma_f32_16x16x32_bf16 v[24:27], v[68:71], v[88:91], v[24:27]
  ds_read_b64_tr_b16 v[144:145], v17 offset:36864
  ds_read_b64_tr_b16 v[146:147], v17 offset:38912
  v_mfma_f32_16x16x32_bf16 v[28:31], v[68:71], v[92:95], v[28:31]
  ds_read_b64_tr_b16 v[148:149], v18 offset:36864
  ds_read_b64_tr_b16 v[150:151], v18 offset:38912
  v_mfma_f32_16x16x32_bf16 v[32:35], v[72:75], v[84:87], v[32:35]
  ds_read_b64_tr_b16 v[152:153], v19 offset:36864
  ds_read_b64_tr_b16 v[154:155], v19 offset:38912
  v_mfma_f32_16x16x32_bf16 v[36:39], v[72:75], v[88:91], v[36:39]
  s_add_u32 s66, s98, s65
  s_and_b32 s66, s66, 15
  s_and_b32 s37, s98, 16
  s_or_b32 s66, s66, s37
  s_lshl_b32 s66, s66, 10
  s_add_u32 s98, s98, 1
  s_add_u32 m0, s31, 32768
  s_mul_i32 s66, s66, 36
  s_add_u32 s66, s66, s30
  v_mfma_f32_16x16x32_bf16 v[40:43], v[72:75], v[92:95], v[40:43]
  buffer_load_dwordx4 v10, s[8:11], s66 offen offset:0 lds
  v_mfma_f32_16x16x32_bf16 v[44:47], v[76:79], v[84:87], v[44:47]
  buffer_load_dwordx4 v11, s[8:11], s66 offen offset:1024 lds
  v_mfma_f32_16x16x32_bf16 v[48:51], v[76:79], v[88:91], v[48:51]
  v_mfma_f32_16x16x32_bf16 v[52:55], v[76:79], v[92:95], v[52:55]
  buffer_load_dwordx4 v12, s[8:11], s66 offen offset:2048 lds
  v_mfma_f32_16x16x32_bf16 v[56:59], v[80:83], v[84:87], v[56:59]
  buffer_load_dwordx4 v13, s[8:11], s66 offen offset:3072 lds
  v_mfma_f32_16x16x32_bf16 v[60:63], v[80:83], v[88:91], v[60:63]
  s_add_u32 s3, s99, s65
  s_and_b32 s3, s3, 15
  s_and_b32 s38, s99, 16
  s_or_b32 s3, s3, s38
  s_lshl_b32 s3, s3, 10
  s_add_u32 s99, s99, 1
  s_add_u32 s67, s33, s3
  s_add_u32 s68, s34, s3
  s_add_u32 s69, s35, s3
  v_mfma_f32_16x16x32_bf16 v[64:67], v[80:83], v[92:95], v[64:67]
  buffer_load_dwordx4 v[84:87], v14, s[20:23], s67 offen sc1
  buffer_load_dwordx4 v[88:91], v14, s[20:23], s68 offen sc1
  buffer_load_dwordx4 v[92:95], v14, s[20:23], s69 offen sc1
  s_waitcnt lgkmcnt(0)
  s_waitcnt vmcnt(21)
  v_mfma_f32_16x16x32_bf16 v[20:23], v[140:143], v[96:99], v[20:23]
  ds_read_b64_tr_b16 v[68:69], v16 offset:0
  ds_read_b64_tr_b16 v[70:71], v16 offset:2048
  v_mfma_f32_16x16x32_bf16 v[24:27], v[140:143], v[100:103], v[24:27]
  ds_read_b64_tr_b16 v[72:73], v17 offset:0
  ds_read_b64_tr_b16 v[74:75], v17 offset:2048
  v_mfma_f32_16x16x32_bf16 v[28:31], v[140:143], v[104:107], v[28:31]
  ds_read_b64_tr_b16 v[76:77], v18 offset:0
  ds_read_b64_tr_b16 v[78:79], v18 offset:2048
  v_mfma_f32_16x16x32_bf16 v[32:35], v[144:147], v[96:99], v[32:35]
  ds_read_b64_tr_b16 v[80:81], v19 offset:0
  ds_read_b64_tr_b16 v[82:83], v19 offset:2048
  v_mfma_f32_16x16x32_bf16 v[36:39], v[144:147], v[100:103], v[36:39]
  s_add_u32 s66, s98, s65
  s_and_b32 s66, s66, 15
  s_and_b32 s37, s98, 16
  s_or_b32 s66, s66, s37
  s_lshl_b32 s66, s66, 10
  s_add_u32 s98, s98, 1
  s_add_u32 m0, s31, 36864
  s_mul_i32 s66, s66, 36
  s_add_u32 s66, s66, s30
  v_mfma_f32_16x16x32_bf16 v[40:43], v[144:147], v[104:107], v[40:43]
  buffer_load_dwordx4 v10, s[8:11], s66 offen offset:0 lds
  v_mfma_f32_16x16x32_bf16 v[44:47], v[148:151], v[96:99], v[44:47]
  buffer_load_dwordx4 v11, s[8:11], s66 offen offset:1024 lds
  v_mfma_f32_16x16x32_bf16 v[48:51], v[148:151], v[100:103], v[48:51]
  v_mfma_f32_16x16x32_bf16 v[52:55], v[148:151], v[104:107], v[52:55]
  buffer_load_dwordx4 v12, s[8:11], s66 offen offset:2048 lds
  v_mfma_f32_16x16x32_bf16 v[56:59], v[152:155], v[96:99], v[56:59]
  buffer_load_dwordx4 v13, s[8:11], s66 offen offset:3072 lds
  v_mfma_f32_16x16x32_bf16 v[60:63], v[152:155], v[100:103], v[60:63]
  s_add_u32 s3, s99, s65
  s_and_b32 s3, s3, 15
  s_and_b32 s38, s99, 16
  s_or_b32 s3, s3, s38
  s_lshl_b32 s3, s3, 10
  s_add_u32 s99, s99, 1
  s_add_u32 s67, s33, s3
  s_add_u32 s68, s34, s3
  s_add_u32 s69, s35, s3
  v_mfma_f32_16x16x32_bf16 v[64:67], v[152:155], v[104:107], v[64:67]
  buffer_load_dwordx4 v[96:99], v14, s[20:23], s67 offen sc1
  buffer_load_dwordx4 v[100:103], v14, s[20:23], s68 offen sc1
  buffer_load_dwordx4 v[104:107], v14, s[20:23], s69 offen sc1
  s_waitcnt lgkmcnt(0)
  s_waitcnt vmcnt(21)
  v_mfma_f32_16x16x32_bf16 v[20:23], v[68:71], v[108:111], v[20:23]
  ds_read_b64_tr_b16 v[140:141], v16 offset:4096
  ds_read_b64_tr_b16 v[142:143], v16 offset:6144
  v_mfma_f32_16x16x32_bf16 v[24:27], v[68:71], v[112:115], v[24:27]
  ds_read_b64_tr_b16 v[144:145], v17 offset:4096
  ds_read_b64_tr_b16 v[146:147], v17 offset:6144
  v_mfma_f32_16x16x32_bf16 v[28:31], v[68:71], v[116:119], v[28:31]
  ds_read_b64_tr_b16 v[148:149], v18 offset:4096
  ds_read_b64_tr_b16 v[150:151], v18 offset:6144
  v_mfma_f32_16x16x32_bf16 v[32:35], v[72:75], v[108:111], v[32:35]
  ds_read_b64_tr_b16 v[152:153], v19 offset:4096
  ds_read_b64_tr_b16 v[154:155], v19 offset:6144
  v_mfma_f32_16x16x32_bf16 v[36:39], v[72:75], v[112:115], v[36:39]
  s_add_u32 s66, s98, s65
  s_and_b32 s66, s66, 15
  s_and_b32 s37, s98, 16
  s_or_b32 s66, s66, s37
  s_lshl_b32 s66, s66, 10
  s_add_u32 s98, s98, 1
  s_add_u32 m0, s31, 0
  s_mul_i32 s66, s66, 36
  s_add_u32 s66, s66, s30
  v_mfma_f32_16x16x32_bf16 v[40:43], v[72:75], v[116:119], v[40:43]
  buffer_load_dwordx4 v10, s[8:11], s66 offen offset:0 lds
  v_mfma_f32_16x16x32_bf16 v[44:47], v[76:79], v[108:111], v[44:47]
  buffer_load_dwordx4 v11, s[8:11], s66 offen offset:1024 lds
  v_mfma_f32_16x16x32_bf16 v[48:51], v[76:79], v[112:115], v[48:51]
  v_mfma_f32_16x16x32_bf16 v[52:55], v[76:79], v[116:119], v[52:55]
  buffer_load_dwordx4 v12, s[8:11], s66 offen offset:2048 lds
  v_mfma_f32_16x16x32_bf16 v[56:59], v[80:83], v[108:111], v[56:59]
  buffer_load_dwordx4 v13, s[8:11], s66 offen offset:3072 lds
  v_mfma_f32_16x16x32_bf16 v[60:63], v[80:83], v[112:115], v[60:63]
  s_add_u32 s3, s99, s65
  s_and_b32 s3, s3, 15
  s_and_b32 s38, s99, 16
  s_or_b32 s3, s3, s38
  s_lshl_b32 s3, s3, 10
  s_add_u32 s99, s99, 1
  s_add_u32 s67, s33, s3
  s_add_u32 s68, s34, s3
  s_add_u32 s69, s35, s3
  v_mfma_f32_16x16x32_bf16 v[64:67], v[80:83], v[116:119], v[64:67]
  buffer_load_dwordx4 v[108:111], v14, s[20:23], s67 offen sc1
  buffer_load_dwordx4 v[112:115], v14, s[20:23], s68 offen sc1
  buffer_load_dwordx4 v[116:119], v14, s[20:23], s69 offen sc1
  s_waitcnt lgkmcnt(0)
  s_waitcnt vmcnt(21)
  v_mfma_f32_16x16x32_bf16 v[20:23], v[140:143], v[120:123], v[20:23]
  ds_read_b64_tr_b16 v[68:69], v16 offset:8192
  ds_read_b64_tr_b16 v[70:71], v16 offset:10240
  v_mfma_f32_16x16x32_bf16 v[24:27], v[140:143], v[124:127], v[24:27]
  ds_read_b64_tr_b16 v[72:73], v17 offset:8192
  ds_read_b64_tr_b16 v[74:75], v17 offset:10240
  v_mfma_f32_16x16x32_bf16 v[28:31], v[140:143], v[128:131], v[28:31]
  ds_read_b64_tr_b16 v[76:77], v18 offset:8192
  ds_read_b64_tr_b16 v[78:79], v18 offset:10240
  v_mfma_f32_16x16x32_bf16 v[32:35], v[144:147], v[120:123], v[32:35]
  ds_read_b64_tr_b16 v[80:81], v19 offset:8192
  ds_read_b64_tr_b16 v[82:83], v19 offset:10240
  v_mfma_f32_16x16x32_bf16 v[36:39], v[144:147], v[124:127], v[36:39]
  s_add_u32 s66, s98, s65
  s_and_b32 s66, s66, 15
  s_and_b32 s37, s98, 16
  s_or_b32 s66, s66, s37
  s_lshl_b32 s66, s66, 10
  s_add_u32 s98, s98, 1
  s_add_u32 m0, s31, 4096
  s_mul_i32 s66, s66, 36
  s_add_u32 s66, s66, s30
  v_mfma_f32_16x16x32_bf16 v[40:43], v[144:147], v[128:131], v[40:43]
  buffer_load_dwordx4 v10, s[8:11], s66 offen offset:0 lds
  v_mfma_f32_16x16x32_bf16 v[44:47], v[148:151], v[120:123], v[44:47]
  buffer_load_dwordx4 v11, s[8:11], s66 offen offset:1024 lds
  v_mfma_f32_16x16x32_bf16 v[48:51], v[148:151], v[124:127], v[48:51]
  v_mfma_f32_16x16x32_bf16 v[52:55], v[148:151], v[128:131], v[52:55]
  buffer_load_dwordx4 v12, s[8:11], s66 offen offset:2048 lds
  v_mfma_f32_16x16x32_bf16 v[56:59], v[152:155], v[120:123], v[56:59]
  buffer_load_dwordx4 v13, s[8:11], s66 offen offset:3072 lds
  v_mfma_f32_16x16x32_bf16 v[60:63], v[152:155], v[124:127], v[60:63]
  s_add_u32 s3, s99, s65
  s_and_b32 s3, s3, 15
  s_and_b32 s38, s99, 16
  s_or_b32 s3, s3, s38
  s_lshl_b32 s3, s3, 10
  s_add_u32 s99, s99, 1
  s_add_u32 s67, s33, s3
  s_add_u32 s68, s34, s3
  s_add_u32 s69, s35, s3
  v_mfma_f32_16x16x32_bf16 v[64:67], v[152:155], v[128:131], v[64:67]
  buffer_load_dwordx4 v[120:123], v14, s[20:23], s67 offen sc1
  buffer_load_dwordx4 v[124:127], v14, s[20:23], s68 offen sc1
  buffer_load_dwordx4 v[128:131], v14, s[20:23], s69 offen sc1
  s_waitcnt lgkmcnt(0)
  s_waitcnt vmcnt(21)
  v_mfma_f32_16x16x32_bf16 v[20:23], v[68:71], v[84:87], v[20:23]
  ds_read_b64_tr_b16 v[140:141], v16 offset:12288
  ds_read_b64_tr_b16 v[142:143], v16 offset:14336
  v_mfma_f32_16x16x32_bf16 v[24:27], v[68:71], v[88:91], v[24:27]
  ds_read_b64_tr_b16 v[144:145], v17 offset:12288
  ds_read_b64_tr_b16 v[146:147], v17 offset:14336
  v_mfma_f32_16x16x32_bf16 v[28:31], v[68:71], v[92:95], v[28:31]
  ds_read_b64_tr_b16 v[148:149], v18 offset:12288
  ds_read_b64_tr_b16 v[150:151], v18 offset:14336
  v_mfma_f32_16x16x32_bf16 v[32:35], v[72:75], v[84:87], v[32:35]
  ds_read_b64_tr_b16 v[152:153], v19 offset:12288
  ds_read_b64_tr_b16 v[154:155], v19 offset:14336
  v_mfma_f32_16x16x32_bf16 v[36:39], v[72:75], v[88:91], v[36:39]
  s_add_u32 s66, s98, s65
  s_and_b32 s66, s66, 15
  s_and_b32 s37, s98, 16
  s_or_b32 s66, s66, s37
  s_lshl_b32 s66, s66, 10
  s_add_u32 s98, s98, 1
  s_add_u32 m0, s31, 8192
  s_mul_i32 s66, s66, 36
  s_add_u32 s66, s66, s30
  v_mfma_f32_16x16x32_bf16 v[40:43], v[72:75], v[92:95], v[40:43]
  buffer_load_dwordx4 v10, s[8:11], s66 offen offset:0 lds
  v_mfma_f32_16x16x32_bf16 v[44:47], v[76:79], v[84:87], v[44:47]
  buffer_load_dwordx4 v11, s[8:11], s66 offen offset:1024 lds
  v_mfma_f32_16x16x32_bf16 v[48:51], v[76:79], v[88:91], v[48:51]
  v_mfma_f32_16x16x32_bf16 v[52:55], v[76:79], v[92:95], v[52:55]
  buffer_load_dwordx4 v12, s[8:11], s66 offen offset:2048 lds
  v_mfma_f32_16x16x32_bf16 v[56:59], v[80:83], v[84:87], v[56:59]
  buffer_load_dwordx4 v13, s[8:11], s66 offen offset:3072 lds
  v_mfma_f32_16x16x32_bf16 v[60:63], v[80:83], v[88:91], v[60:63]
  s_add_u32 s3, s99, s65
  s_and_b32 s3, s3, 15
  s_and_b32 s38, s99, 16
  s_or_b32 s3, s3, s38
  s_lshl_b32 s3, s3, 10
  s_add_u32 s99, s99, 1
  s_add_u32 s67, s33, s3
  s_add_u32 s68, s34, s3
  s_add_u32 s69, s35, s3
  v_mfma_f32_16x16x32_bf16 v[64:67], v[80:83], v[92:95], v[64:67]
  buffer_load_dwordx4 v[84:87], v14, s[20:23], s67 offen sc1
  buffer_load_dwordx4 v[88:91], v14, s[20:23], s68 offen sc1
  buffer_load_dwordx4 v[92:95], v14, s[20:23], s69 offen sc1
  s_waitcnt lgkmcnt(0)
  s_waitcnt vmcnt(21)
  v_mfma_f32_16x16x32_bf16 v[20:23], v[140:143], v[96:99], v[20:23]
  ds_read_b64_tr_b16 v[68:69], v16 offset:16384
  ds_read_b64_tr_b16 v[70:71], v16 offset:18432
  v_mfma_f32_16x16x32_bf16 v[24:27], v[140:143], v[100:103], v[24:27]
  ds_read_b64_tr_b16 v[72:73], v17 offset:16384
  ds_read_b64_tr_b16 v[74:75], v17 offset:18432
  v_mfma_f32_16x16x32_bf16 v[28:31], v[140:143], v[104:107], v[28:31]
  ds_read_b64_tr_b16 v[76:77], v18 offset:16384
  ds_read_b64_tr_b16 v[78:79], v18 offset:18432
  v_mfma_f32_16x16x32_bf16 v[32:35], v[144:147], v[96:99], v[32:35]
  ds_read_b64_tr_b16 v[80:81], v19 offset:16384
  ds_read_b64_tr_b16 v[82:83], v19 offset:18432
  v_mfma_f32_16x16x32_bf16 v[36:39], v[144:147], v[100:103], v[36:39]
  s_add_u32 s66, s98, s65
  s_and_b32 s66, s66, 15
  s_and_b32 s37, s98, 16
  s_or_b32 s66, s66, s37
  s_lshl_b32 s66, s66, 10
  s_add_u32 s98, s98, 1
  s_add_u32 m0, s31, 12288
  s_mul_i32 s66, s66, 36
  s_add_u32 s66, s66, s30
  v_mfma_f32_16x16x32_bf16 v[40:43], v[144:147], v[104:107], v[40:43]
  buffer_load_dwordx4 v10, s[8:11], s66 offen offset:0 lds
  v_mfma_f32_16x16x32_bf16 v[44:47], v[148:151], v[96:99], v[44:47]
  buffer_load_dwordx4 v11, s[8:11], s66 offen offset:1024 lds
  v_mfma_f32_16x16x32_bf16 v[48:51], v[148:151], v[100:103], v[48:51]
  v_mfma_f32_16x16x32_bf16 v[52:55], v[148:151], v[104:107], v[52:55]
  buffer_load_dwordx4 v12, s[8:11], s66 offen offset:2048 lds
  v_mfma_f32_16x16x32_bf16 v[56:59], v[152:155], v[96:99], v[56:59]
  buffer_load_dwordx4 v13, s[8:11], s66 offen offset:3072 lds
  v_mfma_f32_16x16x32_bf16 v[60:63], v[152:155], v[100:103], v[60:63]
  s_add_u32 s3, s99, s65
  s_and_b32 s3, s3, 15
  s_and_b32 s38, s99, 16
  s_or_b32 s3, s3, s38
  s_lshl_b32 s3, s3, 10
  s_add_u32 s99, s99, 1
  s_add_u32 s67, s33, s3
  s_add_u32 s68, s34, s3
  s_add_u32 s69, s35, s3
  v_mfma_f32_16x16x32_bf16 v[64:67], v[152:155], v[104:107], v[64:67]
  buffer_load_dwordx4 v[96:99], v14, s[20:23], s67 offen sc1
  buffer_load_dwordx4 v[100:103], v14, s[20:23], s68 offen sc1
  buffer_load_dwordx4 v[104:107], v14, s[20:23], s69 offen sc1
  s_waitcnt lgkmcnt(0)
  s_waitcnt vmcnt(21)
  v_mfma_f32_16x16x32_bf16 v[20:23], v[68:71], v[108:111], v[20:23]
  ds_read_b64_tr_b16 v[140:141], v16 offset:20480
  ds_read_b64_tr_b16 v[142:143], v16 offset:22528
  v_mfma_f32_16x16x32_bf16 v[24:27], v[68:71], v[112:115], v[24:27]
  ds_read_b64_tr_b16 v[144:145], v17 offset:20480
  ds_read_b64_tr_b16 v[146:147], v17 offset:22528
  v_mfma_f32_16x16x32_bf16 v[28:31], v[68:71], v[116:119], v[28:31]
  ds_read_b64_tr_b16 v[148:149], v18 offset:20480
  ds_read_b64_tr_b16 v[150:151], v18 offset:22528
  v_mfma_f32_16x16x32_bf16 v[32:35], v[72:75], v[108:111], v[32:35]
  ds_read_b64_tr_b16 v[152:153], v19 offset:20480
  ds_read_b64_tr_b16 v[154:155], v19 offset:22528
  v_mfma_f32_16x16x32_bf16 v[36:39], v[72:75], v[112:115], v[36:39]
  s_add_u32 s66, s98, s65
  s_and_b32 s66, s66, 15
  s_and_b32 s37, s98, 16
  s_or_b32 s66, s66, s37
  s_lshl_b32 s66, s66, 10
  s_add_u32 s98, s98, 1
  s_add_u32 m0, s31, 16384
  s_mul_i32 s66, s66, 36
  s_add_u32 s66, s66, s30
  v_mfma_f32_16x16x32_bf16 v[40:43], v[72:75], v[116:119], v[40:43]
  buffer_load_dwordx4 v10, s[8:11], s66 offen offset:0 lds
  v_mfma_f32_16x16x32_bf16 v[44:47], v[76:79], v[108:111], v[44:47]
  buffer_load_dwordx4 v11, s[8:11], s66 offen offset:1024 lds
  v_mfma_f32_16x16x32_bf16 v[48:51], v[76:79], v[112:115], v[48:51]
  v_mfma_f32_16x16x32_bf16 v[52:55], v[76:79], v[116:119], v[52:55]
  buffer_load_dwordx4 v12, s[8:11], s66 offen offset:2048 lds
  v_mfma_f32_16x16x32_bf16 v[56:59], v[80:83], v[108:111], v[56:59]
  buffer_load_dwordx4 v13, s[8:11], s66 offen offset:3072 lds
  v_mfma_f32_16x16x32_bf16 v[60:63], v[80:83], v[112:115], v[60:63]
  s_add_u32 s3, s99, s65
  s_and_b32 s3, s3, 15
  s_and_b32 s38, s99, 16
  s_or_b32 s3, s3, s38
  s_lshl_b32 s3, s3, 10
  s_add_u32 s99, s99, 1
  s_add_u32 s67, s33, s3
  s_add_u32 s68, s34, s3
  s_add_u32 s69, s35, s3
  v_mfma_f32_16x16x32_bf16 v[64:67], v[80:83], v[116:119], v[64:67]
  buffer_load_dwordx4 v[108:111], v14, s[20:23], s67 offen sc1
  buffer_load_dwordx4 v[112:115], v14, s[20:23], s68 offen sc1
  buffer_load_dwordx4 v[116:119], v14, s[20:23], s69 offen sc1
  s_waitcnt lgkmcnt(0)
  s_waitcnt vmcnt(21)
  v_mfma_f32_16x16x32_bf16 v[20:23], v[140:143], v[120:123], v[20:23]
  ds_read_b64_tr_b16 v[68:69], v16 offset:24576
  ds_read_b64_tr_b16 v[70:71], v16 offset:26624
  v_mfma_f32_16x16x32_bf16 v[24:27], v[140:143], v[124:127], v[24:27]
  ds_read_b64_tr_b16 v[72:73], v17 offset:24576
  ds_read_b64_tr_b16 v[74:75], v17 offset:26624
  v_mfma_f32_16x16x32_bf16 v[28:31], v[140:143], v[128:131], v[28:31]
  ds_read_b64_tr_b16 v[76:77], v18 offset:24576
  ds_read_b64_tr_b16 v[78:79], v18 offset:26624
  v_mfma_f32_16x16x32_bf16 v[32:35], v[144:147], v[120:123], v[32:35]
  ds_read_b64_tr_b16 v[80:81], v19 offset:24576
  ds_read_b64_tr_b16 v[82:83], v19 offset:26624
  v_mfma_f32_16x16x32_bf16 v[36:39], v[144:147], v[124:127], v[36:39]
  s_add_u32 s66, s98, s65
  s_and_b32 s66, s66, 15
  s_and_b32 s37, s98, 16
  s_or_b32 s66, s66, s37
  s_lshl_b32 s66, s66, 10
  s_add_u32 s98, s98, 1
  s_add_u32 m0, s31, 20480
  s_mul_i32 s66, s66, 36
  s_add_u32 s66, s66, s30
  v_mfma_f32_16x16x32_bf16 v[40:43], v[144:147], v[128:131], v[40:43]
  buffer_load_dwordx4 v10, s[8:11], s66 offen offset:0 lds
  v_mfma_f32_16x16x32_bf16 v[44:47], v[148:151], v[120:123], v[44:47]
  buffer_load_dwordx4 v11, s[8:11], s66 offen offset:1024 lds
  v_mfma_f32_16x16x32_bf16 v[48:51], v[148:151], v[124:127], v[48:51]
  v_mfma_f32_16x16x32_bf16 v[52:55], v[148:151], v[128:131], v[52:55]
  buffer_load_dwordx4 v12, s[8:11], s66 offen offset:2048 lds
  v_mfma_f32_16x16x32_bf16 v[56:59], v[152:155], v[120:123], v[56:59]
  buffer_load_dwordx4 v13, s[8:11], s66 offen offset:3072 lds
  v_mfma_f32_16x16x32_bf16 v[60:63], v[152:155], v[124:127], v[60:63]
  s_add_u32 s3, s99, s65
  s_and_b32 s3, s3, 15
  s_and_b32 s38, s99, 16
  s_or_b32 s3, s3, s38
  s_lshl_b32 s3, s3, 10
  s_add_u32 s99, s99, 1
  s_add_u32 s67, s33, s3
  s_add_u32 s68, s34, s3
  s_add_u32 s69, s35, s3
  v_mfma_f32_16x16x32_bf16 v[64:67], v[152:155], v[128:131], v[64:67]
  buffer_load_dwordx4 v[120:123], v14, s[20:23], s67 offen sc1
  buffer_load_dwordx4 v[124:127], v14, s[20:23], s68 offen sc1
  buffer_load_dwordx4 v[128:131], v14, s[20:23], s69 offen sc1
  s_waitcnt lgkmcnt(0)
  s_waitcnt vmcnt(21)
  v_mfma_f32_16x16x32_bf16 v[20:23], v[68:71], v[84:87], v[20:23]
  ds_read_b64_tr_b16 v[140:141], v16 offset:28672
  ds_read_b64_tr_b16 v[142:143], v16 offset:30720
  v_mfma_f32_16x16x32_bf16 v[24:27], v[68:71], v[88:91], v[24:27]
  ds_read_b64_tr_b16 v[144:145], v17 offset:28672
  ds_read_b64_tr_b16 v[146:147], v17 offset:30720
  v_mfma_f32_16x16x32_bf16 v[28:31], v[68:71], v[92:95], v[28:31]
  ds_read_b64_tr_b16 v[148:149], v18 offset:28672
  ds_read_b64_tr_b16 v[150:151], v18 offset:30720
  v_mfma_f32_16x16x32_bf16 v[32:35], v[72:75], v[84:87], v[32:35]
  ds_read_b64_tr_b16 v[152:153], v19 offset:28672
  ds_read_b64_tr_b16 v[154:155], v19 offset:30720
  v_mfma_f32_16x16x32_bf16 v[36:39], v[72:75], v[88:91], v[36:39]
  s_add_u32 s66, s98, s65
  s_and_b32 s66, s66, 15
  s_and_b32 s37, s98, 16
  s_or_b32 s66, s66, s37
  s_lshl_b32 s66, s66, 10
  s_add_u32 s98, s98, 1
  s_add_u32 m0, s31, 24576
  s_mul_i32 s66, s66, 36
  s_add_u32 s66, s66, s30
  v_mfma_f32_16x16x32_bf16 v[40:43], v[72:75], v[92:95], v[40:43]
  buffer_load_dwordx4 v10, s[8:11], s66 offen offset:0 lds
  v_mfma_f32_16x16x32_bf16 v[44:47], v[76:79], v[84:87], v[44:47]
  buffer_load_dwordx4 v11, s[8:11], s66 offen offset:1024 lds
  v_mfma_f32_16x16x32_bf16 v[48:51], v[76:79], v[88:91], v[48:51]
  v_mfma_f32_16x16x32_bf16 v[52:55], v[76:79], v[92:95], v[52:55]
  buffer_load_dwordx4 v12, s[8:11], s66 offen offset:2048 lds
  v_mfma_f32_16x16x32_bf16 v[56:59], v[80:83], v[84:87], v[56:59]
  buffer_load_dwordx4 v13, s[8:11], s66 offen offset:3072 lds
  v_mfma_f32_16x16x32_bf16 v[60:63], v[80:83], v[88:91], v[60:63]
  s_add_u32 s3, s99, s65
  s_and_b32 s3, s3, 15
  s_and_b32 s38, s99, 16
  s_or_b32 s3, s3, s38
  s_lshl_b32 s3, s3, 10
  s_add_u32 s99, s99, 1
  s_add_u32 s67, s33, s3
  s_add_u32 s68, s34, s3
  s_add_u32 s69, s35, s3
  v_mfma_f32_16x16x32_bf16 v[64:67], v[80:83], v[92:95], v[64:67]
  buffer_load_dwordx4 v[84:87], v14, s[20:23], s67 offen sc1
  buffer_load_dwordx4 v[88:91], v14, s[20:23], s68 offen sc1
  buffer_load_dwordx4 v[92:95], v14, s[20:23], s69 offen sc1
  s_waitcnt lgkmcnt(0)
  s_waitcnt vmcnt(21)
  v_mfma_f32_16x16x32_bf16 v[20:23], v[140:143], v[96:99], v[20:23]
  ds_read_b64_tr_b16 v[68:69], v16 offset:32768
  ds_read_b64_tr_b16 v[70:71], v16 offset:34816
  v_mfma_f32_16x16x32_bf16 v[24:27], v[140:143], v[100:103], v[24:27]
  ds_read_b64_tr_b16 v[72:73], v17 offset:32768
  ds_read_b64_tr_b16 v[74:75], v17 offset:34816
  v_mfma_f32_16x16x32_bf16 v[28:31], v[140:143], v[104:107], v[28:31]
  ds_read_b64_tr_b16 v[76:77], v18 offset:32768
  ds_read_b64_tr_b16 v[78:79], v18 offset:34816
  v_mfma_f32_16x16x32_bf16 v[32:35], v[144:147], v[96:99], v[32:35]
  ds_read_b64_tr_b16 v[80:81], v19 offset:32768
  ds_read_b64_tr_b16 v[82:83], v19 offset:34816
  v_mfma_f32_16x16x32_bf16 v[36:39], v[144:147], v[100:103], v[36:39]
  s_add_u32 s66, s98, s65
  s_and_b32 s66, s66, 15
  s_and_b32 s37, s98, 16
  s_or_b32 s66, s66, s37
  s_lshl_b32 s66, s66, 10
  s_add_u32 s98, s98, 1
  s_add_u32 m0, s31, 28672
  s_mul_i32 s66, s66, 36
  s_add_u32 s66, s66, s30
  v_mfma_f32_16x16x32_bf16 v[40:43], v[144:147], v[104:107], v[40:43]
  buffer_load_dwordx4 v10, s[8:11], s66 offen offset:0 lds
  v_mfma_f32_16x16x32_bf16 v[44:47], v[148:151], v[96:99], v[44:47]
  buffer_load_dwordx4 v11, s[8:11], s66 offen offset:1024 lds
  v_mfma_f32_16x16x32_bf16 v[48:51], v[148:151], v[100:103], v[48:51]
  v_mfma_f32_16x16x32_bf16 v[52:55], v[148:151], v[104:107], v[52:55]
  buffer_load_dwordx4 v12, s[8:11], s66 offen offset:2048 lds
  v_mfma_f32_16x16x32_bf16 v[56:59], v[152:155], v[96:99], v[56:59]
  buffer_load_dwordx4 v13, s[8:11], s66 offen offset:3072 lds
  v_mfma_f32_16x16x32_bf16 v[60:63], v[152:155], v[100:103], v[60:63]
  s_add_u32 s3, s99, s65
  s_and_b32 s3, s3, 15
  s_and_b32 s38, s99, 16
  s_or_b32 s3, s3, s38
  s_lshl_b32 s3, s3, 10
  s_add_u32 s99, s99, 1
  s_add_u32 s67, s33, s3
  s_add_u32 s68, s34, s3
  s_add_u32 s69, s35, s3
  v_mfma_f32_16x16x32_bf16 v[64:67], v[152:155], v[104:107], v[64:67]
  buffer_load_dwordx4 v[96:99], v14, s[20:23], s67 offen sc1
  buffer_load_dwordx4 v[100:103], v14, s[20:23], s68 offen sc1
  buffer_load_dwordx4 v[104:107], v14, s[20:23], s69 offen sc1
  s_waitcnt lgkmcnt(0)
  s_waitcnt vmcnt(21)
  v_mfma_f32_16x16x32_bf16 v[20:23], v[68:71], v[108:111], v[20:23]
  ds_read_b64_tr_b16 v[140:141], v16 offset:36864
  ds_read_b64_tr_b16 v[142:143], v16 offset:38912
  v_mfma_f32_16x16x32_bf16 v[24:27], v[68:71], v[112:115], v[24:27]
  ds_read_b64_tr_b16 v[144:145], v17 offset:36864
  ds_read_b64_tr_b16 v[146:147], v17 offset:38912
  v_mfma_f32_16x16x32_bf16 v[28:31], v[68:71], v[116:119], v[28:31]
  ds_read_b64_tr_b16 v[148:149], v18 offset:36864
  ds_read_b64_tr_b16 v[150:151], v18 offset:38912
  v_mfma_f32_16x16x32_bf16 v[32:35], v[72:75], v[108:111], v[32:35]
  ds_read_b64_tr_b16 v[152:153], v19 offset:36864
  ds_read_b64_tr_b16 v[154:155], v19 offset:38912
  v_mfma_f32_16x16x32_bf16 v[36:39], v[72:75], v[112:115], v[36:39]
  s_add_u32 s66, s98, s65
  s_and_b32 s66, s66, 15
  s_and_b32 s37, s98, 16
  s_or_b32 s66, s66, s37
  s_lshl_b32 s66, s66, 10
  s_add_u32 s98, s98, 1
  s_add_u32 m0, s31, 32768
  s_mul_i32 s66, s66, 36
  s_add_u32 s66, s66, s30
  v_mfma_f32_16x16x32_bf16 v[40:43], v[72:75], v[116:119], v[40:43]
  buffer_load_dwordx4 v10, s[8:11], s66 offen offset:0 lds
  v_mfma_f32_16x16x32_bf16 v[44:47], v[76:79], v[108:111], v[44:47]
  buffer_load_dwordx4 v11, s[8:11], s66 offen offset:1024 lds
  v_mfma_f32_16x16x32_bf16 v[48:51], v[76:79], v[112:115], v[48:51]
  v_mfma_f32_16x16x32_bf16 v[52:55], v[76:79], v[116:119], v[52:55]
  buffer_load_dwordx4 v12, s[8:11], s66 offen offset:2048 lds
  v_mfma_f32_16x16x32_bf16 v[56:59], v[80:83], v[108:111], v[56:59]
  buffer_load_dwordx4 v13, s[8:11], s66 offen offset:3072 lds
  v_mfma_f32_16x16x32_bf16 v[60:63], v[80:83], v[112:115], v[60:63]
  s_add_u32 s3, s99, s65
  s_and_b32 s3, s3, 15
  s_and_b32 s38, s99, 16
  s_or_b32 s3, s3, s38
  s_lshl_b32 s3, s3, 10
  s_add_u32 s99, s99, 1
  s_add_u32 s67, s33, s3
  s_add_u32 s68, s34, s3
  s_add_u32 s69, s35, s3
  v_mfma_f32_16x16x32_bf16 v[64:67], v[80:83], v[116:119], v[64:67]
  buffer_load_dwordx4 v[108:111], v14, s[20:23], s67 offen sc1
  buffer_load_dwordx4 v[112:115], v14, s[20:23], s68 offen sc1
  buffer_load_dwordx4 v[116:119], v14, s[20:23], s69 offen sc1
  s_waitcnt lgkmcnt(0)
  s_waitcnt vmcnt(21)
  v_mfma_f32_16x16x32_bf16 v[20:23], v[140:143], v[120:123], v[20:23]
  ds_read_b64_tr_b16 v[68:69], v16 offset:0
  ds_read_b64_tr_b16 v[70:71], v16 offset:2048
  v_mfma_f32_16x16x32_bf16 v[24:27], v[140:143], v[124:127], v[24:27]
  ds_read_b64_tr_b16 v[72:73], v17 offset:0
  ds_read_b64_tr_b16 v[74:75], v17 offset:2048
  v_mfma_f32_16x16x32_bf16 v[28:31], v[140:143], v[128:131], v[28:31]
  ds_read_b64_tr_b16 v[76:77], v18 offset:0
  ds_read_b64_tr_b16 v[78:79], v18 offset:2048
  v_mfma_f32_16x16x32_bf16 v[32:35], v[144:147], v[120:123], v[32:35]
  ds_read_b64_tr_b16 v[80:81], v19 offset:0
  ds_read_b64_tr_b16 v[82:83], v19 offset:2048
  v_mfma_f32_16x16x32_bf16 v[36:39], v[144:147], v[124:127], v[36:39]
  s_add_u32 s66, s98, s65
  s_and_b32 s66, s66, 15
  s_and_b32 s37, s98, 16
  s_or_b32 s66, s66, s37
  s_lshl_b32 s66, s66, 10
  s_add_u32 s98, s98, 1
  s_add_u32 m0, s31, 36864
  s_mul_i32 s66, s66, 36
  s_add_u32 s66, s66, s30
  v_mfma_f32_16x16x32_bf16 v[40:43], v[144:147], v[128:131], v[40:43]
  buffer_load_dwordx4 v10, s[8:11], s66 offen offset:0 lds
  v_mfma_f32_16x16x32_bf16 v[44:47], v[148:151], v[120:123], v[44:47]
  buffer_load_dwordx4 v11, s[8:11], s66 offen offset:1024 lds
  v_mfma_f32_16x16x32_bf16 v[48:51], v[148:151], v[124:127], v[48:51]
  v_mfma_f32_16x16x32_bf16 v[52:55], v[148:151], v[128:131], v[52:55]
  buffer_load_dwordx4 v12, s[8:11], s66 offen offset:2048 lds
  v_mfma_f32_16x16x32_bf16 v[56:59], v[152:155], v[120:123], v[56:59]
  buffer_load_dwordx4 v13, s[8:11], s66 offen offset:3072 lds
  v_mfma_f32_16x16x32_bf16 v[60:63], v[152:155], v[124:127], v[60:63]
  s_add_u32 s3, s99, s65
  s_and_b32 s3, s3, 15
  s_and_b32 s38, s99, 16
  s_or_b32 s3, s3, s38
  s_lshl_b32 s3, s3, 10
  s_add_u32 s99, s99, 1
  s_add_u32 s67, s33, s3
  s_add_u32 s68, s34, s3
  s_add_u32 s69, s35, s3
  v_mfma_f32_16x16x32_bf16 v[64:67], v[152:155], v[128:131], v[64:67]
  buffer_load_dwordx4 v[120:123], v14, s[20:23], s67 offen sc1
  buffer_load_dwordx4 v[124:127], v14, s[20:23], s68 offen sc1
  buffer_load_dwordx4 v[128:131], v14, s[20:23], s69 offen sc1
  s_waitcnt lgkmcnt(0)
  s_waitcnt vmcnt(21)
  v_mfma_f32_16x16x32_bf16 v[20:23], v[68:71], v[84:87], v[20:23]
  ds_read_b64_tr_b16 v[140:141], v16 offset:4096
  ds_read_b64_tr_b16 v[142:143], v16 offset:6144
  v_mfma_f32_16x16x32_bf16 v[24:27], v[68:71], v[88:91], v[24:27]
  ds_read_b64_tr_b16 v[144:145], v17 offset:4096
  ds_read_b64_tr_b16 v[146:147], v17 offset:6144
  v_mfma_f32_16x16x32_bf16 v[28:31], v[68:71], v[92:95], v[28:31]
  ds_read_b64_tr_b16 v[148:149], v18 offset:4096
  ds_read_b64_tr_b16 v[150:151], v18 offset:6144
  v_mfma_f32_16x16x32_bf16 v[32:35], v[72:75], v[84:87], v[32:35]
  ds_read_b64_tr_b16 v[152:153], v19 offset:4096
  ds_read_b64_tr_b16 v[154:155], v19 offset:6144
  v_mfma_f32_16x16x32_bf16 v[36:39], v[72:75], v[88:91], v[36:39]
  s_add_u32 s66, s98, s65
  s_and_b32 s66, s66, 15
  s_and_b32 s37, s98, 16
  s_or_b32 s66, s66, s37
  s_lshl_b32 s66, s66, 10
  s_add_u32 s98, s98, 1
  s_add_u32 m0, s31, 0
  s_mul_i32 s66, s66, 36
  s_add_u32 s66, s66, s30
  v_mfma_f32_16x16x32_bf16 v[40:43], v[72:75], v[92:95], v[40:43]
  buffer_load_dwordx4 v10, s[8:11], s66 offen offset:0 lds
  v_mfma_f32_16x16x32_bf16 v[44:47], v[76:79], v[84:87], v[44:47]
  buffer_load_dwordx4 v11, s[8:11], s66 offen offset:1024 lds
  v_mfma_f32_16x16x32_bf16 v[48:51], v[76:79], v[88:91], v[48:51]
  v_mfma_f32_16x16x32_bf16 v[52:55], v[76:79], v[92:95], v[52:55]
  buffer_load_dwordx4 v12, s[8:11], s66 offen offset:2048 lds
  v_mfma_f32_16x16x32_bf16 v[56:59], v[80:83], v[84:87], v[56:59]
  buffer_load_dwordx4 v13, s[8:11], s66 offen offset:3072 lds
  v_mfma_f32_16x16x32_bf16 v[60:63], v[80:83], v[88:91], v[60:63]
  s_add_u32 s3, s99, s65
  s_and_b32 s3, s3, 15
  s_and_b32 s38, s99, 16
  s_or_b32 s3, s3, s38
  s_lshl_b32 s3, s3, 10
  s_add_u32 s99, s99, 1
  s_add_u32 s67, s33, s3
  s_add_u32 s68, s34, s3
  s_add_u32 s69, s35, s3
  v_mfma_f32_16x16x32_bf16 v[64:67], v[80:83], v[92:95], v[64:67]
  buffer_load_dwordx4 v[84:87], v14, s[20:23], s67 offen sc1
  buffer_load_dwordx4 v[88:91], v14, s[20:23], s68 offen sc1
  buffer_load_dwordx4 v[92:95], v14, s[20:23], s69 offen sc1
  s_waitcnt lgkmcnt(0)
  s_waitcnt vmcnt(21)
  v_mfma_f32_16x16x32_bf16 v[20:23], v[140:143], v[96:99], v[20:23]
  ds_read_b64_tr_b16 v[68:69], v16 offset:8192
  ds_read_b64_tr_b16 v[70:71], v16 offset:10240
  v_mfma_f32_16x16x32_bf16 v[24:27], v[140:143], v[100:103], v[24:27]
  ds_read_b64_tr_b16 v[72:73], v17 offset:8192
  ds_read_b64_tr_b16 v[74:75], v17 offset:10240
  v_mfma_f32_16x16x32_bf16 v[28:31], v[140:143], v[104:107], v[28:31]
  ds_read_b64_tr_b16 v[76:77], v18 offset:8192
  ds_read_b64_tr_b16 v[78:79], v18 offset:10240
  v_mfma_f32_16x16x32_bf16 v[32:35], v[144:147], v[96:99], v[32:35]
  ds_read_b64_tr_b16 v[80:81], v19 offset:8192
  ds_read_b64_tr_b16 v[82:83], v19 offset:10240
  v_mfma_f32_16x16x32_bf16 v[36:39], v[144:147], v[100:103], v[36:39]
  s_add_u32 s66, s98, s65
  s_and_b32 s66, s66, 15
  s_and_b32 s37, s98, 16
  s_or_b32 s66, s66, s37
  s_lshl_b32 s66, s66, 10
  s_add_u32 s98, s98, 1
  s_add_u32 m0, s31, 4096
  s_mul_i32 s66, s66, 36
  s_add_u32 s66, s66, s30
  v_mfma_f32_16x16x32_bf16 v[40:43], v[144:147], v[104:107], v[40:43]
  buffer_load_dwordx4 v10, s[8:11], s66 offen offset:0 lds
  v_mfma_f32_16x16x32_bf16 v[44:47], v[148:151], v[96:99], v[44:47]
  buffer_load_dwordx4 v11, s[8:11], s66 offen offset:1024 lds
  v_mfma_f32_16x16x32_bf16 v[48:51], v[148:151], v[100:103], v[48:51]
  v_mfma_f32_16x16x32_bf16 v[52:55], v[148:151], v[104:107], v[52:55]
  buffer_load_dwordx4 v12, s[8:11], s66 offen offset:2048 lds
  v_mfma_f32_16x16x32_bf16 v[56:59], v[152:155], v[96:99], v[56:59]
  buffer_load_dwordx4 v13, s[8:11], s66 offen offset:3072 lds
  v_mfma_f32_16x16x32_bf16 v[60:63], v[152:155], v[100:103], v[60:63]
  s_add_u32 s3, s99, s65
  s_and_b32 s3, s3, 15
  s_and_b32 s38, s99, 16
  s_or_b32 s3, s3, s38
  s_lshl_b32 s3, s3, 10
  s_add_u32 s99, s99, 1
  s_add_u32 s67, s33, s3
  s_add_u32 s68, s34, s3
  s_add_u32 s69, s35, s3
  v_mfma_f32_16x16x32_bf16 v[64:67], v[152:155], v[104:107], v[64:67]
  buffer_load_dwordx4 v[96:99], v14, s[20:23], s67 offen sc1
  buffer_load_dwordx4 v[100:103], v14, s[20:23], s68 offen sc1
  buffer_load_dwordx4 v[104:107], v14, s[20:23], s69 offen sc1
  s_waitcnt lgkmcnt(0)
  s_waitcnt vmcnt(21)
  v_mfma_f32_16x16x32_bf16 v[20:23], v[68:71], v[108:111], v[20:23]
  ds_read_b64_tr_b16 v[140:141], v16 offset:12288
  ds_read_b64_tr_b16 v[142:143], v16 offset:14336
  v_mfma_f32_16x16x32_bf16 v[24:27], v[68:71], v[112:115], v[24:27]
  ds_read_b64_tr_b16 v[144:145], v17 offset:12288
  ds_read_b64_tr_b16 v[146:147], v17 offset:14336
  v_mfma_f32_16x16x32_bf16 v[28:31], v[68:71], v[116:119], v[28:31]
  ds_read_b64_tr_b16 v[148:149], v18 offset:12288
  ds_read_b64_tr_b16 v[150:151], v18 offset:14336
  v_mfma_f32_16x16x32_bf16 v[32:35], v[72:75], v[108:111], v[32:35]
  ds_read_b64_tr_b16 v[152:153], v19 offset:12288
  ds_read_b64_tr_b16 v[154:155], v19 offset:14336
  v_mfma_f32_16x16x32_bf16 v[36:39], v[72:75], v[112:115], v[36:39]
  s_add_u32 s3, s99, s65
  s_and_b32 s3, s3, 15
  s_and_b32 s38, s99, 16
  s_or_b32 s3, s3, s38
  s_lshl_b32 s3, s3, 10
  s_add_u32 s99, s99, 1
  s_add_u32 s67, s33, s3
  s_add_u32 s68, s34, s3
  s_add_u32 s69, s35, s3
  v_mfma_f32_16x16x32_bf16 v[40:43], v[72:75], v[116:119], v[40:43]
  v_mfma_f32_16x16x32_bf16 v[44:47], v[76:79], v[108:111], v[44:47]
  v_mfma_f32_16x16x32_bf16 v[48:51], v[76:79], v[112:115], v[48:51]
  v_mfma_f32_16x16x32_bf16 v[52:55], v[76:79], v[116:119], v[52:55]
  v_mfma_f32_16x16x32_bf16 v[56:59], v[80:83], v[108:111], v[56:59]
  v_mfma_f32_16x16x32_bf16 v[60:63], v[80:83], v[112:115], v[60:63]
  v_mfma_f32_16x16x32_bf16 v[64:67], v[80:83], v[116:119], v[64:67]
  buffer_load_dwordx4 v[108:111], v14, s[20:23], s67 offen sc1
  buffer_load_dwordx4 v[112:115], v14, s[20:23], s68 offen sc1
  buffer_load_dwordx4 v[116:119], v14, s[20:23], s69 offen sc1
  s_waitcnt lgkmcnt(0)
  s_waitcnt vmcnt(17)
  v_mfma_f32_16x16x32_bf16 v[20:23], v[140:143], v[120:123], v[20:23]
  ds_read_b64_tr_b16 v[68:69], v16 offset:16384
  ds_read_b64_tr_b16 v[70:71], v16 offset:18432
  v_mfma_f32_16x16x32_bf16 v[24:27], v[140:143], v[124:127], v[24:27]
  ds_read_b64_tr_b16 v[72:73], v17 offset:16384
  ds_read_b64_tr_b16 v[74:75], v17 offset:18432
  v_mfma_f32_16x16x32_bf16 v[28:31], v[140:143], v[128:131], v[28:31]
  ds_read_b64_tr_b16 v[76:77], v18 offset:16384
  ds_read_b64_tr_b16 v[78:79], v18 offset:18432
  v_mfma_f32_16x16x32_bf16 v[32:35], v[144:147], v[120:123], v[32:35]
  ds_read_b64_tr_b16 v[80:81], v19 offset:16384
  ds_read_b64_tr_b16 v[82:83], v19 offset:18432
  v_mfma_f32_16x16x32_bf16 v[36:39], v[144:147], v[124:127], v[36:39]
  s_add_u32 s3, s99, s65
  s_and_b32 s3, s3, 15
  s_and_b32 s38, s99, 16
  s_or_b32 s3, s3, s38
  s_lshl_b32 s3, s3, 10
  s_add_u32 s99, s99, 1
  s_add_u32 s67, s33, s3
  s_add_u32 s68, s34, s3
  s_add_u32 s69, s35, s3
  v_mfma_f32_16x16x32_bf16 v[40:43], v[144:147], v[128:131], v[40:43]
  v_mfma_f32_16x16x32_bf16 v[44:47], v[148:151], v[120:123], v[44:47]
  v_mfma_f32_16x16x32_bf16 v[48:51], v[148:151], v[124:127], v[48:51]
  v_mfma_f32_16x16x32_bf16 v[52:55], v[148:151], v[128:131], v[52:55]
  v_mfma_f32_16x16x32_bf16 v[56:59], v[152:155], v[120:123], v[56:59]
  v_mfma_f32_16x16x32_bf16 v[60:63], v[152:155], v[124:127], v[60:63]
  v_mfma_f32_16x16x32_bf16 v[64:67], v[152:155], v[128:131], v[64:67]
  buffer_load_dwordx4 v[120:123], v14, s[20:23], s67 offen sc1
  buffer_load_dwordx4 v[124:127], v14, s[20:23], s68 offen sc1
  buffer_load_dwordx4 v[128:131], v14, s[20:23], s69 offen sc1
  s_waitcnt lgkmcnt(0)
  s_waitcnt vmcnt(13)
  v_mfma_f32_16x16x32_bf16 v[20:23], v[68:71], v[84:87], v[20:23]
  ds_read_b64_tr_b16 v[140:141], v16 offset:20480
  ds_read_b64_tr_b16 v[142:143], v16 offset:22528
  v_mfma_f32_16x16x32_bf16 v[24:27], v[68:71], v[88:91], v[24:27]
  ds_read_b64_tr_b16 v[144:145], v17 offset:20480
  ds_read_b64_tr_b16 v[146:147], v17 offset:22528
  v_mfma_f32_16x16x32_bf16 v[28:31], v[68:71], v[92:95], v[28:31]
  ds_read_b64_tr_b16 v[148:149], v18 offset:20480
  ds_read_b64_tr_b16 v[150:151], v18 offset:22528
  v_mfma_f32_16x16x32_bf16 v[32:35], v[72:75], v[84:87], v[32:35]
  ds_read_b64_tr_b16 v[152:153], v19 offset:20480
  ds_read_b64_tr_b16 v[154:155], v19 offset:22528
  v_mfma_f32_16x16x32_bf16 v[36:39], v[72:75], v[88:91], v[36:39]
  s_add_u32 s3, s99, s65
  s_and_b32 s3, s3, 15
  s_and_b32 s38, s99, 16
  s_or_b32 s3, s3, s38
  s_lshl_b32 s3, s3, 10
  s_add_u32 s99, s99, 1
  s_add_u32 s67, s33, s3
  s_add_u32 s68, s34, s3
  s_add_u32 s69, s35, s3
  v_mfma_f32_16x16x32_bf16 v[40:43], v[72:75], v[92:95], v[40:43]
  v_mfma_f32_16x16x32_bf16 v[44:47], v[76:79], v[84:87], v[44:47]
  v_mfma_f32_16x16x32_bf16 v[48:51], v[76:79], v[88:91], v[48:51]
  v_mfma_f32_16x16x32_bf16 v[52:55], v[76:79], v[92:95], v[52:55]
  v_mfma_f32_16x16x32_bf16 v[56:59], v[80:83], v[84:87], v[56:59]
  v_mfma_f32_16x16x32_bf16 v[60:63], v[80:83], v[88:91], v[60:63]
  v_mfma_f32_16x16x32_bf16 v[64:67], v[80:83], v[92:95], v[64:67]
  buffer_load_dwordx4 v[84:87], v14, s[20:23], s67 offen sc1
  buffer_load_dwordx4 v[88:91], v14, s[20:23], s68 offen sc1
  buffer_load_dwordx4 v[92:95], v14, s[20:23], s69 offen sc1
  s_waitcnt lgkmcnt(0)
  s_waitcnt vmcnt(9)
  v_mfma_f32_16x16x32_bf16 v[20:23], v[140:143], v[96:99], v[20:23]
  ds_read_b64_tr_b16 v[68:69], v16 offset:24576
  ds_read_b64_tr_b16 v[70:71], v16 offset:26624
  v_mfma_f32_16x16x32_bf16 v[24:27], v[140:143], v[100:103], v[24:27]
  ds_read_b64_tr_b16 v[72:73], v17 offset:24576
  ds_read_b64_tr_b16 v[74:75], v17 offset:26624
  v_mfma_f32_16x16x32_bf16 v[28:31], v[140:143], v[104:107], v[28:31]
  ds_read_b64_tr_b16 v[76:77], v18 offset:24576
  ds_read_b64_tr_b16 v[78:79], v18 offset:26624
  v_mfma_f32_16x16x32_bf16 v[32:35], v[144:147], v[96:99], v[32:35]
  ds_read_b64_tr_b16 v[80:81], v19 offset:24576
  ds_read_b64_tr_b16 v[82:83], v19 offset:26624
  v_mfma_f32_16x16x32_bf16 v[36:39], v[144:147], v[100:103], v[36:39]
  s_add_u32 s3, s99, s65
  s_and_b32 s3, s3, 15
  s_and_b32 s38, s99, 16
  s_or_b32 s3, s3, s38
  s_lshl_b32 s3, s3, 10
  s_add_u32 s99, s99, 1
  s_add_u32 s67, s33, s3
  s_add_u32 s68, s34, s3
  s_add_u32 s69, s35, s3
  v_mfma_f32_16x16x32_bf16 v[40:43], v[144:147], v[104:107], v[40:43]
  v_mfma_f32_16x16x32_bf16 v[44:47], v[148:151], v[96:99], v[44:47]
  v_mfma_f32_16x16x32_bf16 v[48:51], v[148:151], v[100:103], v[48:51]
  v_mfma_f32_16x16x32_bf16 v[52:55], v[148:151], v[104:107], v[52:55]
  v_mfma_f32_16x16x32_bf16 v[56:59], v[152:155], v[96:99], v[56:59]
  v_mfma_f32_16x16x32_bf16 v[60:63], v[152:155], v[100:103], v[60:63]
  v_mfma_f32_16x16x32_bf16 v[64:67], v[152:155], v[104:107], v[64:67]
  buffer_load_dwordx4 v[96:99], v14, s[20:23], s67 offen sc1
  buffer_load_dwordx4 v[100:103], v14, s[20:23], s68 offen sc1
  buffer_load_dwordx4 v[104:107], v14, s[20:23], s69 offen sc1
  s_waitcnt lgkmcnt(0)
  s_waitcnt vmcnt(9)
  v_mfma_f32_16x16x32_bf16 v[20:23], v[68:71], v[108:111], v[20:23]
  ds_read_b64_tr_b16 v[140:141], v16 offset:28672
  ds_read_b64_tr_b16 v[142:143], v16 offset:30720
  v_mfma_f32_16x16x32_bf16 v[24:27], v[68:71], v[112:115], v[24:27]
  ds_read_b64_tr_b16 v[144:145], v17 offset:28672
  ds_read_b64_tr_b16 v[146:147], v17 offset:30720
  v_mfma_f32_16x16x32_bf16 v[28:31], v[68:71], v[116:119], v[28:31]
  ds_read_b64_tr_b16 v[148:149], v18 offset:28672
  ds_read_b64_tr_b16 v[150:151], v18 offset:30720
  v_mfma_f32_16x16x32_bf16 v[32:35], v[72:75], v[108:111], v[32:35]
  ds_read_b64_tr_b16 v[152:153], v19 offset:28672
  ds_read_b64_tr_b16 v[154:155], v19 offset:30720
  v_mfma_f32_16x16x32_bf16 v[36:39], v[72:75], v[112:115], v[36:39]
  s_add_u32 s3, s99, s65
  s_and_b32 s3, s3, 15
  s_and_b32 s38, s99, 16
  s_or_b32 s3, s3, s38
  s_lshl_b32 s3, s3, 10
  s_add_u32 s99, s99, 1
  s_add_u32 s67, s33, s3
  s_add_u32 s68, s34, s3
  s_add_u32 s69, s35, s3
  v_mfma_f32_16x16x32_bf16 v[40:43], v[72:75], v[116:119], v[40:43]
  v_mfma_f32_16x16x32_bf16 v[44:47], v[76:79], v[108:111], v[44:47]
  v_mfma_f32_16x16x32_bf16 v[48:51], v[76:79], v[112:115], v[48:51]
  v_mfma_f32_16x16x32_bf16 v[52:55], v[76:79], v[116:119], v[52:55]
  v_mfma_f32_16x16x32_bf16 v[56:59], v[80:83], v[108:111], v[56:59]
  v_mfma_f32_16x16x32_bf16 v[60:63], v[80:83], v[112:115], v[60:63]
  v_mfma_f32_16x16x32_bf16 v[64:67], v[80:83], v[116:119], v[64:67]
  buffer_load_dwordx4 v[108:111], v14, s[20:23], s67 offen sc1
  buffer_load_dwordx4 v[112:115], v14, s[20:23], s68 offen sc1
  buffer_load_dwordx4 v[116:119], v14, s[20:23], s69 offen sc1
  s_waitcnt lgkmcnt(0)
  s_waitcnt vmcnt(9)
  v_mfma_f32_16x16x32_bf16 v[20:23], v[140:143], v[120:123], v[20:23]
  ds_read_b64_tr_b16 v[68:69], v16 offset:32768
  ds_read_b64_tr_b16 v[70:71], v16 offset:34816
  v_mfma_f32_16x16x32_bf16 v[24:27], v[140:143], v[124:127], v[24:27]
  ds_read_b64_tr_b16 v[72:73], v17 offset:32768
  ds_read_b64_tr_b16 v[74:75], v17 offset:34816
  v_mfma_f32_16x16x32_bf16 v[28:31], v[140:143], v[128:131], v[28:31]
  ds_read_b64_tr_b16 v[76:77], v18 offset:32768
  ds_read_b64_tr_b16 v[78:79], v18 offset:34816
  v_mfma_f32_16x16x32_bf16 v[32:35], v[144:147], v[120:123], v[32:35]
  ds_read_b64_tr_b16 v[80:81], v19 offset:32768
  ds_read_b64_tr_b16 v[82:83], v19 offset:34816
  v_mfma_f32_16x16x32_bf16 v[36:39], v[144:147], v[124:127], v[36:39]
  s_add_u32 s3, s99, s65
  s_and_b32 s3, s3, 15
  s_and_b32 s38, s99, 16
  s_or_b32 s3, s3, s38
  s_lshl_b32 s3, s3, 10
  s_add_u32 s99, s99, 1
  s_add_u32 s67, s33, s3
  s_add_u32 s68, s34, s3
  s_add_u32 s69, s35, s3
  v_mfma_f32_16x16x32_bf16 v[40:43], v[144:147], v[128:131], v[40:43]
  v_mfma_f32_16x16x32_bf16 v[44:47], v[148:151], v[120:123], v[44:47]
  v_mfma_f32_16x16x32_bf16 v[48:51], v[148:151], v[124:127], v[48:51]
  v_mfma_f32_16x16x32_bf16 v[52:55], v[148:151], v[128:131], v[52:55]
  v_mfma_f32_16x16x32_bf16 v[56:59], v[152:155], v[120:123], v[56:59]
  v_mfma_f32_16x16x32_bf16 v[60:63], v[152:155], v[124:127], v[60:63]
  v_mfma_f32_16x16x32_bf16 v[64:67], v[152:155], v[128:131], v[64:67]
  buffer_load_dwordx4 v[120:123], v14, s[20:23], s67 offen sc1
  buffer_load_dwordx4 v[124:127], v14, s[20:23], s68 offen sc1
  buffer_load_dwordx4 v[128:131], v14, s[20:23], s69 offen sc1
  s_waitcnt lgkmcnt(0)
  s_waitcnt vmcnt(9)
  v_mfma_f32_16x16x32_bf16 v[20:23], v[68:71], v[84:87], v[20:23]
  ds_read_b64_tr_b16 v[140:141], v16 offset:36864
  ds_read_b64_tr_b16 v[142:143], v16 offset:38912
  v_mfma_f32_16x16x32_bf16 v[24:27], v[68:71], v[88:91], v[24:27]
  ds_read_b64_tr_b16 v[144:145], v17 offset:36864
  ds_read_b64_tr_b16 v[146:147], v17 offset:38912
  v_mfma_f32_16x16x32_bf16 v[28:31], v[68:71], v[92:95], v[28:31]
  ds_read_b64_tr_b16 v[148:149], v18 offset:36864
  ds_read_b64_tr_b16 v[150:151], v18 offset:38912
  v_mfma_f32_16x16x32_bf16 v[32:35], v[72:75], v[84:87], v[32:35]
  ds_read_b64_tr_b16 v[152:153], v19 offset:36864
  ds_read_b64_tr_b16 v[154:155], v19 offset:38912
  v_mfma_f32_16x16x32_bf16 v[36:39], v[72:75], v[88:91], v[36:39]
  v_mfma_f32_16x16x32_bf16 v[40:43], v[72:75], v[92:95], v[40:43]
  v_mfma_f32_16x16x32_bf16 v[44:47], v[76:79], v[84:87], v[44:47]
  v_mfma_f32_16x16x32_bf16 v[48:51], v[76:79], v[88:91], v[48:51]
  v_mfma_f32_16x16x32_bf16 v[52:55], v[76:79], v[92:95], v[52:55]
  v_mfma_f32_16x16x32_bf16 v[56:59], v[80:83], v[84:87], v[56:59]
  v_mfma_f32_16x16x32_bf16 v[60:63], v[80:83], v[88:91], v[60:63]
  v_mfma_f32_16x16x32_bf16 v[64:67], v[80:83], v[92:95], v[64:67]
  s_waitcnt lgkmcnt(0)
  s_waitcnt vmcnt(6)
  v_mfma_f32_16x16x32_bf16 v[20:23], v[140:143], v[96:99], v[20:23]
  ds_read_b64_tr_b16 v[68:69], v16 offset:0
  ds_read_b64_tr_b16 v[70:71], v16 offset:2048
  v_mfma_f32_16x16x32_bf16 v[24:27], v[140:143], v[100:103], v[24:27]
  ds_read_b64_tr_b16 v[72:73], v17 offset:0
  ds_read_b64_tr_b16 v[74:75], v17 offset:2048
  v_mfma_f32_16x16x32_bf16 v[28:31], v[140:143], v[104:107], v[28:31]
  ds_read_b64_tr_b16 v[76:77], v18 offset:0
  ds_read_b64_tr_b16 v[78:79], v18 offset:2048
  v_mfma_f32_16x16x32_bf16 v[32:35], v[144:147], v[96:99], v[32:35]
  ds_read_b64_tr_b16 v[80:81], v19 offset:0
  ds_read_b64_tr_b16 v[82:83], v19 offset:2048
  v_mfma_f32_16x16x32_bf16 v[36:39], v[144:147], v[100:103], v[36:39]
  v_mfma_f32_16x16x32_bf16 v[40:43], v[144:147], v[104:107], v[40:43]
  v_mfma_f32_16x16x32_bf16 v[44:47], v[148:151], v[96:99], v[44:47]
  v_mfma_f32_16x16x32_bf16 v[48:51], v[148:151], v[100:103], v[48:51]
  v_mfma_f32_16x16x32_bf16 v[52:55], v[148:151], v[104:107], v[52:55]
  v_mfma_f32_16x16x32_bf16 v[56:59], v[152:155], v[96:99], v[56:59]
  v_mfma_f32_16x16x32_bf16 v[60:63], v[152:155], v[100:103], v[60:63]
  v_mfma_f32_16x16x32_bf16 v[64:67], v[152:155], v[104:107], v[64:67]
  s_waitcnt lgkmcnt(0)
  s_waitcnt vmcnt(3)
  v_mfma_f32_16x16x32_bf16 v[20:23], v[68:71], v[108:111], v[20:23]
  ds_read_b64_tr_b16 v[140:141], v16 offset:4096
  ds_read_b64_tr_b16 v[142:143], v16 offset:6144
  v_mfma_f32_16x16x32_bf16 v[24:27], v[68:71], v[112:115], v[24:27]
  ds_read_b64_tr_b16 v[144:145], v17 offset:4096
  ds_read_b64_tr_b16 v[146:147], v17 offset:6144
  v_mfma_f32_16x16x32_bf16 v[28:31], v[68:71], v[116:119], v[28:31]
  ds_read_b64_tr_b16 v[148:149], v18 offset:4096
  ds_read_b64_tr_b16 v[150:151], v18 offset:6144
  v_mfma_f32_16x16x32_bf16 v[32:35], v[72:75], v[108:111], v[32:35]
  ds_read_b64_tr_b16 v[152:153], v19 offset:4096
  ds_read_b64_tr_b16 v[154:155], v19 offset:6144
  v_mfma_f32_16x16x32_bf16 v[36:39], v[72:75], v[112:115], v[36:39]
  v_mfma_f32_16x16x32_bf16 v[40:43], v[72:75], v[116:119], v[40:43]
  v_mfma_f32_16x16x32_bf16 v[44:47], v[76:79], v[108:111], v[44:47]
  v_mfma_f32_16x16x32_bf16 v[48:51], v[76:79], v[112:115], v[48:51]
  v_mfma_f32_16x16x32_bf16 v[52:55], v[76:79], v[116:119], v[52:55]
  v_mfma_f32_16x16x32_bf16 v[56:59], v[80:83], v[108:111], v[56:59]
  v_mfma_f32_16x16x32_bf16 v[60:63], v[80:83], v[112:115], v[60:63]
  v_mfma_f32_16x16x32_bf16 v[64:67], v[80:83], v[116:119], v[64:67]
  s_waitcnt lgkmcnt(0)
  s_waitcnt vmcnt(0)
  v_mfma_f32_16x16x32_bf16 v[20:23], v[140:143], v[120:123], v[20:23]
  v_mfma_f32_16x16x32_bf16 v[24:27], v[140:143], v[124:127], v[24:27]
  v_mfma_f32_16x16x32_bf16 v[28:31], v[140:143], v[128:131], v[28:31]
  v_mfma_f32_16x16x32_bf16 v[32:35], v[144:147], v[120:123], v[32:35]
  v_mfma_f32_16x16x32_bf16 v[36:39], v[144:147], v[124:127], v[36:39]
  v_mfma_f32_16x16x32_bf16 v[40:43], v[144:147], v[128:131], v[40:43]
  v_mfma_f32_16x16x32_bf16 v[44:47], v[148:151], v[120:123], v[44:47]
  v_mfma_f32_16x16x32_bf16 v[48:51], v[148:151], v[124:127], v[48:51]
  v_mfma_f32_16x16x32_bf16 v[52:55], v[148:151], v[128:131], v[52:55]
  v_mfma_f32_16x16x32_bf16 v[56:59], v[152:155], v[120:123], v[56:59]
  v_mfma_f32_16x16x32_bf16 v[60:63], v[152:155], v[124:127], v[60:63]
  v_mfma_f32_16x16x32_bf16 v[64:67], v[152:155], v[128:131], v[64:67]
  v_add_u32 v4, s31, v14
  ds_write_b128 v4, v[32:35] offset:0
  ds_write_b128 v4, v[36:39] offset:1024
  ds_write_b128 v4, v[40:43] offset:2048
  ds_write_b128 v4, v[44:47] offset:3072
  ds_write_b128 v4, v[48:51] offset:4096
  ds_write_b128 v4, v[52:55] offset:5120
  ds_write_b128 v4, v[56:59] offset:6144
  ds_write_b128 v4, v[60:63] offset:7168
  ds_write_b128 v4, v[64:67] offset:8192
  s_xor_b32 s37, s24, 1
  s_mul_i32 s37, s37, 40960
  v_add_u32 v7, s37, v14
  s_xor_b32 s37, s24, 2
  s_mul_i32 s37, s37, 40960
  v_add_u32 v8, s37, v14
  s_xor_b32 s37, s24, 3
  s_mul_i32 s37, s37, 40960
  v_add_u32 v9, s37, v14
  s_waitcnt lgkmcnt(0)
  s_barrier
  ds_read_b128 v[84:87], v7 offset:0
  ds_read_b128 v[88:91], v8 offset:3072
  ds_read_b128 v[92:95], v9 offset:6144
  ds_read_b128 v[96:99], v7 offset:1024
  ds_read_b128 v[100:103], v8 offset:4096
  ds_read_b128 v[104:107], v9 offset:7168
  ds_read_b128 v[108:111], v7 offset:2048
  ds_read_b128 v[112:115], v8 offset:5120
  ds_read_b128 v[116:119], v9 offset:8192
  s_lshl_b32 s37, s5, 4
  v_add_u32 v5, s37, v2
  s_movk_i32 s38, 2304
  v_mul_lo_u32 v5, v5, s38
  v_lshl_add_u32 v5, v3, 3, v5
  s_mul_i32 s37, s4, 1152
  s_lshl_b32 s38, s6, 1
  s_add_u32 s37, s37, s38
  s_lshl_b32 s38, s24, 5
  s_add_u32 s37, s37, s38
  s_waitcnt lgkmcnt(6)
  v_pk_add_f32 v[20:21], v[20:21], v[84:85]
  v_pk_add_f32 v[22:23], v[22:23], v[86:87]
  v_pk_add_f32 v[88:89], v[88:89], v[92:93]
  v_pk_add_f32 v[90:91], v[90:91], v[94:95]
  v_pk_add_f32 v[20:21], v[20:21], v[88:89]
  v_pk_add_f32 v[22:23], v[22:23], v[90:91]
  v_cvt_pk_bf16_f32 v20, v20, v21
  v_cvt_pk_bf16_f32 v21, v22, v23
  buffer_store_dwordx2 v[20:21], v5, s[12:15], s37 offen
  s_add_u32 s37, s37, 36864
  s_waitcnt lgkmcnt(3)
  v_pk_add_f32 v[24:25], v[24:25], v[96:97]
  v_pk_add_f32 v[26:27], v[26:27], v[98:99]
  v_pk_add_f32 v[100:101], v[100:101], v[104:105]
  v_pk_add_f32 v[102:103], v[102:103], v[106:107]
  v_pk_add_f32 v[24:25], v[24:25], v[100:101]
  v_pk_add_f32 v[26:27], v[26:27], v[102:103]
  v_cvt_pk_bf16_f32 v24, v24, v25
  v_cvt_pk_bf16_f32 v25, v26, v27
  buffer_store_dwordx2 v[24:25], v5, s[12:15], s37 offen
  s_add_u32 s37, s37, 36864
  s_waitcnt lgkmcnt(0)
  v_pk_add_f32 v[28:29], v[28:29], v[108:109]
  v_pk_add_f32 v[30:31], v[30:31], v[110:111]
  v_pk_add_f32 v[112:113], v[112:113], v[116:117]
  v_pk_add_f32 v[114:115], v[114:115], v[118:119]
  v_pk_add_f32 v[28:29], v[28:29], v[112:113]
  v_pk_add_f32 v[30:31], v[30:31], v[114:115]
  v_cvt_pk_bf16_f32 v28, v28, v29
  v_cvt_pk_bf16_f32 v29, v30, v31
  buffer_store_dwordx2 v[28:29], v5, s[12:15], s37 offen
L_concat_heads__gqa_block_cached__mha_block_cached__near_ridge_kernel_end:
  s_endpgm
L_concat_heads__gqa_block_cached__mha_block_cached__near_ridge_kernel_rare1:
  s_nop 7
  v_mov_b32 v49, v44
  s_nop 1
  v_permlane16_swap_b32 v44, v49
  v_max_f32 v44, v44, v49
  v_mov_b32 v49, v44
  s_nop 1
  v_permlane32_swap_b32 v44, v49
  v_max_f32 v44, v44, v49
  v_max_f32 v44, 0, v44
  v_sub_f32 v50, 0, v44
  v_exp_f32 v50, v50
  v_sub_f32 v24, v24, v44
  v_sub_f32 v25, v25, v44
  v_sub_f32 v26, v26, v44
  v_sub_f32 v27, v27, v44
  v_sub_f32 v56, v56, v44
  v_sub_f32 v57, v57, v44
  v_sub_f32 v58, v58, v44
  v_sub_f32 v59, v59, v44
  v_sub_f32 v60, v60, v44
  v_sub_f32 v61, v61, v44
  v_sub_f32 v62, v62, v44
  v_sub_f32 v63, v63, v44
  v_accvgpr_read_b32 v52, a144
  v_mul_f32 v52, v52, v50
  v_accvgpr_write_b32 a144, v52
  v_accvgpr_read_b32 v52, a145
  v_mul_f32 v52, v52, v50
  v_accvgpr_write_b32 a145, v52
  v_accvgpr_read_b32 v52, a146
  v_mul_f32 v52, v52, v50
  v_accvgpr_write_b32 a146, v52
  v_accvgpr_read_b32 v52, a147
  v_mul_f32 v52, v52, v50
  v_accvgpr_write_b32 a147, v52
  v_pk_mul_f32 v[96:97], v[96:97], v[50:51] op_sel_hi:[1,0]
  v_pk_mul_f32 v[98:99], v[98:99], v[50:51] op_sel_hi:[1,0]
  v_pk_mul_f32 v[116:117], v[116:117], v[50:51] op_sel_hi:[1,0]
  v_pk_mul_f32 v[118:119], v[118:119], v[50:51] op_sel_hi:[1,0]
  v_pk_mul_f32 v[136:137], v[136:137], v[50:51] op_sel_hi:[1,0]
  v_pk_mul_f32 v[138:139], v[138:139], v[50:51] op_sel_hi:[1,0]
  v_pk_mul_f32 v[156:157], v[156:157], v[50:51] op_sel_hi:[1,0]
  v_pk_mul_f32 v[158:159], v[158:159], v[50:51] op_sel_hi:[1,0]
  v_pk_mul_f32 v[176:177], v[176:177], v[50:51] op_sel_hi:[1,0]
  v_pk_mul_f32 v[178:179], v[178:179], v[50:51] op_sel_hi:[1,0]
  v_pk_mul_f32 v[196:197], v[196:197], v[50:51] op_sel_hi:[1,0]
  v_pk_mul_f32 v[198:199], v[198:199], v[50:51] op_sel_hi:[1,0]
  v_pk_mul_f32 v[216:217], v[216:217], v[50:51] op_sel_hi:[1,0]
  v_pk_mul_f32 v[218:219], v[218:219], v[50:51] op_sel_hi:[1,0]
  v_pk_mul_f32 v[236:237], v[236:237], v[50:51] op_sel_hi:[1,0]
  v_pk_mul_f32 v[238:239], v[238:239], v[50:51] op_sel_hi:[1,0]
  v_mov_b32 v49, v45
  s_nop 1
  v_permlane16_swap_b32 v45, v49
  v_max_f32 v45, v45, v49
  v_mov_b32 v49, v45
  s_nop 1
  v_permlane32_swap_b32 v45, v49
  v_max_f32 v45, v45, v49
  v_max_f32 v45, 0, v45
  v_sub_f32 v50, 0, v45
  v_exp_f32 v50, v50
  v_sub_f32 v28, v28, v45
  v_sub_f32 v29, v29, v45
  v_sub_f32 v30, v30, v45
  v_sub_f32 v31, v31, v45
  v_sub_f32 v64, v64, v45
  v_sub_f32 v65, v65, v45
  v_sub_f32 v66, v66, v45
  v_sub_f32 v67, v67, v45
  v_sub_f32 v68, v68, v45
  v_sub_f32 v69, v69, v45
  v_sub_f32 v70, v70, v45
  v_sub_f32 v71, v71, v45
  v_accvgpr_read_b32 v52, a148
  v_mul_f32 v52, v52, v50
  v_accvgpr_write_b32 a148, v52
  v_accvgpr_read_b32 v52, a149
  v_mul_f32 v52, v52, v50
  v_accvgpr_write_b32 a149, v52
  v_accvgpr_read_b32 v52, a150
  v_mul_f32 v52, v52, v50
  v_accvgpr_write_b32 a150, v52
  v_accvgpr_read_b32 v52, a151
  v_mul_f32 v52, v52, v50
  v_accvgpr_write_b32 a151, v52
  v_pk_mul_f32 v[100:101], v[100:101], v[50:51] op_sel_hi:[1,0]
  v_pk_mul_f32 v[102:103], v[102:103], v[50:51] op_sel_hi:[1,0]
  v_pk_mul_f32 v[120:121], v[120:121], v[50:51] op_sel_hi:[1,0]
  v_pk_mul_f32 v[122:123], v[122:123], v[50:51] op_sel_hi:[1,0]
  v_pk_mul_f32 v[140:141], v[140:141], v[50:51] op_sel_hi:[1,0]
  v_pk_mul_f32 v[142:143], v[142:143], v[50:51] op_sel_hi:[1,0]
  v_pk_mul_f32 v[160:161], v[160:161], v[50:51] op_sel_hi:[1,0]
  v_pk_mul_f32 v[162:163], v[162:163], v[50:51] op_sel_hi:[1,0]
  v_pk_mul_f32 v[180:181], v[180:181], v[50:51] op_sel_hi:[1,0]
  v_pk_mul_f32 v[182:183], v[182:183], v[50:51] op_sel_hi:[1,0]
  v_pk_mul_f32 v[200:201], v[200:201], v[50:51] op_sel_hi:[1,0]
  v_pk_mul_f32 v[202:203], v[202:203], v[50:51] op_sel_hi:[1,0]
  v_pk_mul_f32 v[220:221], v[220:221], v[50:51] op_sel_hi:[1,0]
  v_pk_mul_f32 v[222:223], v[222:223], v[50:51] op_sel_hi:[1,0]
  v_pk_mul_f32 v[240:241], v[240:241], v[50:51] op_sel_hi:[1,0]
  v_pk_mul_f32 v[242:243], v[242:243], v[50:51] op_sel_hi:[1,0]
  v_mov_b32 v49, v46
  s_nop 1
  v_permlane16_swap_b32 v46, v49
  v_max_f32 v46, v46, v49
  v_mov_b32 v49, v46
  s_nop 1
  v_permlane32_swap_b32 v46, v49
  v_max_f32 v46, v46, v49
  v_max_f32 v46, 0, v46
  v_sub_f32 v50, 0, v46
  v_exp_f32 v50, v50
  v_sub_f32 v32, v32, v46
  v_sub_f32 v33, v33, v46
  v_sub_f32 v34, v34, v46
  v_sub_f32 v35, v35, v46
  v_sub_f32 v72, v72, v46
  v_sub_f32 v73, v73, v46
  v_sub_f32 v74, v74, v46
  v_sub_f32 v75, v75, v46
  v_sub_f32 v76, v76, v46
  v_sub_f32 v77, v77, v46
  v_sub_f32 v78, v78, v46
  v_sub_f32 v79, v79, v46
  v_accvgpr_read_b32 v52, a152
  v_mul_f32 v52, v52, v50
  v_accvgpr_write_b32 a152, v52
  v_accvgpr_read_b32 v52, a153
  v_mul_f32 v52, v52, v50
  v_accvgpr_write_b32 a153, v52
  v_accvgpr_read_b32 v52, a154
  v_mul_f32 v52, v52, v50
  v_accvgpr_write_b32 a154, v52
  v_accvgpr_read_b32 v52, a155
  v_mul_f32 v52, v52, v50
  v_accvgpr_write_b32 a155, v52
  v_pk_mul_f32 v[104:105], v[104:105], v[50:51] op_sel_hi:[1,0]
  v_pk_mul_f32 v[106:107], v[106:107], v[50:51] op_sel_hi:[1,0]
  v_pk_mul_f32 v[124:125], v[124:125], v[50:51] op_sel_hi:[1,0]
  v_pk_mul_f32 v[126:127], v[126:127], v[50:51] op_sel_hi:[1,0]
  v_pk_mul_f32 v[144:145], v[144:145], v[50:51] op_sel_hi:[1,0]
  v_pk_mul_f32 v[146:147], v[146:147], v[50:51] op_sel_hi:[1,0]
  v_pk_mul_f32 v[164:165], v[164:165], v[50:51] op_sel_hi:[1,0]
  v_pk_mul_f32 v[166:167], v[166:167], v[50:51] op_sel_hi:[1,0]
  v_pk_mul_f32 v[184:185], v[184:185], v[50:51] op_sel_hi:[1,0]
  v_pk_mul_f32 v[186:187], v[186:187], v[50:51] op_sel_hi:[1,0]
  v_pk_mul_f32 v[204:205], v[204:205], v[50:51] op_sel_hi:[1,0]
  v_pk_mul_f32 v[206:207], v[206:207], v[50:51] op_sel_hi:[1,0]
  v_pk_mul_f32 v[224:225], v[224:225], v[50:51] op_sel_hi:[1,0]
  v_pk_mul_f32 v[226:227], v[226:227], v[50:51] op_sel_hi:[1,0]
  v_pk_mul_f32 v[244:245], v[244:245], v[50:51] op_sel_hi:[1,0]
  v_pk_mul_f32 v[246:247], v[246:247], v[50:51] op_sel_hi:[1,0]
  v_mov_b32 v49, v47
  s_nop 1
  v_permlane16_swap_b32 v47, v49
  v_max_f32 v47, v47, v49
  v_mov_b32 v49, v47
  s_nop 1
  v_permlane32_swap_b32 v47, v49
  v_max_f32 v47, v47, v49
  v_max_f32 v47, 0, v47
  v_sub_f32 v50, 0, v47
  v_exp_f32 v50, v50
  v_sub_f32 v36, v36, v47
  v_sub_f32 v37, v37, v47
  v_sub_f32 v38, v38, v47
  v_sub_f32 v39, v39, v47
  v_sub_f32 v80, v80, v47
  v_sub_f32 v81, v81, v47
  v_sub_f32 v82, v82, v47
  v_sub_f32 v83, v83, v47
  v_sub_f32 v84, v84, v47
  v_sub_f32 v85, v85, v47
  v_sub_f32 v86, v86, v47
  v_sub_f32 v87, v87, v47
  v_accvgpr_read_b32 v52, a156
  v_mul_f32 v52, v52, v50
  v_accvgpr_write_b32 a156, v52
  v_accvgpr_read_b32 v52, a157
  v_mul_f32 v52, v52, v50
  v_accvgpr_write_b32 a157, v52
  v_accvgpr_read_b32 v52, a158
  v_mul_f32 v52, v52, v50
  v_accvgpr_write_b32 a158, v52
  v_accvgpr_read_b32 v52, a159
  v_mul_f32 v52, v52, v50
  v_accvgpr_write_b32 a159, v52
  v_pk_mul_f32 v[108:109], v[108:109], v[50:51] op_sel_hi:[1,0]
  v_pk_mul_f32 v[110:111], v[110:111], v[50:51] op_sel_hi:[1,0]
  v_pk_mul_f32 v[128:129], v[128:129], v[50:51] op_sel_hi:[1,0]
  v_pk_mul_f32 v[130:131], v[130:131], v[50:51] op_sel_hi:[1,0]
  v_pk_mul_f32 v[148:149], v[148:149], v[50:51] op_sel_hi:[1,0]
  v_pk_mul_f32 v[150:151], v[150:151], v[50:51] op_sel_hi:[1,0]
  v_pk_mul_f32 v[168:169], v[168:169], v[50:51] op_sel_hi:[1,0]
  v_pk_mul_f32 v[170:171], v[170:171], v[50:51] op_sel_hi:[1,0]
  v_pk_mul_f32 v[188:189], v[188:189], v[50:51] op_sel_hi:[1,0]
  v_pk_mul_f32 v[190:191], v[190:191], v[50:51] op_sel_hi:[1,0]
  v_pk_mul_f32 v[208:209], v[208:209], v[50:51] op_sel_hi:[1,0]
  v_pk_mul_f32 v[210:211], v[210:211], v[50:51] op_sel_hi:[1,0]
  v_pk_mul_f32 v[228:229], v[228:229], v[50:51] op_sel_hi:[1,0]
  v_pk_mul_f32 v[230:231], v[230:231], v[50:51] op_sel_hi:[1,0]
  v_pk_mul_f32 v[248:249], v[248:249], v[50:51] op_sel_hi:[1,0]
  v_pk_mul_f32 v[250:251], v[250:251], v[50:51] op_sel_hi:[1,0]
  v_mov_b32 v49, v48
  s_nop 1
  v_permlane16_swap_b32 v48, v49
  v_max_f32 v48, v48, v49
  v_mov_b32 v49, v48
  s_nop 1
  v_permlane32_swap_b32 v48, v49
  v_max_f32 v48, v48, v49
  v_max_f32 v48, 0, v48
  v_sub_f32 v50, 0, v48
  v_exp_f32 v50, v50
  v_sub_f32 v40, v40, v48
  v_sub_f32 v41, v41, v48
  v_sub_f32 v42, v42, v48
  v_sub_f32 v43, v43, v48
  v_sub_f32 v88, v88, v48
  v_sub_f32 v89, v89, v48
  v_sub_f32 v90, v90, v48
  v_sub_f32 v91, v91, v48
  v_sub_f32 v92, v92, v48
  v_sub_f32 v93, v93, v48
  v_sub_f32 v94, v94, v48
  v_sub_f32 v95, v95, v48
  v_accvgpr_read_b32 v52, a160
  v_mul_f32 v52, v52, v50
  v_accvgpr_write_b32 a160, v52
  v_accvgpr_read_b32 v52, a161
  v_mul_f32 v52, v52, v50
  v_accvgpr_write_b32 a161, v52
  v_accvgpr_read_b32 v52, a162
  v_mul_f32 v52, v52, v50
  v_accvgpr_write_b32 a162, v52
  v_accvgpr_read_b32 v52, a163
  v_mul_f32 v52, v52, v50
  v_accvgpr_write_b32 a163, v52
  v_pk_mul_f32 v[112:113], v[112:113], v[50:51] op_sel_hi:[1,0]
  v_pk_mul_f32 v[114:115], v[114:115], v[50:51] op_sel_hi:[1,0]
  v_pk_mul_f32 v[132:133], v[132:133], v[50:51] op_sel_hi:[1,0]
  v_pk_mul_f32 v[134:135], v[134:135], v[50:51] op_sel_hi:[1,0]
  v_pk_mul_f32 v[152:153], v[152:153], v[50:51] op_sel_hi:[1,0]
  v_pk_mul_f32 v[154:155], v[154:155], v[50:51] op_sel_hi:[1,0]
  v_pk_mul_f32 v[172:173], v[172:173], v[50:51] op_sel_hi:[1,0]
  v_pk_mul_f32 v[174:175], v[174:175], v[50:51] op_sel_hi:[1,0]
  v_pk_mul_f32 v[192:193], v[192:193], v[50:51] op_sel_hi:[1,0]
  v_pk_mul_f32 v[194:195], v[194:195], v[50:51] op_sel_hi:[1,0]
  v_pk_mul_f32 v[212:213], v[212:213], v[50:51] op_sel_hi:[1,0]
  v_pk_mul_f32 v[214:215], v[214:215], v[50:51] op_sel_hi:[1,0]
  v_pk_mul_f32 v[232:233], v[232:233], v[50:51] op_sel_hi:[1,0]
  v_pk_mul_f32 v[234:235], v[234:235], v[50:51] op_sel_hi:[1,0]
  v_pk_mul_f32 v[252:253], v[252:253], v[50:51] op_sel_hi:[1,0]
  v_pk_mul_f32 v[254:255], v[254:255], v[50:51] op_sel_hi:[1,0]
  s_nop 7
  s_branch L_concat_heads__gqa_block_cached__mha_block_cached__near_ridge_kernel_back1
L_concat_heads__gqa_block_cached__mha_block_cached__near_ridge_kernel_rare2:
  s_nop 7
  v_mov_b32 v49, v44
  s_nop 1
  v_permlane16_swap_b32 v44, v49
  v_max_f32 v44, v44, v49
  v_mov_b32 v49, v44
  s_nop 1
  v_permlane32_swap_b32 v44, v49
  v_max_f32 v44, v44, v49
  v_max_f32 v44, 0, v44
  v_sub_f32 v50, 0, v44
  v_exp_f32 v50, v50
  v_sub_f32 v24, v24, v44
  v_sub_f32 v25, v25, v44
  v_sub_f32 v26, v26, v44
  v_sub_f32 v27, v27, v44
  v_sub_f32 v56, v56, v44
  v_sub_f32 v57, v57, v44
  v_sub_f32 v58, v58, v44
  v_sub_f32 v59, v59, v44
  v_sub_f32 v60, v60, v44
  v_sub_f32 v61, v61, v44
  v_sub_f32 v62, v62, v44
  v_sub_f32 v63, v63, v44
  v_accvgpr_read_b32 v52, a144
  v_mul_f32 v52, v52, v50
  v_accvgpr_write_b32 a144, v52
  v_accvgpr_read_b32 v52, a145
  v_mul_f32 v52, v52, v50
  v_accvgpr_write_b32 a145, v52
  v_accvgpr_read_b32 v52, a146
  v_mul_f32 v52, v52, v50
  v_accvgpr_write_b32 a146, v52
  v_accvgpr_read_b32 v52, a147
  v_mul_f32 v52, v52, v50
  v_accvgpr_write_b32 a147, v52
  v_pk_mul_f32 v[96:97], v[96:97], v[50:51] op_sel_hi:[1,0]
  v_pk_mul_f32 v[98:99], v[98:99], v[50:51] op_sel_hi:[1,0]
  v_pk_mul_f32 v[116:117], v[116:117], v[50:51] op_sel_hi:[1,0]
  v_pk_mul_f32 v[118:119], v[118:119], v[50:51] op_sel_hi:[1,0]
  v_pk_mul_f32 v[136:137], v[136:137], v[50:51] op_sel_hi:[1,0]
  v_pk_mul_f32 v[138:139], v[138:139], v[50:51] op_sel_hi:[1,0]
  v_pk_mul_f32 v[156:157], v[156:157], v[50:51] op_sel_hi:[1,0]
  v_pk_mul_f32 v[158:159], v[158:159], v[50:51] op_sel_hi:[1,0]
  v_pk_mul_f32 v[176:177], v[176:177], v[50:51] op_sel_hi:[1,0]
  v_pk_mul_f32 v[178:179], v[178:179], v[50:51] op_sel_hi:[1,0]
  v_pk_mul_f32 v[196:197], v[196:197], v[50:51] op_sel_hi:[1,0]
  v_pk_mul_f32 v[198:199], v[198:199], v[50:51] op_sel_hi:[1,0]
  v_pk_mul_f32 v[216:217], v[216:217], v[50:51] op_sel_hi:[1,0]
  v_pk_mul_f32 v[218:219], v[218:219], v[50:51] op_sel_hi:[1,0]
  v_pk_mul_f32 v[236:237], v[236:237], v[50:51] op_sel_hi:[1,0]
  v_pk_mul_f32 v[238:239], v[238:239], v[50:51] op_sel_hi:[1,0]
  v_mov_b32 v49, v45
  s_nop 1
  v_permlane16_swap_b32 v45, v49
  v_max_f32 v45, v45, v49
  v_mov_b32 v49, v45
  s_nop 1
  v_permlane32_swap_b32 v45, v49
  v_max_f32 v45, v45, v49
  v_max_f32 v45, 0, v45
  v_sub_f32 v50, 0, v45
  v_exp_f32 v50, v50
  v_sub_f32 v28, v28, v45
  v_sub_f32 v29, v29, v45
  v_sub_f32 v30, v30, v45
  v_sub_f32 v31, v31, v45
  v_sub_f32 v64, v64, v45
  v_sub_f32 v65, v65, v45
  v_sub_f32 v66, v66, v45
  v_sub_f32 v67, v67, v45
  v_sub_f32 v68, v68, v45
  v_sub_f32 v69, v69, v45
  v_sub_f32 v70, v70, v45
  v_sub_f32 v71, v71, v45
  v_accvgpr_read_b32 v52, a148
  v_mul_f32 v52, v52, v50
  v_accvgpr_write_b32 a148, v52
  v_accvgpr_read_b32 v52, a149
  v_mul_f32 v52, v52, v50
  v_accvgpr_write_b32 a149, v52
  v_accvgpr_read_b32 v52, a150
  v_mul_f32 v52, v52, v50
  v_accvgpr_write_b32 a150, v52
  v_accvgpr_read_b32 v52, a151
  v_mul_f32 v52, v52, v50
  v_accvgpr_write_b32 a151, v52
  v_pk_mul_f32 v[100:101], v[100:101], v[50:51] op_sel_hi:[1,0]
  v_pk_mul_f32 v[102:103], v[102:103], v[50:51] op_sel_hi:[1,0]
  v_pk_mul_f32 v[120:121], v[120:121], v[50:51] op_sel_hi:[1,0]
  v_pk_mul_f32 v[122:123], v[122:123], v[50:51] op_sel_hi:[1,0]
  v_pk_mul_f32 v[140:141], v[140:141], v[50:51] op_sel_hi:[1,0]
  v_pk_mul_f32 v[142:143], v[142:143], v[50:51] op_sel_hi:[1,0]
  v_pk_mul_f32 v[160:161], v[160:161], v[50:51] op_sel_hi:[1,0]
  v_pk_mul_f32 v[162:163], v[162:163], v[50:51] op_sel_hi:[1,0]
  v_pk_mul_f32 v[180:181], v[180:181], v[50:51] op_sel_hi:[1,0]
  v_pk_mul_f32 v[182:183], v[182:183], v[50:51] op_sel_hi:[1,0]
  v_pk_mul_f32 v[200:201], v[200:201], v[50:51] op_sel_hi:[1,0]
  v_pk_mul_f32 v[202:203], v[202:203], v[50:51] op_sel_hi:[1,0]
  v_pk_mul_f32 v[220:221], v[220:221], v[50:51] op_sel_hi:[1,0]
  v_pk_mul_f32 v[222:223], v[222:223], v[50:51] op_sel_hi:[1,0]
  v_pk_mul_f32 v[240:241], v[240:241], v[50:51] op_sel_hi:[1,0]
  v_pk_mul_f32 v[242:243], v[242:243], v[50:51] op_sel_hi:[1,0]
  v_mov_b32 v49, v46
  s_nop 1
  v_permlane16_swap_b32 v46, v49
  v_max_f32 v46, v46, v49
  v_mov_b32 v49, v46
  s_nop 1
  v_permlane32_swap_b32 v46, v49
  v_max_f32 v46, v46, v49
  v_max_f32 v46, 0, v46
  v_sub_f32 v50, 0, v46
  v_exp_f32 v50, v50
  v_sub_f32 v32, v32, v46
  v_sub_f32 v33, v33, v46
  v_sub_f32 v34, v34, v46
  v_sub_f32 v35, v35, v46
  v_sub_f32 v72, v72, v46
  v_sub_f32 v73, v73, v46
  v_sub_f32 v74, v74, v46
  v_sub_f32 v75, v75, v46
  v_sub_f32 v76, v76, v46
  v_sub_f32 v77, v77, v46
  v_sub_f32 v78, v78, v46
  v_sub_f32 v79, v79, v46
  v_accvgpr_read_b32 v52, a152
  v_mul_f32 v52, v52, v50
  v_accvgpr_write_b32 a152, v52
  v_accvgpr_read_b32 v52, a153
  v_mul_f32 v52, v52, v50
  v_accvgpr_write_b32 a153, v52
  v_accvgpr_read_b32 v52, a154
  v_mul_f32 v52, v52, v50
  v_accvgpr_write_b32 a154, v52
  v_accvgpr_read_b32 v52, a155
  v_mul_f32 v52, v52, v50
  v_accvgpr_write_b32 a155, v52
  v_pk_mul_f32 v[104:105], v[104:105], v[50:51] op_sel_hi:[1,0]
  v_pk_mul_f32 v[106:107], v[106:107], v[50:51] op_sel_hi:[1,0]
  v_pk_mul_f32 v[124:125], v[124:125], v[50:51] op_sel_hi:[1,0]
  v_pk_mul_f32 v[126:127], v[126:127], v[50:51] op_sel_hi:[1,0]
  v_pk_mul_f32 v[144:145], v[144:145], v[50:51] op_sel_hi:[1,0]
  v_pk_mul_f32 v[146:147], v[146:147], v[50:51] op_sel_hi:[1,0]
  v_pk_mul_f32 v[164:165], v[164:165], v[50:51] op_sel_hi:[1,0]
  v_pk_mul_f32 v[166:167], v[166:167], v[50:51] op_sel_hi:[1,0]
  v_pk_mul_f32 v[184:185], v[184:185], v[50:51] op_sel_hi:[1,0]
  v_pk_mul_f32 v[186:187], v[186:187], v[50:51] op_sel_hi:[1,0]
  v_pk_mul_f32 v[204:205], v[204:205], v[50:51] op_sel_hi:[1,0]
  v_pk_mul_f32 v[206:207], v[206:207], v[50:51] op_sel_hi:[1,0]
  v_pk_mul_f32 v[224:225], v[224:225], v[50:51] op_sel_hi:[1,0]
  v_pk_mul_f32 v[226:227], v[226:227], v[50:51] op_sel_hi:[1,0]
  v_pk_mul_f32 v[244:245], v[244:245], v[50:51] op_sel_hi:[1,0]
  v_pk_mul_f32 v[246:247], v[246:247], v[50:51] op_sel_hi:[1,0]
  v_mov_b32 v49, v47
  s_nop 1
  v_permlane16_swap_b32 v47, v49
  v_max_f32 v47, v47, v49
  v_mov_b32 v49, v47
  s_nop 1
  v_permlane32_swap_b32 v47, v49
  v_max_f32 v47, v47, v49
  v_max_f32 v47, 0, v47
  v_sub_f32 v50, 0, v47
  v_exp_f32 v50, v50
  v_sub_f32 v36, v36, v47
  v_sub_f32 v37, v37, v47
  v_sub_f32 v38, v38, v47
  v_sub_f32 v39, v39, v47
  v_sub_f32 v80, v80, v47
  v_sub_f32 v81, v81, v47
  v_sub_f32 v82, v82, v47
  v_sub_f32 v83, v83, v47
  v_sub_f32 v84, v84, v47
  v_sub_f32 v85, v85, v47
  v_sub_f32 v86, v86, v47
  v_sub_f32 v87, v87, v47
  v_accvgpr_read_b32 v52, a156
  v_mul_f32 v52, v52, v50
  v_accvgpr_write_b32 a156, v52
  v_accvgpr_read_b32 v52, a157
  v_mul_f32 v52, v52, v50
  v_accvgpr_write_b32 a157, v52
  v_accvgpr_read_b32 v52, a158
  v_mul_f32 v52, v52, v50
  v_accvgpr_write_b32 a158, v52
  v_accvgpr_read_b32 v52, a159
  v_mul_f32 v52, v52, v50
  v_accvgpr_write_b32 a159, v52
  v_pk_mul_f32 v[108:109], v[108:109], v[50:51] op_sel_hi:[1,0]
  v_pk_mul_f32 v[110:111], v[110:111], v[50:51] op_sel_hi:[1,0]
  v_pk_mul_f32 v[128:129], v[128:129], v[50:51] op_sel_hi:[1,0]
  v_pk_mul_f32 v[130:131], v[130:131], v[50:51] op_sel_hi:[1,0]
  v_pk_mul_f32 v[148:149], v[148:149], v[50:51] op_sel_hi:[1,0]
  v_pk_mul_f32 v[150:151], v[150:151], v[50:51] op_sel_hi:[1,0]
  v_pk_mul_f32 v[168:169], v[168:169], v[50:51] op_sel_hi:[1,0]
  v_pk_mul_f32 v[170:171], v[170:171], v[50:51] op_sel_hi:[1,0]
  v_pk_mul_f32 v[188:189], v[188:189], v[50:51] op_sel_hi:[1,0]
  v_pk_mul_f32 v[190:191], v[190:191], v[50:51] op_sel_hi:[1,0]
  v_pk_mul_f32 v[208:209], v[208:209], v[50:51] op_sel_hi:[1,0]
  v_pk_mul_f32 v[210:211], v[210:211], v[50:51] op_sel_hi:[1,0]
  v_pk_mul_f32 v[228:229], v[228:229], v[50:51] op_sel_hi:[1,0]
  v_pk_mul_f32 v[230:231], v[230:231], v[50:51] op_sel_hi:[1,0]
  v_pk_mul_f32 v[248:249], v[248:249], v[50:51] op_sel_hi:[1,0]
  v_pk_mul_f32 v[250:251], v[250:251], v[50:51] op_sel_hi:[1,0]
  v_mov_b32 v49, v48
  s_nop 1
  v_permlane16_swap_b32 v48, v49
  v_max_f32 v48, v48, v49
  v_mov_b32 v49, v48
  s_nop 1
  v_permlane32_swap_b32 v48, v49
  v_max_f32 v48, v48, v49
  v_max_f32 v48, 0, v48
  v_sub_f32 v50, 0, v48
  v_exp_f32 v50, v50
  v_sub_f32 v40, v40, v48
  v_sub_f32 v41, v41, v48
  v_sub_f32 v42, v42, v48
  v_sub_f32 v43, v43, v48
  v_sub_f32 v88, v88, v48
  v_sub_f32 v89, v89, v48
  v_sub_f32 v90, v90, v48
  v_sub_f32 v91, v91, v48
  v_sub_f32 v92, v92, v48
  v_sub_f32 v93, v93, v48
  v_sub_f32 v94, v94, v48
  v_sub_f32 v95, v95, v48
  v_accvgpr_read_b32 v52, a160
  v_mul_f32 v52, v52, v50
  v_accvgpr_write_b32 a160, v52
  v_accvgpr_read_b32 v52, a161
  v_mul_f32 v52, v52, v50
  v_accvgpr_write_b32 a161, v52
  v_accvgpr_read_b32 v52, a162
  v_mul_f32 v52, v52, v50
  v_accvgpr_write_b32 a162, v52
  v_accvgpr_read_b32 v52, a163
  v_mul_f32 v52, v52, v50
  v_accvgpr_write_b32 a163, v52
  v_pk_mul_f32 v[112:113], v[112:113], v[50:51] op_sel_hi:[1,0]
  v_pk_mul_f32 v[114:115], v[114:115], v[50:51] op_sel_hi:[1,0]
  v_pk_mul_f32 v[132:133], v[132:133], v[50:51] op_sel_hi:[1,0]
  v_pk_mul_f32 v[134:135], v[134:135], v[50:51] op_sel_hi:[1,0]
  v_pk_mul_f32 v[152:153], v[152:153], v[50:51] op_sel_hi:[1,0]
  v_pk_mul_f32 v[154:155], v[154:155], v[50:51] op_sel_hi:[1,0]
  v_pk_mul_f32 v[172:173], v[172:173], v[50:51] op_sel_hi:[1,0]
  v_pk_mul_f32 v[174:175], v[174:175], v[50:51] op_sel_hi:[1,0]
  v_pk_mul_f32 v[192:193], v[192:193], v[50:51] op_sel_hi:[1,0]
  v_pk_mul_f32 v[194:195], v[194:195], v[50:51] op_sel_hi:[1,0]
  v_pk_mul_f32 v[212:213], v[212:213], v[50:51] op_sel_hi:[1,0]
  v_pk_mul_f32 v[214:215], v[214:215], v[50:51] op_sel_hi:[1,0]
  v_pk_mul_f32 v[232:233], v[232:233], v[50:51] op_sel_hi:[1,0]
  v_pk_mul_f32 v[234:235], v[234:235], v[50:51] op_sel_hi:[1,0]
  v_pk_mul_f32 v[252:253], v[252:253], v[50:51] op_sel_hi:[1,0]
  v_pk_mul_f32 v[254:255], v[254:255], v[50:51] op_sel_hi:[1,0]
  s_nop 7
  s_branch L_concat_heads__gqa_block_cached__mha_block_cached__near_ridge_kernel_back2
L_concat_heads__gqa_block_cached__mha_block_cached__near_ridge_kernel_rare3:
  s_nop 7
  v_mov_b32 v49, v44
  s_nop 1
  v_permlane16_swap_b32 v44, v49
  v_max_f32 v44, v44, v49
  v_mov_b32 v49, v44
  s_nop 1
  v_permlane32_swap_b32 v44, v49
  v_max_f32 v44, v44, v49
  v_max_f32 v44, 0, v44
  v_sub_f32 v50, 0, v44
  v_exp_f32 v50, v50
  v_sub_f32 v24, v24, v44
  v_sub_f32 v25, v25, v44
  v_sub_f32 v26, v26, v44
  v_sub_f32 v27, v27, v44
  v_sub_f32 v56, v56, v44
  v_sub_f32 v57, v57, v44
  v_sub_f32 v58, v58, v44
  v_sub_f32 v59, v59, v44
  v_sub_f32 v60, v60, v44
  v_sub_f32 v61, v61, v44
  v_sub_f32 v62, v62, v44
  v_sub_f32 v63, v63, v44
  v_accvgpr_read_b32 v52, a144
  v_mul_f32 v52, v52, v50
  v_accvgpr_write_b32 a144, v52
  v_accvgpr_read_b32 v52, a145
  v_mul_f32 v52, v52, v50
  v_accvgpr_write_b32 a145, v52
  v_accvgpr_read_b32 v52, a146
  v_mul_f32 v52, v52, v50
  v_accvgpr_write_b32 a146, v52
  v_accvgpr_read_b32 v52, a147
  v_mul_f32 v52, v52, v50
  v_accvgpr_write_b32 a147, v52
  v_pk_mul_f32 v[96:97], v[96:97], v[50:51] op_sel_hi:[1,0]
  v_pk_mul_f32 v[98:99], v[98:99], v[50:51] op_sel_hi:[1,0]
  v_pk_mul_f32 v[116:117], v[116:117], v[50:51] op_sel_hi:[1,0]
  v_pk_mul_f32 v[118:119], v[118:119], v[50:51] op_sel_hi:[1,0]
  v_pk_mul_f32 v[136:137], v[136:137], v[50:51] op_sel_hi:[1,0]
  v_pk_mul_f32 v[138:139], v[138:139], v[50:51] op_sel_hi:[1,0]
  v_pk_mul_f32 v[156:157], v[156:157], v[50:51] op_sel_hi:[1,0]
  v_pk_mul_f32 v[158:159], v[158:159], v[50:51] op_sel_hi:[1,0]
  v_pk_mul_f32 v[176:177], v[176:177], v[50:51] op_sel_hi:[1,0]
  v_pk_mul_f32 v[178:179], v[178:179], v[50:51] op_sel_hi:[1,0]
  v_pk_mul_f32 v[196:197], v[196:197], v[50:51] op_sel_hi:[1,0]
  v_pk_mul_f32 v[198:199], v[198:199], v[50:51] op_sel_hi:[1,0]
  v_pk_mul_f32 v[216:217], v[216:217], v[50:51] op_sel_hi:[1,0]
  v_pk_mul_f32 v[218:219], v[218:219], v[50:51] op_sel_hi:[1,0]
  v_pk_mul_f32 v[236:237], v[236:237], v[50:51] op_sel_hi:[1,0]
  v_pk_mul_f32 v[238:239], v[238:239], v[50:51] op_sel_hi:[1,0]
  v_mov_b32 v49, v45
  s_nop 1
  v_permlane16_swap_b32 v45, v49
  v_max_f32 v45, v45, v49
  v_mov_b32 v49, v45
  s_nop 1
  v_permlane32_swap_b32 v45, v49
  v_max_f32 v45, v45, v49
  v_max_f32 v45, 0, v45
  v_sub_f32 v50, 0, v45
  v_exp_f32 v50, v50
  v_sub_f32 v28, v28, v45
  v_sub_f32 v29, v29, v45
  v_sub_f32 v30, v30, v45
  v_sub_f32 v31, v31, v45
  v_sub_f32 v64, v64, v45
  v_sub_f32 v65, v65, v45
  v_sub_f32 v66, v66, v45
  v_sub_f32 v67, v67, v45
  v_sub_f32 v68, v68, v45
  v_sub_f32 v69, v69, v45
  v_sub_f32 v70, v70, v45
  v_sub_f32 v71, v71, v45
  v_accvgpr_read_b32 v52, a148
  v_mul_f32 v52, v52, v50
  v_accvgpr_write_b32 a148, v52
  v_accvgpr_read_b32 v52, a149
  v_mul_f32 v52, v52, v50
  v_accvgpr_write_b32 a149, v52
  v_accvgpr_read_b32 v52, a150
  v_mul_f32 v52, v52, v50
  v_accvgpr_write_b32 a150, v52
  v_accvgpr_read_b32 v52, a151
  v_mul_f32 v52, v52, v50
  v_accvgpr_write_b32 a151, v52
  v_pk_mul_f32 v[100:101], v[100:101], v[50:51] op_sel_hi:[1,0]
  v_pk_mul_f32 v[102:103], v[102:103], v[50:51] op_sel_hi:[1,0]
  v_pk_mul_f32 v[120:121], v[120:121], v[50:51] op_sel_hi:[1,0]
  v_pk_mul_f32 v[122:123], v[122:123], v[50:51] op_sel_hi:[1,0]
  v_pk_mul_f32 v[140:141], v[140:141], v[50:51] op_sel_hi:[1,0]
  v_pk_mul_f32 v[142:143], v[142:143], v[50:51] op_sel_hi:[1,0]
  v_pk_mul_f32 v[160:161], v[160:161], v[50:51] op_sel_hi:[1,0]
  v_pk_mul_f32 v[162:163], v[162:163], v[50:51] op_sel_hi:[1,0]
  v_pk_mul_f32 v[180:181], v[180:181], v[50:51] op_sel_hi:[1,0]
  v_pk_mul_f32 v[182:183], v[182:183], v[50:51] op_sel_hi:[1,0]
  v_pk_mul_f32 v[200:201], v[200:201], v[50:51] op_sel_hi:[1,0]
  v_pk_mul_f32 v[202:203], v[202:203], v[50:51] op_sel_hi:[1,0]
  v_pk_mul_f32 v[220:221], v[220:221], v[50:51] op_sel_hi:[1,0]
  v_pk_mul_f32 v[222:223], v[222:223], v[50:51] op_sel_hi:[1,0]
  v_pk_mul_f32 v[240:241], v[240:241], v[50:51] op_sel_hi:[1,0]
  v_pk_mul_f32 v[242:243], v[242:243], v[50:51] op_sel_hi:[1,0]
  v_mov_b32 v49, v46
  s_nop 1
  v_permlane16_swap_b32 v46, v49
  v_max_f32 v46, v46, v49
  v_mov_b32 v49, v46
  s_nop 1
  v_permlane32_swap_b32 v46, v49
  v_max_f32 v46, v46, v49
  v_max_f32 v46, 0, v46
  v_sub_f32 v50, 0, v46
  v_exp_f32 v50, v50
  v_sub_f32 v32, v32, v46
  v_sub_f32 v33, v33, v46
  v_sub_f32 v34, v34, v46
  v_sub_f32 v35, v35, v46
  v_sub_f32 v72, v72, v46
  v_sub_f32 v73, v73, v46
  v_sub_f32 v74, v74, v46
  v_sub_f32 v75, v75, v46
  v_sub_f32 v76, v76, v46
  v_sub_f32 v77, v77, v46
  v_sub_f32 v78, v78, v46
  v_sub_f32 v79, v79, v46
  v_accvgpr_read_b32 v52, a152
  v_mul_f32 v52, v52, v50
  v_accvgpr_write_b32 a152, v52
  v_accvgpr_read_b32 v52, a153
  v_mul_f32 v52, v52, v50
  v_accvgpr_write_b32 a153, v52
  v_accvgpr_read_b32 v52, a154
  v_mul_f32 v52, v52, v50
  v_accvgpr_write_b32 a154, v52
  v_accvgpr_read_b32 v52, a155
  v_mul_f32 v52, v52, v50
  v_accvgpr_write_b32 a155, v52
  v_pk_mul_f32 v[104:105], v[104:105], v[50:51] op_sel_hi:[1,0]
  v_pk_mul_f32 v[106:107], v[106:107], v[50:51] op_sel_hi:[1,0]
  v_pk_mul_f32 v[124:125], v[124:125], v[50:51] op_sel_hi:[1,0]
  v_pk_mul_f32 v[126:127], v[126:127], v[50:51] op_sel_hi:[1,0]
  v_pk_mul_f32 v[144:145], v[144:145], v[50:51] op_sel_hi:[1,0]
  v_pk_mul_f32 v[146:147], v[146:147], v[50:51] op_sel_hi:[1,0]
  v_pk_mul_f32 v[164:165], v[164:165], v[50:51] op_sel_hi:[1,0]
  v_pk_mul_f32 v[166:167], v[166:167], v[50:51] op_sel_hi:[1,0]
  v_pk_mul_f32 v[184:185], v[184:185], v[50:51] op_sel_hi:[1,0]
  v_pk_mul_f32 v[186:187], v[186:187], v[50:51] op_sel_hi:[1,0]
  v_pk_mul_f32 v[204:205], v[204:205], v[50:51] op_sel_hi:[1,0]
  v_pk_mul_f32 v[206:207], v[206:207], v[50:51] op_sel_hi:[1,0]
  v_pk_mul_f32 v[224:225], v[224:225], v[50:51] op_sel_hi:[1,0]
  v_pk_mul_f32 v[226:227], v[226:227], v[50:51] op_sel_hi:[1,0]
  v_pk_mul_f32 v[244:245], v[244:245], v[50:51] op_sel_hi:[1,0]
  v_pk_mul_f32 v[246:247], v[246:247], v[50:51] op_sel_hi:[1,0]
  v_mov_b32 v49, v47
  s_nop 1
  v_permlane16_swap_b32 v47, v49
  v_max_f32 v47, v47, v49
  v_mov_b32 v49, v47
  s_nop 1
  v_permlane32_swap_b32 v47, v49
  v_max_f32 v47, v47, v49
  v_max_f32 v47, 0, v47
  v_sub_f32 v50, 0, v47
  v_exp_f32 v50, v50
  v_sub_f32 v36, v36, v47
  v_sub_f32 v37, v37, v47
  v_sub_f32 v38, v38, v47
  v_sub_f32 v39, v39, v47
  v_sub_f32 v80, v80, v47
  v_sub_f32 v81, v81, v47
  v_sub_f32 v82, v82, v47
  v_sub_f32 v83, v83, v47
  v_sub_f32 v84, v84, v47
  v_sub_f32 v85, v85, v47
  v_sub_f32 v86, v86, v47
  v_sub_f32 v87, v87, v47
  v_accvgpr_read_b32 v52, a156
  v_mul_f32 v52, v52, v50
  v_accvgpr_write_b32 a156, v52
  v_accvgpr_read_b32 v52, a157
  v_mul_f32 v52, v52, v50
  v_accvgpr_write_b32 a157, v52
  v_accvgpr_read_b32 v52, a158
  v_mul_f32 v52, v52, v50
  v_accvgpr_write_b32 a158, v52
  v_accvgpr_read_b32 v52, a159
  v_mul_f32 v52, v52, v50
  v_accvgpr_write_b32 a159, v52
  v_pk_mul_f32 v[108:109], v[108:109], v[50:51] op_sel_hi:[1,0]
  v_pk_mul_f32 v[110:111], v[110:111], v[50:51] op_sel_hi:[1,0]
  v_pk_mul_f32 v[128:129], v[128:129], v[50:51] op_sel_hi:[1,0]
  v_pk_mul_f32 v[130:131], v[130:131], v[50:51] op_sel_hi:[1,0]
  v_pk_mul_f32 v[148:149], v[148:149], v[50:51] op_sel_hi:[1,0]
  v_pk_mul_f32 v[150:151], v[150:151], v[50:51] op_sel_hi:[1,0]
  v_pk_mul_f32 v[168:169], v[168:169], v[50:51] op_sel_hi:[1,0]
  v_pk_mul_f32 v[170:171], v[170:171], v[50:51] op_sel_hi:[1,0]
  v_pk_mul_f32 v[188:189], v[188:189], v[50:51] op_sel_hi:[1,0]
  v_pk_mul_f32 v[190:191], v[190:191], v[50:51] op_sel_hi:[1,0]
  v_pk_mul_f32 v[208:209], v[208:209], v[50:51] op_sel_hi:[1,0]
  v_pk_mul_f32 v[210:211], v[210:211], v[50:51] op_sel_hi:[1,0]
  v_pk_mul_f32 v[228:229], v[228:229], v[50:51] op_sel_hi:[1,0]
  v_pk_mul_f32 v[230:231], v[230:231], v[50:51] op_sel_hi:[1,0]
  v_pk_mul_f32 v[248:249], v[248:249], v[50:51] op_sel_hi:[1,0]
  v_pk_mul_f32 v[250:251], v[250:251], v[50:51] op_sel_hi:[1,0]
  v_mov_b32 v49, v48
  s_nop 1
  v_permlane16_swap_b32 v48, v49
  v_max_f32 v48, v48, v49
  v_mov_b32 v49, v48
  s_nop 1
  v_permlane32_swap_b32 v48, v49
  v_max_f32 v48, v48, v49
  v_max_f32 v48, 0, v48
  v_sub_f32 v50, 0, v48
  v_exp_f32 v50, v50
  v_sub_f32 v40, v40, v48
  v_sub_f32 v41, v41, v48
  v_sub_f32 v42, v42, v48
  v_sub_f32 v43, v43, v48
  v_sub_f32 v88, v88, v48
  v_sub_f32 v89, v89, v48
  v_sub_f32 v90, v90, v48
  v_sub_f32 v91, v91, v48
  v_sub_f32 v92, v92, v48
  v_sub_f32 v93, v93, v48
  v_sub_f32 v94, v94, v48
  v_sub_f32 v95, v95, v48
  v_accvgpr_read_b32 v52, a160
  v_mul_f32 v52, v52, v50
  v_accvgpr_write_b32 a160, v52
  v_accvgpr_read_b32 v52, a161
  v_mul_f32 v52, v52, v50
  v_accvgpr_write_b32 a161, v52
  v_accvgpr_read_b32 v52, a162
  v_mul_f32 v52, v52, v50
  v_accvgpr_write_b32 a162, v52
  v_accvgpr_read_b32 v52, a163
  v_mul_f32 v52, v52, v50
  v_accvgpr_write_b32 a163, v52
  v_pk_mul_f32 v[112:113], v[112:113], v[50:51] op_sel_hi:[1,0]
  v_pk_mul_f32 v[114:115], v[114:115], v[50:51] op_sel_hi:[1,0]
  v_pk_mul_f32 v[132:133], v[132:133], v[50:51] op_sel_hi:[1,0]
  v_pk_mul_f32 v[134:135], v[134:135], v[50:51] op_sel_hi:[1,0]
  v_pk_mul_f32 v[152:153], v[152:153], v[50:51] op_sel_hi:[1,0]
  v_pk_mul_f32 v[154:155], v[154:155], v[50:51] op_sel_hi:[1,0]
  v_pk_mul_f32 v[172:173], v[172:173], v[50:51] op_sel_hi:[1,0]
  v_pk_mul_f32 v[174:175], v[174:175], v[50:51] op_sel_hi:[1,0]
  v_pk_mul_f32 v[192:193], v[192:193], v[50:51] op_sel_hi:[1,0]
  v_pk_mul_f32 v[194:195], v[194:195], v[50:51] op_sel_hi:[1,0]
  v_pk_mul_f32 v[212:213], v[212:213], v[50:51] op_sel_hi:[1,0]
  v_pk_mul_f32 v[214:215], v[214:215], v[50:51] op_sel_hi:[1,0]
  v_pk_mul_f32 v[232:233], v[232:233], v[50:51] op_sel_hi:[1,0]
  v_pk_mul_f32 v[234:235], v[234:235], v[50:51] op_sel_hi:[1,0]
  v_pk_mul_f32 v[252:253], v[252:253], v[50:51] op_sel_hi:[1,0]
  v_pk_mul_f32 v[254:255], v[254:255], v[50:51] op_sel_hi:[1,0]
  s_nop 7
  s_branch L_concat_heads__gqa_block_cached__mha_block_cached__near_ridge_kernel_back3
L_concat_heads__gqa_block_cached__mha_block_cached__near_ridge_kernel_rare4:
  s_nop 7
  v_mov_b32 v49, v44
  s_nop 1
  v_permlane16_swap_b32 v44, v49
  v_max_f32 v44, v44, v49
  v_mov_b32 v49, v44
  s_nop 1
  v_permlane32_swap_b32 v44, v49
  v_max_f32 v44, v44, v49
  v_max_f32 v44, 0, v44
  v_sub_f32 v50, 0, v44
  v_exp_f32 v50, v50
  v_sub_f32 v24, v24, v44
  v_sub_f32 v25, v25, v44
  v_sub_f32 v26, v26, v44
  v_sub_f32 v27, v27, v44
  v_sub_f32 v56, v56, v44
  v_sub_f32 v57, v57, v44
  v_sub_f32 v58, v58, v44
  v_sub_f32 v59, v59, v44
  v_sub_f32 v60, v60, v44
  v_sub_f32 v61, v61, v44
  v_sub_f32 v62, v62, v44
  v_sub_f32 v63, v63, v44
  v_accvgpr_read_b32 v52, a144
  v_mul_f32 v52, v52, v50
  v_accvgpr_write_b32 a144, v52
  v_accvgpr_read_b32 v52, a145
  v_mul_f32 v52, v52, v50
  v_accvgpr_write_b32 a145, v52
  v_accvgpr_read_b32 v52, a146
  v_mul_f32 v52, v52, v50
  v_accvgpr_write_b32 a146, v52
  v_accvgpr_read_b32 v52, a147
  v_mul_f32 v52, v52, v50
  v_accvgpr_write_b32 a147, v52
  v_pk_mul_f32 v[96:97], v[96:97], v[50:51] op_sel_hi:[1,0]
  v_pk_mul_f32 v[98:99], v[98:99], v[50:51] op_sel_hi:[1,0]
  v_pk_mul_f32 v[116:117], v[116:117], v[50:51] op_sel_hi:[1,0]
  v_pk_mul_f32 v[118:119], v[118:119], v[50:51] op_sel_hi:[1,0]
  v_pk_mul_f32 v[136:137], v[136:137], v[50:51] op_sel_hi:[1,0]
  v_pk_mul_f32 v[138:139], v[138:139], v[50:51] op_sel_hi:[1,0]
  v_pk_mul_f32 v[156:157], v[156:157], v[50:51] op_sel_hi:[1,0]
  v_pk_mul_f32 v[158:159], v[158:159], v[50:51] op_sel_hi:[1,0]
  v_pk_mul_f32 v[176:177], v[176:177], v[50:51] op_sel_hi:[1,0]
  v_pk_mul_f32 v[178:179], v[178:179], v[50:51] op_sel_hi:[1,0]
  v_pk_mul_f32 v[196:197], v[196:197], v[50:51] op_sel_hi:[1,0]
  v_pk_mul_f32 v[198:199], v[198:199], v[50:51] op_sel_hi:[1,0]
  v_pk_mul_f32 v[216:217], v[216:217], v[50:51] op_sel_hi:[1,0]
  v_pk_mul_f32 v[218:219], v[218:219], v[50:51] op_sel_hi:[1,0]
  v_pk_mul_f32 v[236:237], v[236:237], v[50:51] op_sel_hi:[1,0]
  v_pk_mul_f32 v[238:239], v[238:239], v[50:51] op_sel_hi:[1,0]
  v_mov_b32 v49, v45
  s_nop 1
  v_permlane16_swap_b32 v45, v49
  v_max_f32 v45, v45, v49
  v_mov_b32 v49, v45
  s_nop 1
  v_permlane32_swap_b32 v45, v49
  v_max_f32 v45, v45, v49
  v_max_f32 v45, 0, v45
  v_sub_f32 v50, 0, v45
  v_exp_f32 v50, v50
  v_sub_f32 v28, v28, v45
  v_sub_f32 v29, v29, v45
  v_sub_f32 v30, v30, v45
  v_sub_f32 v31, v31, v45
  v_sub_f32 v64, v64, v45
  v_sub_f32 v65, v65, v45
  v_sub_f32 v66, v66, v45
  v_sub_f32 v67, v67, v45
  v_sub_f32 v68, v68, v45
  v_sub_f32 v69, v69, v45
  v_sub_f32 v70, v70, v45
  v_sub_f32 v71, v71, v45
  v_accvgpr_read_b32 v52, a148
  v_mul_f32 v52, v52, v50
  v_accvgpr_write_b32 a148, v52
  v_accvgpr_read_b32 v52, a149
  v_mul_f32 v52, v52, v50
  v_accvgpr_write_b32 a149, v52
  v_accvgpr_read_b32 v52, a150
  v_mul_f32 v52, v52, v50
  v_accvgpr_write_b32 a150, v52
  v_accvgpr_read_b32 v52, a151
  v_mul_f32 v52, v52, v50
  v_accvgpr_write_b32 a151, v52
  v_pk_mul_f32 v[100:101], v[100:101], v[50:51] op_sel_hi:[1,0]
  v_pk_mul_f32 v[102:103], v[102:103], v[50:51] op_sel_hi:[1,0]
  v_pk_mul_f32 v[120:121], v[120:121], v[50:51] op_sel_hi:[1,0]
  v_pk_mul_f32 v[122:123], v[122:123], v[50:51] op_sel_hi:[1,0]
  v_pk_mul_f32 v[140:141], v[140:141], v[50:51] op_sel_hi:[1,0]
  v_pk_mul_f32 v[142:143], v[142:143], v[50:51] op_sel_hi:[1,0]
  v_pk_mul_f32 v[160:161], v[160:161], v[50:51] op_sel_hi:[1,0]
  v_pk_mul_f32 v[162:163], v[162:163], v[50:51] op_sel_hi:[1,0]
  v_pk_mul_f32 v[180:181], v[180:181], v[50:51] op_sel_hi:[1,0]
  v_pk_mul_f32 v[182:183], v[182:183], v[50:51] op_sel_hi:[1,0]
  v_pk_mul_f32 v[200:201], v[200:201], v[50:51] op_sel_hi:[1,0]
  v_pk_mul_f32 v[202:203], v[202:203], v[50:51] op_sel_hi:[1,0]
  v_pk_mul_f32 v[220:221], v[220:221], v[50:51] op_sel_hi:[1,0]
  v_pk_mul_f32 v[222:223], v[222:223], v[50:51] op_sel_hi:[1,0]
  v_pk_mul_f32 v[240:241], v[240:241], v[50:51] op_sel_hi:[1,0]
  v_pk_mul_f32 v[242:243], v[242:243], v[50:51] op_sel_hi:[1,0]
  v_mov_b32 v49, v46
  s_nop 1
  v_permlane16_swap_b32 v46, v49
  v_max_f32 v46, v46, v49
  v_mov_b32 v49, v46
  s_nop 1
  v_permlane32_swap_b32 v46, v49
  v_max_f32 v46, v46, v49
  v_max_f32 v46, 0, v46
  v_sub_f32 v50, 0, v46
  v_exp_f32 v50, v50
  v_sub_f32 v32, v32, v46
  v_sub_f32 v33, v33, v46
  v_sub_f32 v34, v34, v46
  v_sub_f32 v35, v35, v46
  v_sub_f32 v72, v72, v46
  v_sub_f32 v73, v73, v46
  v_sub_f32 v74, v74, v46
  v_sub_f32 v75, v75, v46
  v_sub_f32 v76, v76, v46
  v_sub_f32 v77, v77, v46
  v_sub_f32 v78, v78, v46
  v_sub_f32 v79, v79, v46
  v_accvgpr_read_b32 v52, a152
  v_mul_f32 v52, v52, v50
  v_accvgpr_write_b32 a152, v52
  v_accvgpr_read_b32 v52, a153
  v_mul_f32 v52, v52, v50
  v_accvgpr_write_b32 a153, v52
  v_accvgpr_read_b32 v52, a154
  v_mul_f32 v52, v52, v50
  v_accvgpr_write_b32 a154, v52
  v_accvgpr_read_b32 v52, a155
  v_mul_f32 v52, v52, v50
  v_accvgpr_write_b32 a155, v52
  v_pk_mul_f32 v[104:105], v[104:105], v[50:51] op_sel_hi:[1,0]
  v_pk_mul_f32 v[106:107], v[106:107], v[50:51] op_sel_hi:[1,0]
  v_pk_mul_f32 v[124:125], v[124:125], v[50:51] op_sel_hi:[1,0]
  v_pk_mul_f32 v[126:127], v[126:127], v[50:51] op_sel_hi:[1,0]
  v_pk_mul_f32 v[144:145], v[144:145], v[50:51] op_sel_hi:[1,0]
  v_pk_mul_f32 v[146:147], v[146:147], v[50:51] op_sel_hi:[1,0]
  v_pk_mul_f32 v[164:165], v[164:165], v[50:51] op_sel_hi:[1,0]
  v_pk_mul_f32 v[166:167], v[166:167], v[50:51] op_sel_hi:[1,0]
  v_pk_mul_f32 v[184:185], v[184:185], v[50:51] op_sel_hi:[1,0]
  v_pk_mul_f32 v[186:187], v[186:187], v[50:51] op_sel_hi:[1,0]
  v_pk_mul_f32 v[204:205], v[204:205], v[50:51] op_sel_hi:[1,0]
  v_pk_mul_f32 v[206:207], v[206:207], v[50:51] op_sel_hi:[1,0]
  v_pk_mul_f32 v[224:225], v[224:225], v[50:51] op_sel_hi:[1,0]
  v_pk_mul_f32 v[226:227], v[226:227], v[50:51] op_sel_hi:[1,0]
  v_pk_mul_f32 v[244:245], v[244:245], v[50:51] op_sel_hi:[1,0]
  v_pk_mul_f32 v[246:247], v[246:247], v[50:51] op_sel_hi:[1,0]
  v_mov_b32 v49, v47
  s_nop 1
  v_permlane16_swap_b32 v47, v49
  v_max_f32 v47, v47, v49
  v_mov_b32 v49, v47
  s_nop 1
  v_permlane32_swap_b32 v47, v49
  v_max_f32 v47, v47, v49
  v_max_f32 v47, 0, v47
  v_sub_f32 v50, 0, v47
  v_exp_f32 v50, v50
  v_sub_f32 v36, v36, v47
  v_sub_f32 v37, v37, v47
  v_sub_f32 v38, v38, v47
  v_sub_f32 v39, v39, v47
  v_sub_f32 v80, v80, v47
  v_sub_f32 v81, v81, v47
  v_sub_f32 v82, v82, v47
  v_sub_f32 v83, v83, v47
  v_sub_f32 v84, v84, v47
  v_sub_f32 v85, v85, v47
  v_sub_f32 v86, v86, v47
  v_sub_f32 v87, v87, v47
  v_accvgpr_read_b32 v52, a156
  v_mul_f32 v52, v52, v50
  v_accvgpr_write_b32 a156, v52
  v_accvgpr_read_b32 v52, a157
  v_mul_f32 v52, v52, v50
  v_accvgpr_write_b32 a157, v52
  v_accvgpr_read_b32 v52, a158
  v_mul_f32 v52, v52, v50
  v_accvgpr_write_b32 a158, v52
  v_accvgpr_read_b32 v52, a159
  v_mul_f32 v52, v52, v50
  v_accvgpr_write_b32 a159, v52
  v_pk_mul_f32 v[108:109], v[108:109], v[50:51] op_sel_hi:[1,0]
  v_pk_mul_f32 v[110:111], v[110:111], v[50:51] op_sel_hi:[1,0]
  v_pk_mul_f32 v[128:129], v[128:129], v[50:51] op_sel_hi:[1,0]
  v_pk_mul_f32 v[130:131], v[130:131], v[50:51] op_sel_hi:[1,0]
  v_pk_mul_f32 v[148:149], v[148:149], v[50:51] op_sel_hi:[1,0]
  v_pk_mul_f32 v[150:151], v[150:151], v[50:51] op_sel_hi:[1,0]
  v_pk_mul_f32 v[168:169], v[168:169], v[50:51] op_sel_hi:[1,0]
  v_pk_mul_f32 v[170:171], v[170:171], v[50:51] op_sel_hi:[1,0]
  v_pk_mul_f32 v[188:189], v[188:189], v[50:51] op_sel_hi:[1,0]
  v_pk_mul_f32 v[190:191], v[190:191], v[50:51] op_sel_hi:[1,0]
  v_pk_mul_f32 v[208:209], v[208:209], v[50:51] op_sel_hi:[1,0]
  v_pk_mul_f32 v[210:211], v[210:211], v[50:51] op_sel_hi:[1,0]
  v_pk_mul_f32 v[228:229], v[228:229], v[50:51] op_sel_hi:[1,0]
  v_pk_mul_f32 v[230:231], v[230:231], v[50:51] op_sel_hi:[1,0]
  v_pk_mul_f32 v[248:249], v[248:249], v[50:51] op_sel_hi:[1,0]
  v_pk_mul_f32 v[250:251], v[250:251], v[50:51] op_sel_hi:[1,0]
  v_mov_b32 v49, v48
  s_nop 1
  v_permlane16_swap_b32 v48, v49
  v_max_f32 v48, v48, v49
  v_mov_b32 v49, v48
  s_nop 1
  v_permlane32_swap_b32 v48, v49
  v_max_f32 v48, v48, v49
  v_max_f32 v48, 0, v48
  v_sub_f32 v50, 0, v48
  v_exp_f32 v50, v50
  v_sub_f32 v40, v40, v48
  v_sub_f32 v41, v41, v48
  v_sub_f32 v42, v42, v48
  v_sub_f32 v43, v43, v48
  v_sub_f32 v88, v88, v48
  v_sub_f32 v89, v89, v48
  v_sub_f32 v90, v90, v48
  v_sub_f32 v91, v91, v48
  v_sub_f32 v92, v92, v48
  v_sub_f32 v93, v93, v48
  v_sub_f32 v94, v94, v48
  v_sub_f32 v95, v95, v48
  v_accvgpr_read_b32 v52, a160
  v_mul_f32 v52, v52, v50
  v_accvgpr_write_b32 a160, v52
  v_accvgpr_read_b32 v52, a161
  v_mul_f32 v52, v52, v50
  v_accvgpr_write_b32 a161, v52
  v_accvgpr_read_b32 v52, a162
  v_mul_f32 v52, v52, v50
  v_accvgpr_write_b32 a162, v52
  v_accvgpr_read_b32 v52, a163
  v_mul_f32 v52, v52, v50
  v_accvgpr_write_b32 a163, v52
  v_pk_mul_f32 v[112:113], v[112:113], v[50:51] op_sel_hi:[1,0]
  v_pk_mul_f32 v[114:115], v[114:115], v[50:51] op_sel_hi:[1,0]
  v_pk_mul_f32 v[132:133], v[132:133], v[50:51] op_sel_hi:[1,0]
  v_pk_mul_f32 v[134:135], v[134:135], v[50:51] op_sel_hi:[1,0]
  v_pk_mul_f32 v[152:153], v[152:153], v[50:51] op_sel_hi:[1,0]
  v_pk_mul_f32 v[154:155], v[154:155], v[50:51] op_sel_hi:[1,0]
  v_pk_mul_f32 v[172:173], v[172:173], v[50:51] op_sel_hi:[1,0]
  v_pk_mul_f32 v[174:175], v[174:175], v[50:51] op_sel_hi:[1,0]
  v_pk_mul_f32 v[192:193], v[192:193], v[50:51] op_sel_hi:[1,0]
  v_pk_mul_f32 v[194:195], v[194:195], v[50:51] op_sel_hi:[1,0]
  v_pk_mul_f32 v[212:213], v[212:213], v[50:51] op_sel_hi:[1,0]
  v_pk_mul_f32 v[214:215], v[214:215], v[50:51] op_sel_hi:[1,0]
  v_pk_mul_f32 v[232:233], v[232:233], v[50:51] op_sel_hi:[1,0]
  v_pk_mul_f32 v[234:235], v[234:235], v[50:51] op_sel_hi:[1,0]
  v_pk_mul_f32 v[252:253], v[252:253], v[50:51] op_sel_hi:[1,0]
  v_pk_mul_f32 v[254:255], v[254:255], v[50:51] op_sel_hi:[1,0]
  s_nop 7
  s_branch L_concat_heads__gqa_block_cached__mha_block_cached__near_ridge_kernel_back4
L_concat_heads__gqa_block_cached__mha_block_cached__near_ridge_kernel_rare5:
  s_nop 7
  v_mov_b32 v49, v44
  s_nop 1
  v_permlane16_swap_b32 v44, v49
  v_max_f32 v44, v44, v49
  v_mov_b32 v49, v44
  s_nop 1
  v_permlane32_swap_b32 v44, v49
  v_max_f32 v44, v44, v49
  v_max_f32 v44, 0, v44
  v_sub_f32 v50, 0, v44
  v_exp_f32 v50, v50
  v_sub_f32 v24, v24, v44
  v_sub_f32 v25, v25, v44
  v_sub_f32 v26, v26, v44
  v_sub_f32 v27, v27, v44
  v_sub_f32 v56, v56, v44
  v_sub_f32 v57, v57, v44
  v_sub_f32 v58, v58, v44
  v_sub_f32 v59, v59, v44
  v_sub_f32 v60, v60, v44
  v_sub_f32 v61, v61, v44
  v_sub_f32 v62, v62, v44
  v_sub_f32 v63, v63, v44
  v_accvgpr_read_b32 v52, a144
  v_mul_f32 v52, v52, v50
  v_accvgpr_write_b32 a144, v52
  v_accvgpr_read_b32 v52, a145
  v_mul_f32 v52, v52, v50
  v_accvgpr_write_b32 a145, v52
  v_accvgpr_read_b32 v52, a146
  v_mul_f32 v52, v52, v50
  v_accvgpr_write_b32 a146, v52
  v_accvgpr_read_b32 v52, a147
  v_mul_f32 v52, v52, v50
  v_accvgpr_write_b32 a147, v52
  v_pk_mul_f32 v[96:97], v[96:97], v[50:51] op_sel_hi:[1,0]
  v_pk_mul_f32 v[98:99], v[98:99], v[50:51] op_sel_hi:[1,0]
  v_pk_mul_f32 v[116:117], v[116:117], v[50:51] op_sel_hi:[1,0]
  v_pk_mul_f32 v[118:119], v[118:119], v[50:51] op_sel_hi:[1,0]
  v_pk_mul_f32 v[136:137], v[136:137], v[50:51] op_sel_hi:[1,0]
  v_pk_mul_f32 v[138:139], v[138:139], v[50:51] op_sel_hi:[1,0]
  v_pk_mul_f32 v[156:157], v[156:157], v[50:51] op_sel_hi:[1,0]
  v_pk_mul_f32 v[158:159], v[158:159], v[50:51] op_sel_hi:[1,0]
  v_pk_mul_f32 v[176:177], v[176:177], v[50:51] op_sel_hi:[1,0]
  v_pk_mul_f32 v[178:179], v[178:179], v[50:51] op_sel_hi:[1,0]
  v_pk_mul_f32 v[196:197], v[196:197], v[50:51] op_sel_hi:[1,0]
  v_pk_mul_f32 v[198:199], v[198:199], v[50:51] op_sel_hi:[1,0]
  v_pk_mul_f32 v[216:217], v[216:217], v[50:51] op_sel_hi:[1,0]
  v_pk_mul_f32 v[218:219], v[218:219], v[50:51] op_sel_hi:[1,0]
  v_pk_mul_f32 v[236:237], v[236:237], v[50:51] op_sel_hi:[1,0]
  v_pk_mul_f32 v[238:239], v[238:239], v[50:51] op_sel_hi:[1,0]
  v_mov_b32 v49, v45
  s_nop 1
  v_permlane16_swap_b32 v45, v49
  v_max_f32 v45, v45, v49
  v_mov_b32 v49, v45
  s_nop 1
  v_permlane32_swap_b32 v45, v49
  v_max_f32 v45, v45, v49
  v_max_f32 v45, 0, v45
  v_sub_f32 v50, 0, v45
  v_exp_f32 v50, v50
  v_sub_f32 v28, v28, v45
  v_sub_f32 v29, v29, v45
  v_sub_f32 v30, v30, v45
  v_sub_f32 v31, v31, v45
  v_sub_f32 v64, v64, v45
  v_sub_f32 v65, v65, v45
  v_sub_f32 v66, v66, v45
  v_sub_f32 v67, v67, v45
  v_sub_f32 v68, v68, v45
  v_sub_f32 v69, v69, v45
  v_sub_f32 v70, v70, v45
  v_sub_f32 v71, v71, v45
  v_accvgpr_read_b32 v52, a148
  v_mul_f32 v52, v52, v50
  v_accvgpr_write_b32 a148, v52
  v_accvgpr_read_b32 v52, a149
  v_mul_f32 v52, v52, v50
  v_accvgpr_write_b32 a149, v52
  v_accvgpr_read_b32 v52, a150
  v_mul_f32 v52, v52, v50
  v_accvgpr_write_b32 a150, v52
  v_accvgpr_read_b32 v52, a151
  v_mul_f32 v52, v52, v50
  v_accvgpr_write_b32 a151, v52
  v_pk_mul_f32 v[100:101], v[100:101], v[50:51] op_sel_hi:[1,0]
  v_pk_mul_f32 v[102:103], v[102:103], v[50:51] op_sel_hi:[1,0]
  v_pk_mul_f32 v[120:121], v[120:121], v[50:51] op_sel_hi:[1,0]
  v_pk_mul_f32 v[122:123], v[122:123], v[50:51] op_sel_hi:[1,0]
  v_pk_mul_f32 v[140:141], v[140:141], v[50:51] op_sel_hi:[1,0]
  v_pk_mul_f32 v[142:143], v[142:143], v[50:51] op_sel_hi:[1,0]
  v_pk_mul_f32 v[160:161], v[160:161], v[50:51] op_sel_hi:[1,0]
  v_pk_mul_f32 v[162:163], v[162:163], v[50:51] op_sel_hi:[1,0]
  v_pk_mul_f32 v[180:181], v[180:181], v[50:51] op_sel_hi:[1,0]
  v_pk_mul_f32 v[182:183], v[182:183], v[50:51] op_sel_hi:[1,0]
  v_pk_mul_f32 v[200:201], v[200:201], v[50:51] op_sel_hi:[1,0]
  v_pk_mul_f32 v[202:203], v[202:203], v[50:51] op_sel_hi:[1,0]
  v_pk_mul_f32 v[220:221], v[220:221], v[50:51] op_sel_hi:[1,0]
  v_pk_mul_f32 v[222:223], v[222:223], v[50:51] op_sel_hi:[1,0]
  v_pk_mul_f32 v[240:241], v[240:241], v[50:51] op_sel_hi:[1,0]
  v_pk_mul_f32 v[242:243], v[242:243], v[50:51] op_sel_hi:[1,0]
  v_mov_b32 v49, v46
  s_nop 1
  v_permlane16_swap_b32 v46, v49
  v_max_f32 v46, v46, v49
  v_mov_b32 v49, v46
  s_nop 1
  v_permlane32_swap_b32 v46, v49
  v_max_f32 v46, v46, v49
  v_max_f32 v46, 0, v46
  v_sub_f32 v50, 0, v46
  v_exp_f32 v50, v50
  v_sub_f32 v32, v32, v46
  v_sub_f32 v33, v33, v46
  v_sub_f32 v34, v34, v46
  v_sub_f32 v35, v35, v46
  v_sub_f32 v72, v72, v46
  v_sub_f32 v73, v73, v46
  v_sub_f32 v74, v74, v46
  v_sub_f32 v75, v75, v46
  v_sub_f32 v76, v76, v46
  v_sub_f32 v77, v77, v46
  v_sub_f32 v78, v78, v46
  v_sub_f32 v79, v79, v46
  v_accvgpr_read_b32 v52, a152
  v_mul_f32 v52, v52, v50
  v_accvgpr_write_b32 a152, v52
  v_accvgpr_read_b32 v52, a153
  v_mul_f32 v52, v52, v50
  v_accvgpr_write_b32 a153, v52
  v_accvgpr_read_b32 v52, a154
  v_mul_f32 v52, v52, v50
  v_accvgpr_write_b32 a154, v52
  v_accvgpr_read_b32 v52, a155
  v_mul_f32 v52, v52, v50
  v_accvgpr_write_b32 a155, v52
  v_pk_mul_f32 v[104:105], v[104:105], v[50:51] op_sel_hi:[1,0]
  v_pk_mul_f32 v[106:107], v[106:107], v[50:51] op_sel_hi:[1,0]
  v_pk_mul_f32 v[124:125], v[124:125], v[50:51] op_sel_hi:[1,0]
  v_pk_mul_f32 v[126:127], v[126:127], v[50:51] op_sel_hi:[1,0]
  v_pk_mul_f32 v[144:145], v[144:145], v[50:51] op_sel_hi:[1,0]
  v_pk_mul_f32 v[146:147], v[146:147], v[50:51] op_sel_hi:[1,0]
  v_pk_mul_f32 v[164:165], v[164:165], v[50:51] op_sel_hi:[1,0]
  v_pk_mul_f32 v[166:167], v[166:167], v[50:51] op_sel_hi:[1,0]
  v_pk_mul_f32 v[184:185], v[184:185], v[50:51] op_sel_hi:[1,0]
  v_pk_mul_f32 v[186:187], v[186:187], v[50:51] op_sel_hi:[1,0]
  v_pk_mul_f32 v[204:205], v[204:205], v[50:51] op_sel_hi:[1,0]
  v_pk_mul_f32 v[206:207], v[206:207], v[50:51] op_sel_hi:[1,0]
  v_pk_mul_f32 v[224:225], v[224:225], v[50:51] op_sel_hi:[1,0]
  v_pk_mul_f32 v[226:227], v[226:227], v[50:51] op_sel_hi:[1,0]
  v_pk_mul_f32 v[244:245], v[244:245], v[50:51] op_sel_hi:[1,0]
  v_pk_mul_f32 v[246:247], v[246:247], v[50:51] op_sel_hi:[1,0]
  v_mov_b32 v49, v47
  s_nop 1
  v_permlane16_swap_b32 v47, v49
  v_max_f32 v47, v47, v49
  v_mov_b32 v49, v47
  s_nop 1
  v_permlane32_swap_b32 v47, v49
  v_max_f32 v47, v47, v49
  v_max_f32 v47, 0, v47
  v_sub_f32 v50, 0, v47
  v_exp_f32 v50, v50
  v_sub_f32 v36, v36, v47
  v_sub_f32 v37, v37, v47
  v_sub_f32 v38, v38, v47
  v_sub_f32 v39, v39, v47
  v_sub_f32 v80, v80, v47
  v_sub_f32 v81, v81, v47
  v_sub_f32 v82, v82, v47
  v_sub_f32 v83, v83, v47
  v_sub_f32 v84, v84, v47
  v_sub_f32 v85, v85, v47
  v_sub_f32 v86, v86, v47
  v_sub_f32 v87, v87, v47
  v_accvgpr_read_b32 v52, a156
  v_mul_f32 v52, v52, v50
  v_accvgpr_write_b32 a156, v52
  v_accvgpr_read_b32 v52, a157
  v_mul_f32 v52, v52, v50
  v_accvgpr_write_b32 a157, v52
  v_accvgpr_read_b32 v52, a158
  v_mul_f32 v52, v52, v50
  v_accvgpr_write_b32 a158, v52
  v_accvgpr_read_b32 v52, a159
  v_mul_f32 v52, v52, v50
  v_accvgpr_write_b32 a159, v52
  v_pk_mul_f32 v[108:109], v[108:109], v[50:51] op_sel_hi:[1,0]
  v_pk_mul_f32 v[110:111], v[110:111], v[50:51] op_sel_hi:[1,0]
  v_pk_mul_f32 v[128:129], v[128:129], v[50:51] op_sel_hi:[1,0]
  v_pk_mul_f32 v[130:131], v[130:131], v[50:51] op_sel_hi:[1,0]
  v_pk_mul_f32 v[148:149], v[148:149], v[50:51] op_sel_hi:[1,0]
  v_pk_mul_f32 v[150:151], v[150:151], v[50:51] op_sel_hi:[1,0]
  v_pk_mul_f32 v[168:169], v[168:169], v[50:51] op_sel_hi:[1,0]
  v_pk_mul_f32 v[170:171], v[170:171], v[50:51] op_sel_hi:[1,0]
  v_pk_mul_f32 v[188:189], v[188:189], v[50:51] op_sel_hi:[1,0]
  v_pk_mul_f32 v[190:191], v[190:191], v[50:51] op_sel_hi:[1,0]
  v_pk_mul_f32 v[208:209], v[208:209], v[50:51] op_sel_hi:[1,0]
  v_pk_mul_f32 v[210:211], v[210:211], v[50:51] op_sel_hi:[1,0]
  v_pk_mul_f32 v[228:229], v[228:229], v[50:51] op_sel_hi:[1,0]
  v_pk_mul_f32 v[230:231], v[230:231], v[50:51] op_sel_hi:[1,0]
  v_pk_mul_f32 v[248:249], v[248:249], v[50:51] op_sel_hi:[1,0]
  v_pk_mul_f32 v[250:251], v[250:251], v[50:51] op_sel_hi:[1,0]
  v_mov_b32 v49, v48
  s_nop 1
  v_permlane16_swap_b32 v48, v49
  v_max_f32 v48, v48, v49
  v_mov_b32 v49, v48
  s_nop 1
  v_permlane32_swap_b32 v48, v49
  v_max_f32 v48, v48, v49
  v_max_f32 v48, 0, v48
  v_sub_f32 v50, 0, v48
  v_exp_f32 v50, v50
  v_sub_f32 v40, v40, v48
  v_sub_f32 v41, v41, v48
  v_sub_f32 v42, v42, v48
  v_sub_f32 v43, v43, v48
  v_sub_f32 v88, v88, v48
  v_sub_f32 v89, v89, v48
  v_sub_f32 v90, v90, v48
  v_sub_f32 v91, v91, v48
  v_sub_f32 v92, v92, v48
  v_sub_f32 v93, v93, v48
  v_sub_f32 v94, v94, v48
  v_sub_f32 v95, v95, v48
  v_accvgpr_read_b32 v52, a160
  v_mul_f32 v52, v52, v50
  v_accvgpr_write_b32 a160, v52
  v_accvgpr_read_b32 v52, a161
  v_mul_f32 v52, v52, v50
  v_accvgpr_write_b32 a161, v52
  v_accvgpr_read_b32 v52, a162
  v_mul_f32 v52, v52, v50
  v_accvgpr_write_b32 a162, v52
  v_accvgpr_read_b32 v52, a163
  v_mul_f32 v52, v52, v50
  v_accvgpr_write_b32 a163, v52
  v_pk_mul_f32 v[112:113], v[112:113], v[50:51] op_sel_hi:[1,0]
  v_pk_mul_f32 v[114:115], v[114:115], v[50:51] op_sel_hi:[1,0]
  v_pk_mul_f32 v[132:133], v[132:133], v[50:51] op_sel_hi:[1,0]
  v_pk_mul_f32 v[134:135], v[134:135], v[50:51] op_sel_hi:[1,0]
  v_pk_mul_f32 v[152:153], v[152:153], v[50:51] op_sel_hi:[1,0]
  v_pk_mul_f32 v[154:155], v[154:155], v[50:51] op_sel_hi:[1,0]
  v_pk_mul_f32 v[172:173], v[172:173], v[50:51] op_sel_hi:[1,0]
  v_pk_mul_f32 v[174:175], v[174:175], v[50:51] op_sel_hi:[1,0]
  v_pk_mul_f32 v[192:193], v[192:193], v[50:51] op_sel_hi:[1,0]
  v_pk_mul_f32 v[194:195], v[194:195], v[50:51] op_sel_hi:[1,0]
  v_pk_mul_f32 v[212:213], v[212:213], v[50:51] op_sel_hi:[1,0]
  v_pk_mul_f32 v[214:215], v[214:215], v[50:51] op_sel_hi:[1,0]
  v_pk_mul_f32 v[232:233], v[232:233], v[50:51] op_sel_hi:[1,0]
  v_pk_mul_f32 v[234:235], v[234:235], v[50:51] op_sel_hi:[1,0]
  v_pk_mul_f32 v[252:253], v[252:253], v[50:51] op_sel_hi:[1,0]
  v_pk_mul_f32 v[254:255], v[254:255], v[50:51] op_sel_hi:[1,0]
  s_nop 7
  s_branch L_concat_heads__gqa_block_cached__mha_block_cached__near_ridge_kernel_back5
L_concat_heads__gqa_block_cached__mha_block_cached__near_ridge_kernel_rareend:
  s_endpgm

.section .rodata,"a"
.p2align 6
.amdhsa_kernel concat_heads__gqa_block_cached__mha_block_cached__near_ridge_kernel
  .amdhsa_next_free_vgpr 512
  .amdhsa_next_free_sgpr 102
  .amdhsa_accum_offset 256
  .amdhsa_group_segment_fixed_size 0
  .amdhsa_kernarg_size 104
  .amdhsa_user_sgpr_count 2
  .amdhsa_user_sgpr_kernarg_segment_ptr 1
  .amdhsa_system_sgpr_workgroup_id_x 1
.end_amdhsa_kernel
```
